```python
import torch

def _softmax(x, axis=-1):
    return torch.softmax(x, dim=axis)
def _gelu(x):
    return torch.nn.functional.gelu(x, approximate="tanh")
def _silu(x):
    return torch.nn.functional.silu(x)
def _sigmoid(x):
    return torch.sigmoid(x)
def _layernorm(x, axis=-1, eps=1e-5):
    m = x.mean(dim=axis, keepdim=True)
    v = x.var(dim=axis, keepdim=True, unbiased=False)
    return (x - m) / torch.sqrt(v + eps)
def _scatter_add(tgt, idx, src, axis=0):
    return tgt.clone().index_add_(axis, idx, src)
def _segment_sum(src, seg, n):
    out = torch.zeros((n,) + src.shape[1:], dtype=src.dtype)
    return out.index_add_(0, seg, src)
def _pad(x, pw):
    flat = tuple(v for pair in reversed(pw) for v in pair)
    return torch.nn.functional.pad(x, flat)

kernel_name = 'recurrent_scan__sliding_block_cached__mixer_s_mlp__prompt'

def setup_inputs():

    _w = (lambda a: (lambda t: t.to(torch.bfloat16) if t.is_floating_point() else t)(torch.as_tensor(a)))
    def _A_setup():
        B, Sq, D = 1, 2048, 1024
        Hq, Hkv, Sk, Dh = 32, 4, 2048, 128
        assert Hq % Hkv == 0, (Hq, Hkv)
        return {
            "x": _w((lambda *s: torch.randn(*s, dtype=torch.bfloat16) * 0.05)(B, Sq, D)),
            "k_cache": _w((lambda *s: torch.randn(*s, dtype=torch.bfloat16) * 0.8)(B, Hkv, Sk, Dh)),
            "v_cache": _w((lambda *s: torch.randn(*s, dtype=torch.bfloat16) * 0.8)(B, Hkv, Sk, Dh)),
            "wq": _w((lambda *s: torch.randn(*s, dtype=torch.bfloat16) * 0.8)(D, Hq * Dh) * (D ** -0.5)),
            "wo": _w((lambda *s: torch.randn(*s, dtype=torch.bfloat16) * 0.8)(Hq * Dh, D) * ((Hq * Dh) ** -0.5)),
        }
    _A_in = _A_setup()

    def _B_setup():
        B, S, D, F = 1, 2048, 1024, 3584
        return {
            "x":  _w((lambda *s: torch.randn(*s, dtype=torch.bfloat16) * 0.05)(B, S, D)),
            "w1": _w((lambda *s: torch.randn(*s, dtype=torch.bfloat16) * 3.2)(D, D) * (D ** -0.5)),
            "w2": _w((lambda *s: torch.randn(*s, dtype=torch.bfloat16) * 3.2)(D, D) * (D ** -0.5)),
            "w3": _w((lambda *s: torch.randn(*s, dtype=torch.bfloat16) * 3.2)(D, F) * (D ** -0.5)),
            "w4": _w((lambda *s: torch.randn(*s, dtype=torch.bfloat16) * 1.6)(F, D) * (F ** -0.5)),
        }
    _B_in = _B_setup()

    return {
        "A_x": _A_in["x"],
        "A_k_cache": _A_in["k_cache"],
        "A_v_cache": _A_in["v_cache"],
        "A_wq": _A_in["wq"],
        "A_wo": _A_in["wo"],
        "B_x": _B_in["x"],
        "B_w1": _B_in["w1"],
        "B_w2": _B_in["w2"],
        "B_w3": _B_in["w3"],
        "B_w4": _B_in["w4"],
    }

def reference(A_x, A_k_cache, A_v_cache, A_wq, A_wo, B_x, B_w1, B_w2, B_w3, B_w4):
    def _A_ref(x, k_cache, v_cache, wq, wo):
        B, Sq, D = x.shape
        Hq, Dh = 32, 128
        Hkv, Sk = k_cache.shape[1], k_cache.shape[2]
        W = min(4096, max(256, Sk // 4))
        rep = Hq // Hkv
        q = (lambda x, *d: x.permute(*d))((x @ wq).reshape(B, Sq, Hq, Dh), 0, 2, 1, 3)
        k = (lambda x, n, axis: torch.repeat_interleave(x, n, dim=axis))(k_cache[:, :, Sk - W:, :], rep, axis=1)
        v = (lambda x, n, axis: torch.repeat_interleave(x, n, dim=axis))(v_cache[:, :, Sk - W:, :], rep, axis=1)
        scores = torch.einsum("bhqd,bhkd->bhqk", q, k) * (Dh ** -0.5)
        p = _softmax(scores, axis=-1)
        o = torch.einsum("bhqk,bhkd->bhqd", p, v)
        return (lambda x, *d: x.permute(*d))(o, 0, 2, 1, 3).reshape(B, Sq, Hq * Dh) @ wo

    def _B_ref(x, w1, w2, w3, w4):
        B, S, D = x.shape
        h = _gelu(_layernorm(x, axis=-1) @ w1)
        c = D // 4
        g0 = _pad(h[:, :, 0*c:1*c], ((0, 0), (1, 0), (0, 0)))[:, :S, :]
        g1 = _pad(h[:, :, 1*c:2*c], ((0, 0), (0, 1), (0, 0)))[:, 1:, :]
        g2 = _pad(h[:, :, 2*c:3*c], ((0, 0), (2, 0), (0, 0)))[:, :S, :]
        g3 = _pad(h[:, :, 3*c:   ], ((0, 0), (0, 2), (0, 0)))[:, 2:, :]
        hs = torch.concatenate([g0, g1, g2, g3], axis=-1) @ w2
        x1 = x + hs
        h2 = _gelu(_layernorm(x1, axis=-1) @ w3) @ w4
        return x1 + h2

    x = A_x
    xn = _layernorm(x, axis=-1)
    s = _A_ref(xn, A_k_cache, A_v_cache, A_wq, A_wo)
    g = _silu(_B_ref(xn, B_w1, B_w2, B_w3, B_w4))
    return x + s * g
```

```asm
; @launch kernel=m1_kernel grid=(256,1,1) block=(256,1,1) lds=163840
.amdgcn_target "amdgcn-amd-amdhsa--gfx950"
.macro Maaa d,a,b
v_mfma_f32_16x16x32_bf16 a[\d:\d+3], a[\a:\a+3], a[\b:\b+3], a[\d:\d+3]
.endm
.macro Zaaa d,a,b
v_mfma_f32_16x16x32_bf16 a[\d:\d+3], a[\a:\a+3], a[\b:\b+3], 0
.endm
.macro Caaa d,a,b,c
v_mfma_f32_16x16x32_bf16 a[\d:\d+3], a[\a:\a+3], a[\b:\b+3], a[\c:\c+3]
.endm
.macro Maav d,a,b
v_mfma_f32_16x16x32_bf16 a[\d:\d+3], a[\a:\a+3], v[\b:\b+3], a[\d:\d+3]
.endm
.macro Zaav d,a,b
v_mfma_f32_16x16x32_bf16 a[\d:\d+3], a[\a:\a+3], v[\b:\b+3], 0
.endm
.macro Caav d,a,b,c
v_mfma_f32_16x16x32_bf16 a[\d:\d+3], a[\a:\a+3], v[\b:\b+3], a[\c:\c+3]
.endm
.macro Mava d,a,b
v_mfma_f32_16x16x32_bf16 a[\d:\d+3], v[\a:\a+3], a[\b:\b+3], a[\d:\d+3]
.endm
.macro Zava d,a,b
v_mfma_f32_16x16x32_bf16 a[\d:\d+3], v[\a:\a+3], a[\b:\b+3], 0
.endm
.macro Cava d,a,b,c
v_mfma_f32_16x16x32_bf16 a[\d:\d+3], v[\a:\a+3], a[\b:\b+3], a[\c:\c+3]
.endm
.macro Mavv d,a,b
v_mfma_f32_16x16x32_bf16 a[\d:\d+3], v[\a:\a+3], v[\b:\b+3], a[\d:\d+3]
.endm
.macro Zavv d,a,b
v_mfma_f32_16x16x32_bf16 a[\d:\d+3], v[\a:\a+3], v[\b:\b+3], 0
.endm
.macro Cavv d,a,b,c
v_mfma_f32_16x16x32_bf16 a[\d:\d+3], v[\a:\a+3], v[\b:\b+3], a[\c:\c+3]
.endm
.macro Mvaa d,a,b
v_mfma_f32_16x16x32_bf16 v[\d:\d+3], a[\a:\a+3], a[\b:\b+3], v[\d:\d+3]
.endm
.macro Zvaa d,a,b
v_mfma_f32_16x16x32_bf16 v[\d:\d+3], a[\a:\a+3], a[\b:\b+3], 0
.endm
.macro Cvaa d,a,b,c
v_mfma_f32_16x16x32_bf16 v[\d:\d+3], a[\a:\a+3], a[\b:\b+3], v[\c:\c+3]
.endm
.macro Mvav d,a,b
v_mfma_f32_16x16x32_bf16 v[\d:\d+3], a[\a:\a+3], v[\b:\b+3], v[\d:\d+3]
.endm
.macro Zvav d,a,b
v_mfma_f32_16x16x32_bf16 v[\d:\d+3], a[\a:\a+3], v[\b:\b+3], 0
.endm
.macro Cvav d,a,b,c
v_mfma_f32_16x16x32_bf16 v[\d:\d+3], a[\a:\a+3], v[\b:\b+3], v[\c:\c+3]
.endm
.macro Mvva d,a,b
v_mfma_f32_16x16x32_bf16 v[\d:\d+3], v[\a:\a+3], a[\b:\b+3], v[\d:\d+3]
.endm
.macro Zvva d,a,b
v_mfma_f32_16x16x32_bf16 v[\d:\d+3], v[\a:\a+3], a[\b:\b+3], 0
.endm
.macro Cvva d,a,b,c
v_mfma_f32_16x16x32_bf16 v[\d:\d+3], v[\a:\a+3], a[\b:\b+3], v[\c:\c+3]
.endm
.macro Mvvv d,a,b
v_mfma_f32_16x16x32_bf16 v[\d:\d+3], v[\a:\a+3], v[\b:\b+3], v[\d:\d+3]
.endm
.macro Zvvv d,a,b
v_mfma_f32_16x16x32_bf16 v[\d:\d+3], v[\a:\a+3], v[\b:\b+3], 0
.endm
.macro Cvvv d,a,b,c
v_mfma_f32_16x16x32_bf16 v[\d:\d+3], v[\a:\a+3], v[\b:\b+3], v[\c:\c+3]
.endm
.macro TR r,b,o
ds_read_b64_tr_b16 v[\r:\r+1], v\b offset:\o
.endm
.macro RQ r,b,o
ds_read_b128 v[\r:\r+3], v\b offset:\o
.endm
.macro WL n
s_waitcnt lgkmcnt(\n)
.endm
.macro EX r
v_exp_f32 v\r, v\r
.endm
.macro RC r
v_rcp_f32 v\r, v\r
.endm
.macro CV d,a,b
v_cvt_pk_bf16_f32 v\d, v\a, v\b
.endm
.macro AR d,a
v_accvgpr_read_b32 v\d, a\a
.endm
.macro AW d,a
v_accvgpr_write_b32 a\d, v\a
.endm
.macro PM d,a,b
v_pk_mul_f32 v[\d:\d+1], v[\a:\a+1], v[\b:\b+1]
.endm
.macro PA d,a,b
v_pk_add_f32 v[\d:\d+1], v[\a:\a+1], v[\b:\b+1]
.endm
.macro PF d,a,b,c
v_pk_fma_f32 v[\d:\d+1], v[\a:\a+1], v[\b:\b+1], v[\c:\c+1]
.endm
.macro DM v,s,f,o
buffer_load_dwordx4 v\v, s[\s:\s+3], s\f offen offset:\o lds
.endm
.macro LV d,v,s,f,o
buffer_load_dwordx4 v[\d:\d+3], v\v, s[\s:\s+3], s\f offen offset:\o
.endm
.macro LA d,v,s,f,o
buffer_load_dwordx4 a[\d:\d+3], v\v, s[\s:\s+3], s\f offen offset:\o
.endm
.text
.globl m1_kernel
.p2align 8
.type m1_kernel,@function
m1_kernel:
s_cmp_lt_u32 s2, 256
s_cbranch_scc1 M1_go
s_endpgm
M1_go:
s_getpc_b64 s[100:101]
M1_pc:
s_load_dwordx2 s[80:81], s[0:1], 0
s_load_dwordx2 s[4:5], s[0:1], 96
s_load_dwordx2 s[82:83], s[0:1], 88
v_and_b32 v1, 63, v0
v_lshrrev_b32 v2, 6, v0
s_nop 0
v_readfirstlane_b32 s3, v2
s_nop 0
s_cmp_lg_u32 s3, 3
s_cbranch_scc1 M1_nt
s_lshr_b32 s36, s2, 3
s_lshl_b32 s36, s36, 13
v_lshlrev_b32 v196, 7, v1
v_add_u32 v196, s36, v196
v_add_u32 v196, M1_pc-M1_pc, v196
v_min_u32 v196, M1_last-M1_pc, v196
v_add_co_u32 v196, vcc, s100, v196
v_mov_b32 v197, s101
s_nop 0
v_addc_co_u32 v197, vcc, 0, v197, vcc
global_load_dword v199, v[196:197], off
M1_nt:
s_and_b32 s35, s2, 127
s_cmp_ge_u32 s2, 128
s_cbranch_scc1 M1_b
s_load_dwordx2 s[6:7], s[0:1], 24
s_load_dwordx2 s[48:49], s[0:1], 8
s_load_dwordx2 s[50:51], s[0:1], 16
s_load_dwordx2 s[52:53], s[0:1], 32
s_load_dwordx2 s[54:55], s[0:1], 72
s_load_dwordx2 s[96:97], s[0:1], 56
s_load_dwordx2 s[98:99], s[0:1], 64
v_lshrrev_b32 v146, 3, v1
s_lshl_b32 s36, s2, 3
v_add_u32 v147, s36, v146
v_lshlrev_b32 v148, 11, v147
v_and_b32 v150, 7, v1
v_lshl_add_u32 v149, v150, 4, v148
s_lshl_b32 s36, s3, 9
s_lshl_b32 s37, s3, 4
s_add_u32 s37, s37, s2
WL 0
s_mov_b32 s84, s80
s_mov_b32 s85, s81
s_mov_b32 s86, 4194304
s_mov_b32 s87, 0x20000
s_add_u32 s44, s4, 21495808
s_addc_u32 s45, s5, 0
s_mov_b32 s46, 32768
s_mov_b32 s47, 0x20000
s_mov_b32 s88, s82
s_mov_b32 s89, s83
s_mov_b32 s90, 256
s_mov_b32 s91, 0x20000
s_cmp_lt_u32 s37, 16
s_cbranch_scc1 A1_l_z
LV 128,149,84,36,0
LV 132,149,84,36,128
LV 136,149,84,36,256
LV 140,149,84,36,384
buffer_load_ushort v144, v148, s[84:87], 0 offen
s_branch A1_l_zd
A1_l_z:
v_mov_b32 v152, 0
v_mov_b32 v153, 0
v_mov_b32 v154, 0
v_mov_b32 v155, 0
v_lshlrev_b32 v156, 4, v1
s_lshl_b32 s37, s2, 11
v_and_b32 v157, 1, v1
v_lshlrev_b32 v157, 7, v157
buffer_store_dwordx4 v[152:155], v156, s[44:47], s37 offen sc1
buffer_store_dwordx4 v[152:155], v156, s[44:47], s37 offen offset:1024 sc1
LV 128,149,84,36,0
LV 132,149,84,36,128
LV 136,149,84,36,256
LV 140,149,84,36,384
buffer_load_ushort v144, v148, s[84:87], 0 offen
buffer_load_dword v159, v157, s[88:91], 0 offen sc1
v_lshlrev_b32 v156, 6, v1
v_mov_b32 v157, 1
s_waitcnt vmcnt(6)
s_mov_b64 exec, 15
buffer_store_byte v157, v156, s[88:91], s2 offen sc1
s_mov_b64 exec, -1
A1_l_zd:
s_and_b32 s36, s35, 7
s_lshr_b32 s38, s35, 3
s_lshr_b32 s37, s36, 1
s_lshl_b32 s34, s37, 2
s_and_b32 s33, s38, 3
s_add_u32 s34, s34, s33
s_and_b32 s33, s36, 1
s_lshl_b32 s33, s33, 2
s_lshr_b32 s38, s38, 2
s_add_u32 s33, s33, s38
s_mov_b32 s8, s4
s_mov_b32 s9, s5
s_mov_b32 s10, 4194304
s_mov_b32 s11, 0x20000
s_mov_b32 s12, s6
s_mov_b32 s13, s7
s_mov_b32 s14, 8388608
s_mov_b32 s15, 0x20000
s_add_u32 s16, s4, 41943040
s_addc_u32 s17, s5, 0
s_mov_b32 s18, 16777216
s_mov_b32 s19, 0x20000
s_lshl_b32 s37, s37, 19
s_add_u32 s37, s37, 0x60000
s_add_u32 s20, s48, s37
s_addc_u32 s21, s49, 0
s_mov_b32 s22, 0x20000
s_mov_b32 s23, 0x20000
s_add_u32 s28, s50, s37
s_addc_u32 s29, s51, 0
s_mov_b32 s30, 0x20000
s_mov_b32 s31, 0x20000
s_add_u32 s68, s6, 4194304
s_addc_u32 s69, s7, 0
s_add_u32 s70, s96, 1048576
s_addc_u32 s71, s97, 0
s_add_u32 s74, s6, 5242880
s_addc_u32 s75, s7, 0
v_lshrrev_b32 v2, 4, v1
s_lshl_b32 s36, s3, 4
v_add_u32 v3, s36, v2
v_mul_u32_u24 v3, 8192, v3
v_and_b32 v4, 15, v1
v_add_u32 v5, 0, v2
v_lshlrev_b32 v5, 1, v5
v_xor_b32 v5, v5, v4
v_lshl_add_u32 v5, v5, 4, v3
v_add_u32 v24, 0, v5
v_add_u32 v5, 4, v2
v_lshlrev_b32 v5, 1, v5
v_xor_b32 v5, v5, v4
v_lshl_add_u32 v5, v5, 4, v3
v_add_u32 v25, 31744, v5
v_add_u32 v5, 0, v2
v_lshlrev_b32 v5, 1, v5
v_xor_b32 v5, v5, v4
v_lshl_add_u32 v5, v5, 4, v3
v_add_u32 v26, 63488, v5
v_add_u32 v5, 4, v2
v_lshlrev_b32 v5, 1, v5
v_xor_b32 v5, v5, v4
v_lshl_add_u32 v5, v5, 4, v3
v_add_u32 v27, 95232, v5
s_mul_i32 s25, s34, 512
s_lshl_b32 s27, s3, 12
s_add_u32 s26, s25, 256
s_lshl_b32 s36, s3, 6
v_add_u32 v70, s36, v1
v_lshrrev_b32 v70, 2, v70
v_lshlrev_b32 v70, 7, v70
s_lshl_b32 s36, s35, 13
v_add_u32 v70, s36, v70
s_add_u32 s92, s6, 1048576
s_addc_u32 s93, s7, 0
s_mov_b32 s94, 1048576
s_mov_b32 s95, 0x20000
s_mov_b32 s63, 0
s_add_u32 m0, s27, 0
s_nop 0
DM 24,12,25,0
DM 25,12,25,1024
DM 26,12,25,2048
DM 27,12,25,3072
s_add_u32 s25, s25, 524288
s_add_u32 m0, s27, 65536
s_nop 0
DM 24,12,26,0
DM 25,12,26,1024
DM 26,12,26,2048
DM 27,12,26,3072
s_add_u32 s26, s26, 524288
s_add_u32 m0, s27, 16384
s_nop 0
DM 24,12,25,0
DM 25,12,25,1024
DM 26,12,25,2048
DM 27,12,25,3072
s_add_u32 s25, s25, 524288
s_add_u32 m0, s27, 81920
s_nop 0
DM 24,12,26,0
DM 25,12,26,1024
DM 26,12,26,2048
DM 27,12,26,3072
s_add_u32 s26, s26, 524288
buffer_load_dword v7, v70, s[92:95], 0 offen
s_add_u32 s92, s92, 0x100000
s_addc_u32 s93, s93, 0
s_add_u32 s63, s63, 1
s_mov_b32 s84, s4
s_mov_b32 s85, s5
s_mov_b32 s86, 4194304
s_mov_b32 s87, 0x20000
s_lshl_b32 s36, s3, 12
s_add_u32 s36, s36, 0x21000
v_lshrrev_b32 v156, 2, v150
v_lshlrev_b32 v156, 9, v156
v_and_b32 v157, 1, v150
v_lshl_add_u32 v156, v157, 8, v156
v_bfe_u32 v157, v150, 1, 1
v_lshl_add_u32 v156, v157, 3, v156
v_lshl_add_u32 v156, v146, 4, v156
v_add_u32 v156, s36, v156
v_lshlrev_b32 v157, 4, v1
v_add_u32 v157, s36, v157
v_bfe_u32 v151, v1, 3, 2
v_lshlrev_b32 v151, 4, v151
v_and_b32 v196, 7, v1
s_and_b32 s36, s2, 1
s_lshl_b32 s36, s36, 3
v_add3_u32 v151, v151, s36, v196
v_lshlrev_b32 v151, 4, v151
v_lshrrev_b32 v196, 5, v1
v_lshl_add_u32 v151, v196, 10, v151
s_lshr_b32 s37, s2, 1
s_lshl_b32 s37, s37, 15
s_lshl_b32 s36, s3, 13
s_add_u32 s37, s37, s36
s_add_u32 s38, s37, 4096
v_lshlrev_b32 v147, 2, v1
v_mov_b32 v152, 0
v_mov_b32 v153, 0
v_mov_b32 v154, 0
v_mov_b32 v155, 0
s_and_b32 s36, s2, 3
s_lshl_b32 s36, s36, 6
v_mov_b32 v158, s36
s_lshl_b32 s36, s3, 4
s_add_u32 s36, s36, s2
s_cmp_lt_u32 s36, 16
s_cbranch_scc1 LN_zw
s_waitcnt vmcnt(17)
LN_zw:
s_waitcnt vmcnt(18)
v_lshlrev_b32 v144, 16, v144
v_mov_b32 v145, v144
v_lshlrev_b32 v160, 16, v128
v_and_b32 v161, 0xffff0000, v128
v_lshlrev_b32 v162, 16, v129
v_and_b32 v163, 0xffff0000, v129
v_lshlrev_b32 v164, 16, v130
v_and_b32 v165, 0xffff0000, v130
v_lshlrev_b32 v166, 16, v131
v_and_b32 v167, 0xffff0000, v131
v_lshlrev_b32 v168, 16, v132
v_and_b32 v169, 0xffff0000, v132
v_lshlrev_b32 v170, 16, v133
v_and_b32 v171, 0xffff0000, v133
v_lshlrev_b32 v172, 16, v134
v_and_b32 v173, 0xffff0000, v134
v_lshlrev_b32 v174, 16, v135
v_and_b32 v175, 0xffff0000, v135
v_lshlrev_b32 v176, 16, v136
v_and_b32 v177, 0xffff0000, v136
v_lshlrev_b32 v178, 16, v137
v_and_b32 v179, 0xffff0000, v137
v_lshlrev_b32 v180, 16, v138
v_and_b32 v181, 0xffff0000, v138
v_lshlrev_b32 v182, 16, v139
v_and_b32 v183, 0xffff0000, v139
v_lshlrev_b32 v184, 16, v140
v_and_b32 v185, 0xffff0000, v140
v_lshlrev_b32 v186, 16, v141
v_and_b32 v187, 0xffff0000, v141
v_lshlrev_b32 v188, 16, v142
v_and_b32 v189, 0xffff0000, v142
v_lshlrev_b32 v190, 16, v143
v_and_b32 v191, 0xffff0000, v143
v_pk_add_f32 v[160:161], v[160:161], v[144:145] neg_lo:[0,1] neg_hi:[0,1]
v_pk_add_f32 v[162:163], v[162:163], v[144:145] neg_lo:[0,1] neg_hi:[0,1]
v_pk_add_f32 v[164:165], v[164:165], v[144:145] neg_lo:[0,1] neg_hi:[0,1]
v_pk_add_f32 v[166:167], v[166:167], v[144:145] neg_lo:[0,1] neg_hi:[0,1]
v_pk_add_f32 v[168:169], v[168:169], v[144:145] neg_lo:[0,1] neg_hi:[0,1]
v_pk_add_f32 v[170:171], v[170:171], v[144:145] neg_lo:[0,1] neg_hi:[0,1]
v_pk_add_f32 v[172:173], v[172:173], v[144:145] neg_lo:[0,1] neg_hi:[0,1]
v_pk_add_f32 v[174:175], v[174:175], v[144:145] neg_lo:[0,1] neg_hi:[0,1]
v_pk_add_f32 v[176:177], v[176:177], v[144:145] neg_lo:[0,1] neg_hi:[0,1]
v_pk_add_f32 v[178:179], v[178:179], v[144:145] neg_lo:[0,1] neg_hi:[0,1]
v_pk_add_f32 v[180:181], v[180:181], v[144:145] neg_lo:[0,1] neg_hi:[0,1]
v_pk_add_f32 v[182:183], v[182:183], v[144:145] neg_lo:[0,1] neg_hi:[0,1]
v_pk_add_f32 v[184:185], v[184:185], v[144:145] neg_lo:[0,1] neg_hi:[0,1]
v_pk_add_f32 v[186:187], v[186:187], v[144:145] neg_lo:[0,1] neg_hi:[0,1]
v_pk_add_f32 v[188:189], v[188:189], v[144:145] neg_lo:[0,1] neg_hi:[0,1]
v_pk_add_f32 v[190:191], v[190:191], v[144:145] neg_lo:[0,1] neg_hi:[0,1]
PA 152,152,160
PF 154,160,160,154
PA 152,152,162
PF 154,162,162,154
PA 152,152,164
PF 154,164,164,154
PA 152,152,166
PF 154,166,166,154
PA 152,152,168
PF 154,168,168,154
PA 152,152,170
PF 154,170,170,154
PA 152,152,172
PF 154,172,172,154
PA 152,152,174
PF 154,174,174,154
PA 152,152,176
PF 154,176,176,154
PA 152,152,178
PF 154,178,178,154
PA 152,152,180
PF 154,180,180,154
PA 152,152,182
PF 154,182,182,154
PA 152,152,184
PF 154,184,184,154
PA 152,152,186
PF 154,186,186,154
PA 152,152,188
PF 154,188,188,154
PA 152,152,190
PF 154,190,190,154
v_add_f32 v152, v152, v153
v_add_f32 v153, v154, v155
s_nop 0
v_add_f32 v152, v152, v152 quad_perm:[1,0,3,2] row_mask:0xf bank_mask:0xf
v_add_f32 v153, v153, v153 quad_perm:[1,0,3,2] row_mask:0xf bank_mask:0xf
s_nop 0
v_add_f32 v152, v152, v152 quad_perm:[2,3,0,1] row_mask:0xf bank_mask:0xf
v_add_f32 v153, v153, v153 quad_perm:[2,3,0,1] row_mask:0xf bank_mask:0xf
s_nop 0
v_add_f32 v152, v152, v152 row_half_mirror row_mask:0xf bank_mask:0xf
v_add_f32 v153, v153, v153 row_half_mirror row_mask:0xf bank_mask:0xf
s_lshl_b32 s36, s3, 3
v_lshlrev_b32 v154, 5, v146
v_add_u32 v154, 0x20100, v154
v_add_u32 v155, s36, v154
ds_write_b64 v155, v[152:153]
WL 0
s_barrier
ds_read_b128 v[128:131], v154
RQ 132,154,16
WL 0
PA 128,128,130
PA 128,128,132
PA 128,128,134
v_mul_f32 v128, 0x3a800000, v128
v_mul_f32 v129, 0x3a800000, v129
v_fma_f32 v129, -v128, v128, v129
v_max_f32 v129, 0, v129
v_add_f32 v130, 0x3727c5ac, v129
v_rsq_f32 v130, v130
s_nop 0
v_mul_f32 v132, v130, v130
v_mul_f32 v132, v132, v129
v_add_f32 v132, 0x3727c5ac, v132
v_rsq_f32 v132, v132
v_mul_f32 v130, 0x3e0293ee, v130
v_mul_f32 v132, 0x40faf233, v132
v_mov_b32 v129, v128
v_mov_b32 v131, v130
v_pk_add_f32 v[160:161], v[160:161], v[128:129] neg_lo:[0,1] neg_hi:[0,1]
v_pk_add_f32 v[162:163], v[162:163], v[128:129] neg_lo:[0,1] neg_hi:[0,1]
v_pk_add_f32 v[164:165], v[164:165], v[128:129] neg_lo:[0,1] neg_hi:[0,1]
v_pk_add_f32 v[166:167], v[166:167], v[128:129] neg_lo:[0,1] neg_hi:[0,1]
PM 160,160,130
PM 162,162,130
PM 164,164,130
PM 166,166,130
CV 136,160,161
CV 137,162,163
CV 138,164,165
CV 139,166,167
ds_write_b64 v156, v[136:137] offset:0
ds_write_b64 v156, v[138:139] offset:128
v_pk_add_f32 v[168:169], v[168:169], v[128:129] neg_lo:[0,1] neg_hi:[0,1]
v_pk_add_f32 v[170:171], v[170:171], v[128:129] neg_lo:[0,1] neg_hi:[0,1]
v_pk_add_f32 v[172:173], v[172:173], v[128:129] neg_lo:[0,1] neg_hi:[0,1]
v_pk_add_f32 v[174:175], v[174:175], v[128:129] neg_lo:[0,1] neg_hi:[0,1]
PM 168,168,130
PM 170,170,130
PM 172,172,130
PM 174,174,130
CV 140,168,169
CV 141,170,171
CV 142,172,173
CV 143,174,175
ds_write_b64 v156, v[140:141] offset:1024
ds_write_b64 v156, v[142:143] offset:1152
v_pk_add_f32 v[176:177], v[176:177], v[128:129] neg_lo:[0,1] neg_hi:[0,1]
v_pk_add_f32 v[178:179], v[178:179], v[128:129] neg_lo:[0,1] neg_hi:[0,1]
v_pk_add_f32 v[180:181], v[180:181], v[128:129] neg_lo:[0,1] neg_hi:[0,1]
v_pk_add_f32 v[182:183], v[182:183], v[128:129] neg_lo:[0,1] neg_hi:[0,1]
PM 176,176,130
PM 178,178,130
PM 180,180,130
PM 182,182,130
CV 136,176,177
CV 137,178,179
CV 138,180,181
CV 139,182,183
ds_write_b64 v156, v[136:137] offset:2048
ds_write_b64 v156, v[138:139] offset:2176
v_pk_add_f32 v[184:185], v[184:185], v[128:129] neg_lo:[0,1] neg_hi:[0,1]
v_pk_add_f32 v[186:187], v[186:187], v[128:129] neg_lo:[0,1] neg_hi:[0,1]
v_pk_add_f32 v[188:189], v[188:189], v[128:129] neg_lo:[0,1] neg_hi:[0,1]
v_pk_add_f32 v[190:191], v[190:191], v[128:129] neg_lo:[0,1] neg_hi:[0,1]
PM 184,184,130
PM 186,186,130
PM 188,188,130
PM 190,190,130
CV 140,184,185
CV 141,186,187
CV 142,188,189
CV 143,190,191
ds_write_b64 v156, v[140:141] offset:3072
ds_write_b64 v156, v[142:143] offset:3200
WL 0
RQ 160,157,0
RQ 164,157,1024
RQ 168,157,2048
RQ 172,157,3072
WL 3
buffer_store_dwordx4 v[160:163], v151, s[84:87], s37 offen offset:0 sc1
WL 2
buffer_store_dwordx4 v[164:167], v151, s[84:87], s37 offen offset:2048 sc1
WL 1
buffer_store_dwordx4 v[168:171], v151, s[84:87], s38 offen offset:0 sc1
WL 0
buffer_store_dwordx4 v[172:175], v151, s[84:87], s38 offen offset:2048 sc1
s_lshl_b32 s36, s3, 24
s_lshl_b32 s37, s2, 8
s_add_u32 s36, s36, s37
s_add_u32 s8, s4, 21364736
s_addc_u32 s9, s5, 0
s_mov_b32 s10, 65536
s_mov_b32 s11, 0x20000
buffer_store_dword v132, v147, s[8:11], s36 offen sc1
s_mov_b32 s8, s4
s_mov_b32 s9, s5
s_mov_b32 s10, 4194304
s_mov_b32 s11, 0x20000
s_cmp_lg_u32 s3, 0
s_cbranch_scc1 LN_nz16
buffer_load_dwordx4 v[192:195], v158, s[88:91], 0 offen sc1
LN_nz16:
s_cmp_eq_u32 s3, 0
s_cbranch_scc1 A1_ln_w0
s_waitcnt vmcnt(0)
s_barrier
s_branch A1_ln_b
A1_ln_w0:
s_mov_b32 s36, 0x01010101
s_waitcnt vmcnt(0)
s_barrier
A1_ln_zc:
v_and_b32 v192, v192, v193
v_and_b32 v194, v194, v195
v_and_b32 v192, v192, v194
v_cmp_ne_u32 vcc, s36, v192
s_nop 1
s_cbranch_vccz A1_ln_zo
buffer_load_dwordx4 v[192:195], v158, s[88:91], 0 offen sc1
s_waitcnt vmcnt(0)
s_branch A1_ln_zc
A1_ln_zo:
s_lshr_b32 s36, s2, 4
s_lshl_b32 s36, s36, 7
s_add_u32 s36, s36, 22528
v_mov_b32 v152, 0
v_mov_b32 v153, 1
s_mov_b64 exec, 1
buffer_atomic_add v153, v152, s[44:47], s36 offen sc1
s_mov_b64 exec, -1
v_and_b32 v152, 1, v1
v_lshlrev_b32 v152, 7, v152
s_lshl_b32 s36, s33, 8
v_add_u32 v152, s36, v152
s_mov_b32 s36, 22528
s_sleep 16
A1_ln_p:
s_sleep 8
buffer_load_dword v153, v152, s[44:47], s36 offen sc1
s_waitcnt vmcnt(0)
v_cmp_ne_u32 vcc, 16, v153
s_nop 1
s_cbranch_vccnz A1_ln_p
A1_ln_b:
s_barrier
s_lshl_b32 s39, s33, 4
s_lshl_b32 s36, s3, 2
s_add_u32 s39, s39, s36
s_lshl_b32 s24, s39, 15
v_lshlrev_b32 v28, 4, v1
v_add_u32 v29, 32768, v28
v_add_u32 v30, 65536, v28
v_add_u32 v31, 98304, v28
buffer_load_dwordx4 a[0:3], v28, s[8:11], s24 offen offset:0 sc1
buffer_load_dwordx4 a[4:7], v28, s[8:11], s24 offen offset:1024 sc1
buffer_load_dwordx4 a[8:11], v29, s[8:11], s24 offen offset:0 sc1
buffer_load_dwordx4 a[12:15], v29, s[8:11], s24 offen offset:1024 sc1
buffer_load_dwordx4 a[16:19], v30, s[8:11], s24 offen offset:0 sc1
buffer_load_dwordx4 a[20:23], v30, s[8:11], s24 offen offset:1024 sc1
buffer_load_dwordx4 a[24:27], v31, s[8:11], s24 offen offset:0 sc1
buffer_load_dwordx4 a[28:31], v31, s[8:11], s24 offen offset:1024 sc1
s_add_u32 s24, s24, 2048
buffer_load_dwordx4 a[32:35], v28, s[8:11], s24 offen offset:0 sc1
buffer_load_dwordx4 a[36:39], v28, s[8:11], s24 offen offset:1024 sc1
buffer_load_dwordx4 a[40:43], v29, s[8:11], s24 offen offset:0 sc1
buffer_load_dwordx4 a[44:47], v29, s[8:11], s24 offen offset:1024 sc1
buffer_load_dwordx4 a[48:51], v30, s[8:11], s24 offen offset:0 sc1
buffer_load_dwordx4 a[52:55], v30, s[8:11], s24 offen offset:1024 sc1
buffer_load_dwordx4 a[56:59], v31, s[8:11], s24 offen offset:0 sc1
buffer_load_dwordx4 a[60:63], v31, s[8:11], s24 offen offset:1024 sc1
s_add_u32 s24, s24, 2048
s_add_u32 s84, s4, 21495808
s_addc_u32 s85, s5, 0
s_mov_b32 s86, 32768
s_mov_b32 s87, 0x20000
s_lshl_b32 s48, s33, 7
s_add_u32 s49, s48, 25600
s_add_u32 s48, s48, 24576
s_and_b32 s50, s35, 6
s_lshr_b32 s36, s35, 6
s_add_u32 s50, s50, s36
s_lshl_b32 s50, s50, 1
s_and_b32 s36, s35, 1
s_add_u32 s50, s50, s36
s_lshl_b32 s50, s50, 7
s_add_u32 s51, s50, 30720
s_add_u32 s50, s50, 26624
v_lshrrev_b32 v2, 4, v1
v_and_b32 v3, 15, v1
v_lshlrev_b32 v4, 8, v2
v_add_u32 v4, s27, v4
s_mov_b32 s41, 0
s_mov_b32 s42, 0
v_add_u32 v5, 0, v2
v_xor_b32 v5, v5, v3
v_lshl_add_u32 v64, v5, 4, v4
v_add_u32 v5, 4, v2
v_xor_b32 v5, v5, v3
v_lshl_add_u32 v65, v5, 4, v4
v_add_u32 v5, 8, v2
v_xor_b32 v5, v5, v3
v_lshl_add_u32 v66, v5, 4, v4
v_add_u32 v5, 12, v2
v_xor_b32 v5, v5, v3
v_lshl_add_u32 v67, v5, 4, v4
v_add_u32 v5, 0, v2
v_lshlrev_b32 v5, 1, v5
v_xor_b32 v5, v5, v3
v_lshl_add_u32 v68, v5, 4, v4
v_add_u32 v5, 4, v2
v_lshlrev_b32 v5, 1, v5
v_xor_b32 v5, v5, v3
v_lshl_add_u32 v69, v5, 4, v4
v_lshrrev_b32 v2, 2, v1
v_and_b32 v3, 7, v2
v_lshlrev_b32 v2, 8, v2
v_and_b32 v4, 3, v1
v_lshl_add_u32 v2, v4, 3, v2
v_xor_b32 v4, 0, v3
v_lshl_add_u32 v8, v4, 5, v2
v_add_u32 v16, 0x10000, v8
v_xor_b32 v4, 1, v3
v_lshl_add_u32 v9, v4, 5, v2
v_add_u32 v17, 0x10000, v9
v_xor_b32 v4, 2, v3
v_lshl_add_u32 v10, v4, 5, v2
v_add_u32 v18, 0x10000, v10
v_xor_b32 v4, 3, v3
v_lshl_add_u32 v11, v4, 5, v2
v_add_u32 v19, 0x10000, v11
v_xor_b32 v4, 4, v3
v_lshl_add_u32 v12, v4, 5, v2
v_add_u32 v20, 0x10000, v12
v_xor_b32 v4, 5, v3
v_lshl_add_u32 v13, v4, 5, v2
v_add_u32 v21, 0x10000, v13
v_xor_b32 v4, 6, v3
v_lshl_add_u32 v14, v4, 5, v2
v_add_u32 v22, 0x10000, v14
v_xor_b32 v4, 7, v3
v_lshl_add_u32 v15, v4, 5, v2
v_add_u32 v23, 0x10000, v15
s_waitcnt vmcnt(8)
s_barrier
TR 32,8,0
TR 34,8,4096
TR 36,8,8192
TR 38,8,12288
TR 40,9,0
TR 42,9,4096
TR 44,9,8192
TR 46,9,12288
TR 48,10,0
TR 50,10,4096
TR 52,10,8192
TR 54,10,12288
WL 8
Zvva 128,32,0
TR 56,11,0
Mvva 128,36,4
s_add_u32 m0, s27, 32768
Zvva 132,32,8
TR 58,11,4096
Mvva 132,36,12
DM 24,12,25,0
Zvva 136,32,16
TR 60,11,8192
Mvva 136,36,20
Zvva 140,32,24
TR 62,11,12288
Mvva 140,36,28
WL 8
Zvva 144,40,0
TR 32,12,0
Mvva 144,44,4
DM 25,12,25,1024
Zvva 148,40,8
TR 34,12,4096
Mvva 148,44,12
DM 26,12,25,2048
Zvva 152,40,16
TR 36,12,8192
Mvva 152,44,20
Zvva 156,40,24
TR 38,12,12288
Mvva 156,44,28
WL 8
Zvva 160,48,0
TR 40,13,0
Mvva 160,52,4
DM 27,12,25,3072
Zvva 164,48,8
TR 42,13,4096
Mvva 164,52,12
Zvva 168,48,16
TR 44,13,8192
Mvva 168,52,20
s_add_u32 s25, s25, 524288
Zvva 172,48,24
TR 46,13,12288
Mvva 172,52,28
WL 8
Zvva 176,56,0
TR 48,14,0
Mvva 176,60,4
s_add_u32 m0, s27, 98304
Zvva 180,56,8
TR 50,14,4096
Mvva 180,60,12
Zvva 184,56,16
TR 52,14,8192
Mvva 184,60,20
DM 24,12,26,0
Zvva 188,56,24
TR 54,14,12288
Mvva 188,60,28
WL 8
Zvva 192,32,0
TR 56,15,0
Mvva 192,36,4
Zvva 196,32,8
TR 58,15,4096
Mvva 196,36,12
DM 25,12,26,1024
Zvva 200,32,16
TR 60,15,8192
Mvva 200,36,20
DM 26,12,26,2048
Zvva 204,32,24
TR 62,15,12288
Mvva 204,36,28
WL 8
Zvva 208,40,0
TR 32,16,0
Mvva 208,44,4
Zvva 212,40,8
TR 34,16,4096
Mvva 212,44,12
DM 27,12,26,3072
Zvva 216,40,16
TR 36,16,8192
Mvva 216,44,20
s_add_u32 s26, s26, 524288
Zvva 220,40,24
TR 38,16,12288
Mvva 220,44,28
WL 8
Zvva 224,48,0
TR 40,17,0
Mvva 224,52,4
Zvva 228,48,8
TR 42,17,4096
Mvva 228,52,12
buffer_load_dwordx4 a[64:67], v28, s[8:11], s24 offen offset:0 sc1
Zvva 232,48,16
TR 44,17,8192
Mvva 232,52,20
Zvva 236,48,24
TR 46,17,12288
Mvva 236,52,28
WL 8
Zvva 240,56,0
TR 48,18,0
Mvva 240,60,4
buffer_load_dwordx4 a[68:71], v28, s[8:11], s24 offen offset:1024 sc1
Zvva 244,56,8
TR 50,18,4096
Mvva 244,60,12
buffer_load_dwordx4 a[72:75], v29, s[8:11], s24 offen offset:0 sc1
Zvva 248,56,16
TR 52,18,8192
Mvva 248,60,20
Zvva 252,56,24
TR 54,18,12288
Mvva 252,60,28
WL 8
Zava 128,32,0
TR 56,19,0
Mava 128,36,4
buffer_load_dwordx4 a[76:79], v29, s[8:11], s24 offen offset:1024 sc1
Zava 132,32,8
TR 58,19,4096
Mava 132,36,12
Zava 136,32,16
TR 60,19,8192
Mava 136,36,20
buffer_load_dwordx4 a[80:83], v30, s[8:11], s24 offen offset:0 sc1
Zava 140,32,24
TR 62,19,12288
Mava 140,36,28
WL 8
Zava 144,40,0
TR 32,20,0
Mava 144,44,4
buffer_load_dwordx4 a[84:87], v30, s[8:11], s24 offen offset:1024 sc1
Zava 148,40,8
TR 34,20,4096
Mava 148,44,12
Zava 152,40,16
TR 36,20,8192
Mava 152,44,20
buffer_load_dwordx4 a[88:91], v31, s[8:11], s24 offen offset:0 sc1
Zava 156,40,24
TR 38,20,12288
Mava 156,44,28
WL 8
Zava 160,48,0
TR 40,21,0
Mava 160,52,4
buffer_load_dwordx4 a[92:95], v31, s[8:11], s24 offen offset:1024 sc1
Zava 164,48,8
TR 42,21,4096
Mava 164,52,12
Zava 168,48,16
TR 44,21,8192
Mava 168,52,20
s_add_u32 s24, s24, 2048
Zava 172,48,24
TR 46,21,12288
Mava 172,52,28
WL 8
Zava 176,56,0
TR 48,22,0
Mava 176,60,4
Zava 180,56,8
TR 50,22,4096
Mava 180,60,12
buffer_load_dword v7, v70, s[92:95], 0 offen
Zava 184,56,16
TR 52,22,8192
Mava 184,60,20
s_add_u32 s92, s92, 0x100000
s_addc_u32 s93, s93, 0
Zava 188,56,24
TR 54,22,12288
Mava 188,60,28
WL 8
Zava 192,32,0
TR 56,23,0
Mava 192,36,4
Zava 196,32,8
TR 58,23,4096
Mava 196,36,12
s_add_u32 s63, s63, 1
Zava 200,32,16
TR 60,23,8192
Mava 200,36,20
Zava 204,32,24
TR 62,23,12288
Mava 204,36,28
WL 8
s_waitcnt vmcnt(17)
s_barrier
Zava 208,40,0
TR 32,8,16384
Mava 208,44,4
s_add_u32 m0, s27, 49152
Zava 212,40,8
TR 34,8,20480
Mava 212,44,12
DM 24,12,25,0
Zava 216,40,16
TR 36,8,24576
Mava 216,44,20
Zava 220,40,24
TR 38,8,28672
Mava 220,44,28
WL 8
Zava 224,48,0
TR 40,9,16384
Mava 224,52,4
DM 25,12,25,1024
Zava 228,48,8
TR 42,9,20480
Mava 228,52,12
Zava 232,48,16
TR 44,9,24576
Mava 232,52,20
DM 26,12,25,2048
Zava 236,48,24
TR 46,9,28672
Mava 236,52,28
WL 8
Zava 240,56,0
TR 48,10,16384
Mava 240,60,4
Zava 244,56,8
TR 50,10,20480
Mava 244,60,12
DM 27,12,25,3072
Zava 248,56,16
TR 52,10,24576
Mava 248,60,20
Zava 252,56,24
TR 54,10,28672
Mava 252,60,28
WL 8
Mvva 128,32,32
TR 56,11,16384
Mvva 128,36,36
s_add_u32 s25, s25, 524288
Mvva 132,32,40
TR 58,11,20480
Mvva 132,36,44
Mvva 136,32,48
TR 60,11,24576
Mvva 136,36,52
s_add_u32 m0, s27, 114688
Mvva 140,32,56
TR 62,11,28672
Mvva 140,36,60
WL 8
Mvva 144,40,32
TR 32,12,16384
Mvva 144,44,36
Mvva 148,40,40
TR 34,12,20480
Mvva 148,44,44
DM 24,12,26,0
Mvva 152,40,48
TR 36,12,24576
Mvva 152,44,52
Mvva 156,40,56
TR 38,12,28672
Mvva 156,44,60
WL 8
Mvva 160,48,32
TR 40,13,16384
Mvva 160,52,36
DM 25,12,26,1024
Mvva 164,48,40
TR 42,13,20480
Mvva 164,52,44
Mvva 168,48,48
TR 44,13,24576
Mvva 168,52,52
DM 26,12,26,2048
Mvva 172,48,56
TR 46,13,28672
Mvva 172,52,60
WL 8
Mvva 176,56,32
TR 48,14,16384
Mvva 176,60,36
Mvva 180,56,40
TR 50,14,20480
Mvva 180,60,44
DM 27,12,26,3072
Mvva 184,56,48
TR 52,14,24576
Mvva 184,60,52
Mvva 188,56,56
TR 54,14,28672
Mvva 188,60,60
WL 8
Mvva 192,32,32
TR 56,15,16384
Mvva 192,36,36
s_add_u32 s26, s26, 524288
Mvva 196,32,40
TR 58,15,20480
Mvva 196,36,44
Mvva 200,32,48
TR 60,15,24576
Mvva 200,36,52
buffer_load_dwordx4 a[96:99], v28, s[8:11], s24 offen offset:0 sc1
Mvva 204,32,56
TR 62,15,28672
Mvva 204,36,60
WL 8
Mvva 208,40,32
TR 32,16,16384
Mvva 208,44,36
buffer_load_dwordx4 a[100:103], v28, s[8:11], s24 offen offset:1024 sc1
Mvva 212,40,40
TR 34,16,20480
Mvva 212,44,44
Mvva 216,40,48
TR 36,16,24576
Mvva 216,44,52
buffer_load_dwordx4 a[104:107], v29, s[8:11], s24 offen offset:0 sc1
Mvva 220,40,56
TR 38,16,28672
Mvva 220,44,60
WL 8
Mvva 224,48,32
TR 40,17,16384
Mvva 224,52,36
Mvva 228,48,40
TR 42,17,20480
Mvva 228,52,44
buffer_load_dwordx4 a[108:111], v29, s[8:11], s24 offen offset:1024 sc1
Mvva 232,48,48
TR 44,17,24576
Mvva 232,52,52
Mvva 236,48,56
TR 46,17,28672
Mvva 236,52,60
WL 8
Mvva 240,56,32
TR 48,18,16384
Mvva 240,60,36
buffer_load_dwordx4 a[112:115], v30, s[8:11], s24 offen offset:0 sc1
Mvva 244,56,40
TR 50,18,20480
Mvva 244,60,44
Mvva 248,56,48
TR 52,18,24576
Mvva 248,60,52
buffer_load_dwordx4 a[116:119], v30, s[8:11], s24 offen offset:1024 sc1
Mvva 252,56,56
TR 54,18,28672
Mvva 252,60,60
WL 8
Mava 128,32,32
TR 56,19,16384
Mava 128,36,36
Mava 132,32,40
TR 58,19,20480
Mava 132,36,44
buffer_load_dwordx4 a[120:123], v31, s[8:11], s24 offen offset:0 sc1
Mava 136,32,48
TR 60,19,24576
Mava 136,36,52
Mava 140,32,56
TR 62,19,28672
Mava 140,36,60
WL 8
Mava 144,40,32
TR 32,20,16384
Mava 144,44,36
buffer_load_dwordx4 a[124:127], v31, s[8:11], s24 offen offset:1024 sc1
Mava 148,40,40
TR 34,20,20480
Mava 148,44,44
Mava 152,40,48
TR 36,20,24576
Mava 152,44,52
s_add_u32 s24, s24, 2048
Mava 156,40,56
TR 38,20,28672
Mava 156,44,60
WL 8
Mava 160,48,32
TR 40,21,16384
Mava 160,52,36
Mava 164,48,40
TR 42,21,20480
Mava 164,52,44
buffer_load_dword v7, v70, s[92:95], 0 offen
Mava 168,48,48
TR 44,21,24576
Mava 168,52,52
Mava 172,48,56
TR 46,21,28672
Mava 172,52,60
WL 8
Mava 176,56,32
TR 48,22,16384
Mava 176,60,36
s_add_u32 s92, s92, 0x100000
s_addc_u32 s93, s93, 0
Mava 180,56,40
TR 50,22,20480
Mava 180,60,44
Mava 184,56,48
TR 52,22,24576
Mava 184,60,52
s_add_u32 s63, s63, 1
Mava 188,56,56
TR 54,22,28672
Mava 188,60,60
WL 8
Mava 192,32,32
TR 56,23,16384
Mava 192,36,36
Mava 196,32,40
TR 58,23,20480
Mava 196,36,44
s_cmp_eq_u32 s63, 3
s_cselect_b64 s[92:93], s[96:97], s[92:93]
Mava 200,32,48
TR 60,23,24576
Mava 200,36,52
Mava 204,32,56
TR 62,23,28672
Mava 204,36,60
WL 8
s_mov_b32 s32, 3
A1_loop:
s_waitcnt vmcnt(18)
s_barrier
Mava 208,40,32
TR 32,8,32768
Mava 208,44,36
s_add_u32 m0, s27, 0
Mava 212,40,40
TR 34,8,36864
Mava 212,44,44
DM 24,12,25,0
Mava 216,40,48
TR 36,8,40960
Mava 216,44,52
Mava 220,40,56
TR 38,8,45056
Mava 220,44,60
WL 8
Mava 224,48,32
TR 40,9,32768
Mava 224,52,36
DM 25,12,25,1024
Mava 228,48,40
TR 42,9,36864
Mava 228,52,44
Mava 232,48,48
TR 44,9,40960
Mava 232,52,52
DM 26,12,25,2048
Mava 236,48,56
TR 46,9,45056
Mava 236,52,60
WL 8
Mava 240,56,32
TR 48,10,32768
Mava 240,60,36
Mava 244,56,40
TR 50,10,36864
Mava 244,60,44
DM 27,12,25,3072
Mava 248,56,48
TR 52,10,40960
Mava 248,60,52
Mava 252,56,56
TR 54,10,45056
Mava 252,60,60
WL 8
Mvva 128,32,64
TR 56,11,32768
Mvva 128,36,68
s_add_u32 s25, s25, 524288
Mvva 132,32,72
TR 58,11,36864
Mvva 132,36,76
Mvva 136,32,80
TR 60,11,40960
Mvva 136,36,84
s_add_u32 m0, s27, 65536
Mvva 140,32,88
TR 62,11,45056
Mvva 140,36,92
WL 8
Mvva 144,40,64
TR 32,12,32768
Mvva 144,44,68
Mvva 148,40,72
TR 34,12,36864
Mvva 148,44,76
DM 24,12,26,0
Mvva 152,40,80
TR 36,12,40960
Mvva 152,44,84
Mvva 156,40,88
TR 38,12,45056
Mvva 156,44,92
WL 8
Mvva 160,48,64
TR 40,13,32768
Mvva 160,52,68
DM 25,12,26,1024
Mvva 164,48,72
TR 42,13,36864
Mvva 164,52,76
Mvva 168,48,80
TR 44,13,40960
Mvva 168,52,84
DM 26,12,26,2048
Mvva 172,48,88
TR 46,13,45056
Mvva 172,52,92
WL 8
Mvva 176,56,64
TR 48,14,32768
Mvva 176,60,68
Mvva 180,56,72
TR 50,14,36864
Mvva 180,60,76
DM 27,12,26,3072
Mvva 184,56,80
TR 52,14,40960
Mvva 184,60,84
Mvva 188,56,88
TR 54,14,45056
Mvva 188,60,92
WL 8
Mvva 192,32,64
TR 56,15,32768
Mvva 192,36,68
s_add_u32 s26, s26, 524288
Mvva 196,32,72
TR 58,15,36864
Mvva 196,36,76
Mvva 200,32,80
TR 60,15,40960
Mvva 200,36,84
buffer_load_dwordx4 a[0:3], v28, s[8:11], s24 offen offset:0 sc1
Mvva 204,32,88
TR 62,15,45056
Mvva 204,36,92
WL 8
Mvva 208,40,64
TR 32,16,32768
Mvva 208,44,68
buffer_load_dwordx4 a[4:7], v28, s[8:11], s24 offen offset:1024 sc1
Mvva 212,40,72
TR 34,16,36864
Mvva 212,44,76
Mvva 216,40,80
TR 36,16,40960
Mvva 216,44,84
buffer_load_dwordx4 a[8:11], v29, s[8:11], s24 offen offset:0 sc1
Mvva 220,40,88
TR 38,16,45056
Mvva 220,44,92
WL 8
Mvva 224,48,64
TR 40,17,32768
Mvva 224,52,68
Mvva 228,48,72
TR 42,17,36864
Mvva 228,52,76
buffer_load_dwordx4 a[12:15], v29, s[8:11], s24 offen offset:1024 sc1
Mvva 232,48,80
TR 44,17,40960
Mvva 232,52,84
Mvva 236,48,88
TR 46,17,45056
Mvva 236,52,92
WL 8
Mvva 240,56,64
TR 48,18,32768
Mvva 240,60,68
buffer_load_dwordx4 a[16:19], v30, s[8:11], s24 offen offset:0 sc1
Mvva 244,56,72
TR 50,18,36864
Mvva 244,60,76
Mvva 248,56,80
TR 52,18,40960
Mvva 248,60,84
buffer_load_dwordx4 a[20:23], v30, s[8:11], s24 offen offset:1024 sc1
Mvva 252,56,88
TR 54,18,45056
Mvva 252,60,92
WL 8
Mava 128,32,64
TR 56,19,32768
Mava 128,36,68
Mava 132,32,72
TR 58,19,36864
Mava 132,36,76
buffer_load_dwordx4 a[24:27], v31, s[8:11], s24 offen offset:0 sc1
Mava 136,32,80
TR 60,19,40960
Mava 136,36,84
Mava 140,32,88
TR 62,19,45056
Mava 140,36,92
WL 8
Mava 144,40,64
TR 32,20,32768
Mava 144,44,68
buffer_load_dwordx4 a[28:31], v31, s[8:11], s24 offen offset:1024 sc1
Mava 148,40,72
TR 34,20,36864
Mava 148,44,76
Mava 152,40,80
TR 36,20,40960
Mava 152,44,84
s_add_u32 s24, s24, 2048
Mava 156,40,88
TR 38,20,45056
Mava 156,44,92
WL 8
Mava 160,48,64
TR 40,21,32768
Mava 160,52,68
Mava 164,48,72
TR 42,21,36864
Mava 164,52,76
buffer_load_dword v7, v70, s[92:95], 0 offen
Mava 168,48,80
TR 44,21,40960
Mava 168,52,84
Mava 172,48,88
TR 46,21,45056
Mava 172,52,92
WL 8
Mava 176,56,64
TR 48,22,32768
Mava 176,60,68
s_add_u32 s92, s92, 0x100000
s_addc_u32 s93, s93, 0
Mava 180,56,72
TR 50,22,36864
Mava 180,60,76
Mava 184,56,80
TR 52,22,40960
Mava 184,60,84
s_add_u32 s63, s63, 1
Mava 188,56,88
TR 54,22,45056
Mava 188,60,92
WL 8
Mava 192,32,64
TR 56,23,32768
Mava 192,36,68
Mava 196,32,72
TR 58,23,36864
Mava 196,36,76
s_cmp_eq_u32 s63, 4
s_cselect_b64 s[92:93], s[68:69], s[92:93]
Mava 200,32,80
TR 60,23,40960
Mava 200,36,84
Mava 204,32,88
TR 62,23,45056
Mava 204,36,92
WL 8
s_waitcnt vmcnt(18)
s_barrier
Mava 208,40,64
TR 32,8,49152
Mava 208,44,68
s_add_u32 m0, s27, 16384
Mava 212,40,72
TR 34,8,53248
Mava 212,44,76
DM 24,12,25,0
Mava 216,40,80
TR 36,8,57344
Mava 216,44,84
Mava 220,40,88
TR 38,8,61440
Mava 220,44,92
WL 8
Mava 224,48,64
TR 40,9,49152
Mava 224,52,68
DM 25,12,25,1024
Mava 228,48,72
TR 42,9,53248
Mava 228,52,76
Mava 232,48,80
TR 44,9,57344
Mava 232,52,84
DM 26,12,25,2048
Mava 236,48,88
TR 46,9,61440
Mava 236,52,92
WL 8
Mava 240,56,64
TR 48,10,49152
Mava 240,60,68
Mava 244,56,72
TR 50,10,53248
Mava 244,60,76
DM 27,12,25,3072
Mava 248,56,80
TR 52,10,57344
Mava 248,60,84
Mava 252,56,88
TR 54,10,61440
Mava 252,60,92
WL 8
Mvva 128,32,96
TR 56,11,49152
Mvva 128,36,100
s_add_u32 s25, s25, 524288
Mvva 132,32,104
TR 58,11,53248
Mvva 132,36,108
Mvva 136,32,112
TR 60,11,57344
Mvva 136,36,116
s_add_u32 m0, s27, 81920
Mvva 140,32,120
TR 62,11,61440
Mvva 140,36,124
WL 8
Mvva 144,40,96
TR 32,12,49152
Mvva 144,44,100
DM 24,12,26,0
Mvva 148,40,104
TR 34,12,53248
Mvva 148,44,108
Mvva 152,40,112
TR 36,12,57344
Mvva 152,44,116
DM 25,12,26,1024
Mvva 156,40,120
TR 38,12,61440
Mvva 156,44,124
WL 8
Mvva 160,48,96
TR 40,13,49152
Mvva 160,52,100
Mvva 164,48,104
TR 42,13,53248
Mvva 164,52,108
DM 26,12,26,2048
Mvva 168,48,112
TR 44,13,57344
Mvva 168,52,116
Mvva 172,48,120
TR 46,13,61440
Mvva 172,52,124
WL 8
Mvva 176,56,96
TR 48,14,49152
Mvva 176,60,100
DM 27,12,26,3072
Mvva 180,56,104
TR 50,14,53248
Mvva 180,60,108
Mvva 184,56,112
TR 52,14,57344
Mvva 184,60,116
s_add_u32 s26, s26, 524288
Mvva 188,56,120
TR 54,14,61440
Mvva 188,60,124
WL 8
Mvva 192,32,96
TR 56,15,49152
Mvva 192,36,100
Mvva 196,32,104
TR 58,15,53248
Mvva 196,36,108
buffer_load_dwordx4 a[32:35], v28, s[8:11], s24 offen offset:0 sc1
Mvva 200,32,112
TR 60,15,57344
Mvva 200,36,116
Mvva 204,32,120
TR 62,15,61440
Mvva 204,36,124
WL 8
Mvva 208,40,96
TR 32,16,49152
Mvva 208,44,100
buffer_load_dwordx4 a[36:39], v28, s[8:11], s24 offen offset:1024 sc1
Mvva 212,40,104
TR 34,16,53248
Mvva 212,44,108
buffer_load_dwordx4 a[40:43], v29, s[8:11], s24 offen offset:0 sc1
Mvva 216,40,112
TR 36,16,57344
Mvva 216,44,116
Mvva 220,40,120
TR 38,16,61440
Mvva 220,44,124
WL 8
Mvva 224,48,96
TR 40,17,49152
Mvva 224,52,100
buffer_load_dwordx4 a[44:47], v29, s[8:11], s24 offen offset:1024 sc1
Mvva 228,48,104
TR 42,17,53248
Mvva 228,52,108
Mvva 232,48,112
TR 44,17,57344
Mvva 232,52,116
buffer_load_dwordx4 a[48:51], v30, s[8:11], s24 offen offset:0 sc1
Mvva 236,48,120
TR 46,17,61440
Mvva 236,52,124
WL 8
Mvva 240,56,96
TR 48,18,49152
Mvva 240,60,100
Mvva 244,56,104
TR 50,18,53248
Mvva 244,60,108
buffer_load_dwordx4 a[52:55], v30, s[8:11], s24 offen offset:1024 sc1
Mvva 248,56,112
TR 52,18,57344
Mvva 248,60,116
Mvva 252,56,120
TR 54,18,61440
Mvva 252,60,124
WL 8
Mava 128,32,96
TR 56,19,49152
Mava 128,36,100
buffer_load_dwordx4 a[56:59], v31, s[8:11], s24 offen offset:0 sc1
Mava 132,32,104
TR 58,19,53248
Mava 132,36,108
Mava 136,32,112
TR 60,19,57344
Mava 136,36,116
buffer_load_dwordx4 a[60:63], v31, s[8:11], s24 offen offset:1024 sc1
Mava 140,32,120
TR 62,19,61440
Mava 140,36,124
WL 8
Mava 144,40,96
TR 32,20,49152
Mava 144,44,100
s_add_u32 s24, s24, 2048
Mava 148,40,104
TR 34,20,53248
Mava 148,44,108
Mava 152,40,112
TR 36,20,57344
Mava 152,44,116
buffer_load_dword v7, v70, s[92:95], 0 offen
Mava 156,40,120
TR 38,20,61440
Mava 156,44,124
WL 8
Mava 160,48,96
TR 40,21,49152
Mava 160,52,100
Mava 164,48,104
TR 42,21,53248
Mava 164,52,108
s_add_u32 s92, s92, 0x100000
s_addc_u32 s93, s93, 0
Mava 168,48,112
TR 44,21,57344
Mava 168,52,116
Mava 172,48,120
TR 46,21,61440
Mava 172,52,124
WL 8
Mava 176,56,96
TR 48,22,49152
Mava 176,60,100
s_add_u32 s63, s63, 1
Mava 180,56,104
TR 50,22,53248
Mava 180,60,108
Mava 184,56,112
TR 52,22,57344
Mava 184,60,116
s_cmp_eq_u32 s63, 5
s_cselect_b64 s[92:93], s[70:71], s[92:93]
Mava 188,56,120
TR 54,22,61440
Mava 188,60,124
WL 8
Mava 192,32,96
TR 56,23,49152
Mava 192,36,100
Mava 196,32,104
TR 58,23,53248
Mava 196,36,108
s_cmp_eq_u32 s63, 9
s_cselect_b64 s[92:93], s[98:99], s[92:93]
Mava 200,32,112
TR 60,23,57344
Mava 200,36,116
Mava 204,32,120
TR 62,23,61440
Mava 204,36,124
WL 8
s_waitcnt vmcnt(18)
s_barrier
Mava 208,40,96
TR 32,8,0
Mava 208,44,100
s_add_u32 m0, s27, 32768
Mava 212,40,104
TR 34,8,4096
Mava 212,44,108
DM 24,12,25,0
Mava 216,40,112
TR 36,8,8192
Mava 216,44,116
Mava 220,40,120
TR 38,8,12288
Mava 220,44,124
WL 8
Mava 224,48,96
TR 40,9,0
Mava 224,52,100
DM 25,12,25,1024
Mava 228,48,104
TR 42,9,4096
Mava 228,52,108
Mava 232,48,112
TR 44,9,8192
Mava 232,52,116
DM 26,12,25,2048
Mava 236,48,120
TR 46,9,12288
Mava 236,52,124
WL 8
Mava 240,56,96
TR 48,10,0
Mava 240,60,100
Mava 244,56,104
TR 50,10,4096
Mava 244,60,108
DM 27,12,25,3072
Mava 248,56,112
TR 52,10,8192
Mava 248,60,116
Mava 252,56,120
TR 54,10,12288
Mava 252,60,124
WL 8
Mvva 128,32,0
TR 56,11,0
Mvva 128,36,4
s_add_u32 s25, s25, 524288
Mvva 132,32,8
TR 58,11,4096
Mvva 132,36,12
Mvva 136,32,16
TR 60,11,8192
Mvva 136,36,20
s_add_u32 m0, s27, 98304
Mvva 140,32,24
TR 62,11,12288
Mvva 140,36,28
WL 8
Mvva 144,40,0
TR 32,12,0
Mvva 144,44,4
Mvva 148,40,8
TR 34,12,4096
Mvva 148,44,12
DM 24,12,26,0
Mvva 152,40,16
TR 36,12,8192
Mvva 152,44,20
Mvva 156,40,24
TR 38,12,12288
Mvva 156,44,28
WL 8
Mvva 160,48,0
TR 40,13,0
Mvva 160,52,4
DM 25,12,26,1024
Mvva 164,48,8
TR 42,13,4096
Mvva 164,52,12
Mvva 168,48,16
TR 44,13,8192
Mvva 168,52,20
DM 26,12,26,2048
Mvva 172,48,24
TR 46,13,12288
Mvva 172,52,28
WL 8
Mvva 176,56,0
TR 48,14,0
Mvva 176,60,4
Mvva 180,56,8
TR 50,14,4096
Mvva 180,60,12
DM 27,12,26,3072
Mvva 184,56,16
TR 52,14,8192
Mvva 184,60,20
Mvva 188,56,24
TR 54,14,12288
Mvva 188,60,28
WL 8
Mvva 192,32,0
TR 56,15,0
Mvva 192,36,4
s_add_u32 s26, s26, 524288
Mvva 196,32,8
TR 58,15,4096
Mvva 196,36,12
Mvva 200,32,16
TR 60,15,8192
Mvva 200,36,20
buffer_load_dwordx4 a[64:67], v28, s[8:11], s24 offen offset:0 sc1
Mvva 204,32,24
TR 62,15,12288
Mvva 204,36,28
WL 8
Mvva 208,40,0
TR 32,16,0
Mvva 208,44,4
buffer_load_dwordx4 a[68:71], v28, s[8:11], s24 offen offset:1024 sc1
Mvva 212,40,8
TR 34,16,4096
Mvva 212,44,12
Mvva 216,40,16
TR 36,16,8192
Mvva 216,44,20
buffer_load_dwordx4 a[72:75], v29, s[8:11], s24 offen offset:0 sc1
Mvva 220,40,24
TR 38,16,12288
Mvva 220,44,28
WL 8
Mvva 224,48,0
TR 40,17,0
Mvva 224,52,4
Mvva 228,48,8
TR 42,17,4096
Mvva 228,52,12
buffer_load_dwordx4 a[76:79], v29, s[8:11], s24 offen offset:1024 sc1
Mvva 232,48,16
TR 44,17,8192
Mvva 232,52,20
Mvva 236,48,24
TR 46,17,12288
Mvva 236,52,28
WL 8
Mvva 240,56,0
TR 48,18,0
Mvva 240,60,4
buffer_load_dwordx4 a[80:83], v30, s[8:11], s24 offen offset:0 sc1
Mvva 244,56,8
TR 50,18,4096
Mvva 244,60,12
Mvva 248,56,16
TR 52,18,8192
Mvva 248,60,20
buffer_load_dwordx4 a[84:87], v30, s[8:11], s24 offen offset:1024 sc1
Mvva 252,56,24
TR 54,18,12288
Mvva 252,60,28
WL 8
Mava 128,32,0
TR 56,19,0
Mava 128,36,4
Mava 132,32,8
TR 58,19,4096
Mava 132,36,12
buffer_load_dwordx4 a[88:91], v31, s[8:11], s24 offen offset:0 sc1
Mava 136,32,16
TR 60,19,8192
Mava 136,36,20
Mava 140,32,24
TR 62,19,12288
Mava 140,36,28
WL 8
Mava 144,40,0
TR 32,20,0
Mava 144,44,4
buffer_load_dwordx4 a[92:95], v31, s[8:11], s24 offen offset:1024 sc1
Mava 148,40,8
TR 34,20,4096
Mava 148,44,12
Mava 152,40,16
TR 36,20,8192
Mava 152,44,20
s_add_u32 s24, s24, 2048
Mava 156,40,24
TR 38,20,12288
Mava 156,44,28
WL 8
Mava 160,48,0
TR 40,21,0
Mava 160,52,4
Mava 164,48,8
TR 42,21,4096
Mava 164,52,12
buffer_load_dword v7, v70, s[92:95], 0 offen
Mava 168,48,16
TR 44,21,8192
Mava 168,52,20
Mava 172,48,24
TR 46,21,12288
Mava 172,52,28
WL 8
Mava 176,56,0
TR 48,22,0
Mava 176,60,4
s_add_u32 s92, s92, 0x100000
s_addc_u32 s93, s93, 0
Mava 180,56,8
TR 50,22,4096
Mava 180,60,12
Mava 184,56,16
TR 52,22,8192
Mava 184,60,20
s_add_u32 s63, s63, 1
Mava 188,56,24
TR 54,22,12288
Mava 188,60,28
WL 8
Mava 192,32,0
TR 56,23,0
Mava 192,36,4
Mava 196,32,8
TR 58,23,4096
Mava 196,36,12
s_cmp_eq_u32 s63, 6
s_cselect_b64 s[92:93], s[74:75], s[92:93]
Mava 200,32,16
TR 60,23,8192
Mava 200,36,20
Mava 204,32,24
TR 62,23,12288
Mava 204,36,28
WL 8
s_waitcnt vmcnt(18)
s_barrier
Mava 208,40,0
TR 32,8,16384
Mava 208,44,4
s_add_u32 m0, s27, 49152
Mava 212,40,8
TR 34,8,20480
Mava 212,44,12
Mava 216,40,16
TR 36,8,24576
Mava 216,44,20
DM 24,12,25,0
Mava 220,40,24
TR 38,8,28672
Mava 220,44,28
WL 8
Mava 224,48,0
TR 40,9,16384
Mava 224,52,4
Mava 228,48,8
TR 42,9,20480
Mava 228,52,12
DM 25,12,25,1024
Mava 232,48,16
TR 44,9,24576
Mava 232,52,20
Mava 236,48,24
TR 46,9,28672
Mava 236,52,28
WL 8
Mava 240,56,0
TR 48,10,16384
Mava 240,60,4
DM 26,12,25,2048
Mava 244,56,8
TR 50,10,20480
Mava 244,60,12
Mava 248,56,16
TR 52,10,24576
Mava 248,60,20
DM 27,12,25,3072
Mava 252,56,24
TR 54,10,28672
Mava 252,60,28
WL 8
Mvva 128,32,32
TR 56,11,16384
Mvva 128,36,36
Mvva 132,32,40
TR 58,11,20480
Mvva 132,36,44
s_add_u32 s25, s25, 524288
Mvva 136,32,48
TR 60,11,24576
Mvva 136,36,52
Mvva 140,32,56
TR 62,11,28672
Mvva 140,36,60
WL 8
Mvva 144,40,32
TR 32,12,16384
Mvva 144,44,36
s_add_u32 m0, s27, 114688
Mvva 148,40,40
TR 34,12,20480
Mvva 148,44,44
Mvva 152,40,48
TR 36,12,24576
Mvva 152,44,52
DM 24,12,26,0
Mvva 156,40,56
TR 38,12,28672
Mvva 156,44,60
WL 8
Mvva 160,48,32
TR 40,13,16384
Mvva 160,52,36
Mvva 164,48,40
TR 42,13,20480
Mvva 164,52,44
DM 25,12,26,1024
Mvva 168,48,48
TR 44,13,24576
Mvva 168,52,52
Mvva 172,48,56
TR 46,13,28672
Mvva 172,52,60
WL 8
Mvva 176,56,32
TR 48,14,16384
Mvva 176,60,36
DM 26,12,26,2048
Mvva 180,56,40
TR 50,14,20480
Mvva 180,60,44
Mvva 184,56,48
TR 52,14,24576
Mvva 184,60,52
DM 27,12,26,3072
Mvva 188,56,56
TR 54,14,28672
Mvva 188,60,60
WL 8
Mvva 192,32,32
TR 56,15,16384
Mvva 192,36,36
Mvva 196,32,40
TR 58,15,20480
Mvva 196,36,44
s_add_u32 s26, s26, 524288
Mvva 200,32,48
TR 60,15,24576
Mvva 200,36,52
Mvva 204,32,56
TR 62,15,28672
Mvva 204,36,60
WL 8
Mvva 208,40,32
TR 32,16,16384
Mvva 208,44,36
buffer_load_dwordx4 a[96:99], v28, s[8:11], s24 offen offset:0 sc1
Mvva 212,40,40
TR 34,16,20480
Mvva 212,44,44
Mvva 216,40,48
TR 36,16,24576
Mvva 216,44,52
buffer_load_dwordx4 a[100:103], v28, s[8:11], s24 offen offset:1024 sc1
Mvva 220,40,56
TR 38,16,28672
Mvva 220,44,60
WL 8
Mvva 224,48,32
TR 40,17,16384
Mvva 224,52,36
Mvva 228,48,40
TR 42,17,20480
Mvva 228,52,44
buffer_load_dwordx4 a[104:107], v29, s[8:11], s24 offen offset:0 sc1
Mvva 232,48,48
TR 44,17,24576
Mvva 232,52,52
Mvva 236,48,56
TR 46,17,28672
Mvva 236,52,60
WL 8
Mvva 240,56,32
TR 48,18,16384
Mvva 240,60,36
buffer_load_dwordx4 a[108:111], v29, s[8:11], s24 offen offset:1024 sc1
Mvva 244,56,40
TR 50,18,20480
Mvva 244,60,44
Mvva 248,56,48
TR 52,18,24576
Mvva 248,60,52
buffer_load_dwordx4 a[112:115], v30, s[8:11], s24 offen offset:0 sc1
Mvva 252,56,56
TR 54,18,28672
Mvva 252,60,60
WL 8
Mava 128,32,32
TR 56,19,16384
Mava 128,36,36
Mava 132,32,40
TR 58,19,20480
Mava 132,36,44
buffer_load_dwordx4 a[116:119], v30, s[8:11], s24 offen offset:1024 sc1
Mava 136,32,48
TR 60,19,24576
Mava 136,36,52
Mava 140,32,56
TR 62,19,28672
Mava 140,36,60
WL 8
Mava 144,40,32
TR 32,20,16384
Mava 144,44,36
buffer_load_dwordx4 a[120:123], v31, s[8:11], s24 offen offset:0 sc1
Mava 148,40,40
TR 34,20,20480
Mava 148,44,44
Mava 152,40,48
TR 36,20,24576
Mava 152,44,52
buffer_load_dwordx4 a[124:127], v31, s[8:11], s24 offen offset:1024 sc1
Mava 156,40,56
TR 38,20,28672
Mava 156,44,60
WL 8
Mava 160,48,32
TR 40,21,16384
Mava 160,52,36
Mava 164,48,40
TR 42,21,20480
Mava 164,52,44
s_add_u32 s24, s24, 2048
Mava 168,48,48
TR 44,21,24576
Mava 168,52,52
Mava 172,48,56
TR 46,21,28672
Mava 172,52,60
WL 8
Mava 176,56,32
TR 48,22,16384
Mava 176,60,36
buffer_load_dword v7, v70, s[92:95], 0 offen
Mava 180,56,40
TR 50,22,20480
Mava 180,60,44
Mava 184,56,48
TR 52,22,24576
Mava 184,60,52
s_add_u32 s92, s92, 0x100000
s_addc_u32 s93, s93, 0
Mava 188,56,56
TR 54,22,28672
Mava 188,60,60
WL 8
Mava 192,32,32
TR 56,23,16384
Mava 192,36,36
Mava 196,32,40
TR 58,23,20480
Mava 196,36,44
s_add_u32 s63, s63, 1
Mava 200,32,48
TR 60,23,24576
Mava 200,36,52
Mava 204,32,56
TR 62,23,28672
s_sub_u32 s32, s32, 1
Mava 204,36,60
WL 8
s_cmp_lg_u32 s32, 0
s_cbranch_scc1 A1_loop
s_waitcnt vmcnt(18)
s_barrier
Mava 208,40,32
TR 32,8,32768
Mava 208,44,36
s_add_u32 m0, s27, 0
Mava 212,40,40
TR 34,8,36864
Mava 212,44,44
Mava 216,40,48
TR 36,8,40960
Mava 216,44,52
DM 64,20,41,0
Mava 220,40,56
TR 38,8,45056
Mava 220,44,60
WL 8
Mava 224,48,32
TR 40,9,32768
Mava 224,52,36
Mava 228,48,40
TR 42,9,36864
Mava 228,52,44
Mava 232,48,48
TR 44,9,40960
Mava 232,52,52
DM 65,20,41,1024
Mava 236,48,56
TR 46,9,45056
Mava 236,52,60
WL 8
Mava 240,56,32
TR 48,10,32768
Mava 240,60,36
Mava 244,56,40
TR 50,10,36864
Mava 244,60,44
Mava 248,56,48
TR 52,10,40960
Mava 248,60,52
DM 66,20,41,2048
Mava 252,56,56
TR 54,10,45056
Mava 252,60,60
WL 8
Mvva 128,32,64
TR 56,11,32768
Mvva 128,36,68
Mvva 132,32,72
TR 58,11,36864
Mvva 132,36,76
DM 67,20,41,3072
Mvva 136,32,80
TR 60,11,40960
Mvva 136,36,84
Mvva 140,32,88
TR 62,11,45056
Mvva 140,36,92
WL 8
Mvva 144,40,64
TR 32,12,32768
Mvva 144,44,68
Mvva 148,40,72
TR 34,12,36864
Mvva 148,44,76
s_add_u32 s41, s41, 0x4000
Mvva 152,40,80
TR 36,12,40960
Mvva 152,44,84
Mvva 156,40,88
TR 38,12,45056
Mvva 156,44,92
WL 8
Mvva 160,48,64
TR 40,13,32768
Mvva 160,52,68
Mvva 164,48,72
TR 42,13,36864
Mvva 164,52,76
s_and_b32 s41, s41, 0x1ffff
Mvva 168,48,80
TR 44,13,40960
Mvva 168,52,84
Mvva 172,48,88
TR 46,13,45056
Mvva 172,52,92
WL 8
Mvva 176,56,64
TR 48,14,32768
Mvva 176,60,68
s_add_u32 m0, s27, 65536
Mvva 180,56,72
TR 50,14,36864
Mvva 180,60,76
Mvva 184,56,80
TR 52,14,40960
Mvva 184,60,84
Mvva 188,56,88
TR 54,14,45056
Mvva 188,60,92
WL 8
Mvva 192,32,64
TR 56,15,32768
Mvva 192,36,68
DM 68,28,42,0
Mvva 196,32,72
TR 58,15,36864
Mvva 196,36,76
Mvva 200,32,80
TR 60,15,40960
Mvva 200,36,84
Mvva 204,32,88
TR 62,15,45056
Mvva 204,36,92
WL 8
Mvva 208,40,64
TR 32,16,32768
Mvva 208,44,68
DM 69,28,42,1024
Mvva 212,40,72
TR 34,16,36864
Mvva 212,44,76
Mvva 216,40,80
TR 36,16,40960
Mvva 216,44,84
DM 68,28,42,2048
Mvva 220,40,88
TR 38,16,45056
Mvva 220,44,92
WL 8
Mvva 224,48,64
TR 40,17,32768
Mvva 224,52,68
Mvva 228,48,72
TR 42,17,36864
Mvva 228,52,76
Mvva 232,48,80
TR 44,17,40960
Mvva 232,52,84
DM 69,28,42,3072
Mvva 236,48,88
TR 46,17,45056
Mvva 236,52,92
WL 8
Mvva 240,56,64
TR 48,18,32768
Mvva 240,60,68
Mvva 244,56,72
TR 50,18,36864
Mvva 244,60,76
Mvva 248,56,80
TR 52,18,40960
Mvva 248,60,84
s_add_u32 s42, s42, 0x4000
Mvva 252,56,88
TR 54,18,45056
Mvva 252,60,92
WL 8
Mava 128,32,64
TR 56,19,32768
Mava 128,36,68
Mava 132,32,72
TR 58,19,36864
Mava 132,36,76
s_and_b32 s42, s42, 0x1ffff
Mava 136,32,80
TR 60,19,40960
Mava 136,36,84
Mava 140,32,88
TR 62,19,45056
Mava 140,36,92
WL 8
Mava 144,40,64
TR 32,20,32768
Mava 144,44,68
Mava 148,40,72
TR 34,20,36864
Mava 148,44,76
buffer_load_dword v7, v70, s[92:95], 0 offen
Mava 152,40,80
TR 36,20,40960
Mava 152,44,84
Mava 156,40,88
TR 38,20,45056
Mava 156,44,92
WL 8
Mava 160,48,64
TR 40,21,32768
Mava 160,52,68
Mava 164,48,72
TR 42,21,36864
Mava 164,52,76
s_add_u32 s92, s92, 0x100000
s_addc_u32 s93, s93, 0
Mava 168,48,80
TR 44,21,40960
Mava 168,52,84
Mava 172,48,88
TR 46,21,45056
Mava 172,52,92
WL 8
Mava 176,56,64
TR 48,22,32768
Mava 176,60,68
s_add_u32 s63, s63, 1
Mava 180,56,72
TR 50,22,36864
Mava 180,60,76
Mava 184,56,80
TR 52,22,40960
Mava 184,60,84
Mava 188,56,88
TR 54,22,45056
Mava 188,60,92
WL 8
Mava 192,32,64
TR 56,23,32768
Mava 192,36,68
s_cmp_eq_u32 s63, 16
s_cselect_b64 s[92:93], s[52:53], s[92:93]
Mava 196,32,72
TR 58,23,36864
Mava 196,36,76
Mava 200,32,80
TR 60,23,40960
Mava 200,36,84
Mava 204,32,88
TR 62,23,45056
Mava 204,36,92
WL 8
s_waitcnt vmcnt(10)
s_barrier
Mava 208,40,64
TR 32,8,49152
Mava 208,44,68
v_lshlrev_b32 v74, 7, v1
Mava 212,40,72
TR 34,8,53248
Mava 212,44,76
Mava 216,40,80
TR 36,8,57344
Mava 216,44,84
Mava 220,40,88
TR 38,8,61440
Mava 220,44,92
WL 8
Mava 224,48,64
TR 40,9,49152
Mava 224,52,68
s_add_u32 m0, s27, 16384
Mava 228,48,72
TR 42,9,53248
Mava 228,52,76
Mava 232,48,80
TR 44,9,57344
Mava 232,52,84
Mava 236,48,88
TR 46,9,61440
Mava 236,52,92
WL 8
Mava 240,56,64
TR 48,10,49152
Mava 240,60,68
s_lshl_b32 s36, s3, 13
Mava 244,56,72
TR 50,10,53248
Mava 244,60,76
Mava 248,56,80
TR 52,10,57344
Mava 248,60,84
Mava 252,56,88
TR 54,10,61440
Mava 252,60,92
WL 8
Mvva 128,32,96
TR 56,11,49152
Mvva 128,36,100
DM 64,20,41,0
Mvva 132,32,104
TR 58,11,53248
Mvva 132,36,108
Mvva 136,32,112
TR 60,11,57344
Mvva 136,36,116
Mvva 140,32,120
TR 62,11,61440
Mvva 140,36,124
WL 8
Mvva 144,40,96
TR 32,12,49152
Mvva 144,44,100
v_add_u32 v74, s36, v74
Mvva 148,40,104
TR 34,12,53248
Mvva 148,44,108
Mvva 152,40,112
TR 36,12,57344
Mvva 152,44,116
Mvva 156,40,120
TR 38,12,61440
Mvva 156,44,124
WL 8
Mvva 160,48,96
TR 40,13,49152
Mvva 160,52,100
DM 65,20,41,1024
Mvva 164,48,104
TR 42,13,53248
Mvva 164,52,108
Mvva 168,48,112
TR 44,13,57344
Mvva 168,52,116
Mvva 172,48,120
TR 46,13,61440
Mvva 172,52,124
WL 8
Mvva 176,56,96
TR 48,14,49152
Mvva 176,60,100
v_add_u32 v74, A1_cv-M1_pc, v74
Mvva 180,56,104
TR 50,14,53248
Mvva 180,60,108
Mvva 184,56,112
TR 52,14,57344
Mvva 184,60,116
Mvva 188,56,120
TR 54,14,61440
Mvva 188,60,124
WL 8
Mvva 192,32,96
TR 56,15,49152
Mvva 192,36,100
v_min_u32 v74, M1_last-M1_pc, v74
Mvva 196,32,104
TR 58,15,53248
Mvva 196,36,108
Mvva 200,32,112
TR 60,15,57344
Mvva 200,36,116
Mvva 204,32,120
TR 62,15,61440
Mvva 204,36,124
WL 8
Mvva 208,40,96
TR 32,16,49152
Mvva 208,44,100
DM 66,20,41,2048
Mvva 212,40,104
TR 34,16,53248
Mvva 212,44,108
Mvva 216,40,112
TR 36,16,57344
Mvva 216,44,116
Mvva 220,40,120
TR 38,16,61440
Mvva 220,44,124
WL 8
Mvva 224,48,96
TR 40,17,49152
Mvva 224,52,100
v_add_co_u32 v74, vcc, s100, v74
Mvva 228,48,104
TR 42,17,53248
Mvva 228,52,108
Mvva 232,48,112
TR 44,17,57344
Mvva 232,52,116
Mvva 236,48,120
TR 46,17,61440
Mvva 236,52,124
WL 8
Mvva 240,56,96
TR 48,18,49152
Mvva 240,60,100
DM 67,20,41,3072
Mvva 244,56,104
TR 50,18,53248
Mvva 244,60,108
Mvva 248,56,112
TR 52,18,57344
Mvva 248,60,116
Mvva 252,56,120
TR 54,18,61440
Mvva 252,60,124
WL 8
Mava 128,32,96
TR 56,19,49152
Mava 128,36,100
v_mov_b32 v75, s101
Mava 132,32,104
TR 58,19,53248
Mava 132,36,108
Mava 136,32,112
TR 60,19,57344
Mava 136,36,116
Mava 140,32,120
TR 62,19,61440
Mava 140,36,124
WL 8
Mava 144,40,96
TR 32,20,49152
Mava 144,44,100
s_add_u32 s41, s41, 0x4000
Mava 148,40,104
TR 34,20,53248
Mava 148,44,108
Mava 152,40,112
TR 36,20,57344
Mava 152,44,116
Mava 156,40,120
TR 38,20,61440
Mava 156,44,124
WL 8
Mava 160,48,96
TR 40,21,49152
Mava 160,52,100
v_addc_co_u32 v75, vcc, 0, v75, vcc
Mava 164,48,104
TR 42,21,53248
Mava 164,52,108
Mava 168,48,112
TR 44,21,57344
Mava 168,52,116
Mava 172,48,120
TR 46,21,61440
Mava 172,52,124
WL 8
Mava 176,56,96
TR 48,22,49152
Mava 176,60,100
s_and_b32 s41, s41, 0x1ffff
Mava 180,56,104
TR 50,22,53248
Mava 180,60,108
Mava 184,56,112
TR 52,22,57344
Mava 184,60,116
Mava 188,56,120
TR 54,22,61440
Mava 188,60,124
WL 8
Mava 192,32,96
TR 56,23,49152
Mava 192,36,100
global_load_dword v7, v[74:75], off
Mava 196,32,104
TR 58,23,53248
Mava 196,36,108
Mava 200,32,112
TR 60,23,57344
Mava 200,36,116
Mava 204,32,120
TR 62,23,61440
Mava 204,36,124
WL 8
Mava 208,40,96
Mava 208,44,100
Mava 212,40,104
Mava 212,44,108
Mava 216,40,112
Mava 216,44,116
Mava 220,40,120
Mava 220,44,124
WL 4
Mava 224,48,96
Mava 224,52,100
Mava 228,48,104
Mava 228,52,108
Mava 232,48,112
Mava 232,52,116
Mava 236,48,120
Mava 236,52,124
WL 0
Mava 240,56,96
Mava 240,60,100
Mava 244,56,104
Mava 244,60,108
Mava 248,56,112
Mava 248,60,116
Mava 252,56,120
Mava 252,60,124
A1_cv:
v_mov_b32 v6, v70
v_mov_b32 v24, v64
v_mov_b32 v25, v65
v_mov_b32 v26, v66
v_mov_b32 v27, v67
v_mov_b32 v28, v68
v_mov_b32 v29, v69
v_and_b32 v2, 15, v1
v_bfe_u32 v3, v1, 4, 1
v_bfe_u32 v4, v1, 5, 1
v_lshl_add_u32 v3, v3, 1, v4
v_lshlrev_b32 v4, 8, v2
v_add_u32 v5, 0, v3
v_xor_b32 v5, v5, v2
v_lshl_add_u32 v8, v5, 4, v4
v_add_u32 v5, 4, v3
v_xor_b32 v5, v5, v2
v_lshl_add_u32 v9, v5, 4, v4
v_add_u32 v5, 8, v3
v_xor_b32 v5, v5, v2
v_lshl_add_u32 v10, v5, 4, v4
v_add_u32 v5, 12, v3
v_xor_b32 v5, v5, v2
v_lshl_add_u32 v11, v5, 4, v4
v_mov_b32 v12, 0x3f803f80
v_mov_b32 v13, 0x3f803f80
v_mov_b32 v14, 0x3f803f80
v_mov_b32 v15, 0x3f803f80
s_lshl_b32 s43, s39, 17
s_lshl_b32 s36, s34, 13
s_add_u32 s43, s43, s36
v_lshlrev_b32 v30, 4, v1
s_mov_b32 s44, 0
s_mov_b32 s45, 0
s_lshl_b32 s36, s3, 2
s_add_u32 s36, s36, 0x20000
v_mov_b32 v31, s36
s_waitcnt vmcnt(10)
s_barrier
RQ 64,8,0
RQ 68,9,0
RQ 72,10,0
RQ 76,11,0
RQ 80,8,4096
RQ 84,9,4096
RQ 88,10,4096
RQ 92,11,4096
CV 96,128,129
CV 97,130,131
CV 98,144,145
CV 99,146,147
CV 100,132,133
CV 101,134,135
CV 102,148,149
CV 103,150,151
v_permlane16_swap_b32 v96, v98
v_permlane16_swap_b32 v97, v99
AW 0,96
AW 1,97
AW 2,98
AW 3,99
CV 104,136,137
CV 105,138,139
CV 106,152,153
CV 107,154,155
v_permlane16_swap_b32 v100, v102
v_permlane16_swap_b32 v101, v103
AW 4,100
AW 5,101
AW 6,102
s_add_u32 m0, s27, 32768
AW 7,103
CV 108,140,141
CV 109,142,143
CV 110,156,157
CV 111,158,159
v_permlane16_swap_b32 v104, v106
DM 24,20,41,0
v_permlane16_swap_b32 v105, v107
AW 8,104
AW 9,105
AW 10,106
AW 11,107
CV 96,160,161
DM 25,20,41,1024
CV 97,162,163
CV 98,176,177
CV 99,178,179
v_permlane16_swap_b32 v108, v110
v_permlane16_swap_b32 v109, v111
AW 12,108
DM 26,20,41,2048
AW 13,109
AW 14,110
AW 15,111
CV 100,164,165
CV 101,166,167
CV 102,180,181
DM 27,20,41,3072
CV 103,182,183
v_permlane16_swap_b32 v96, v98
v_permlane16_swap_b32 v97, v99
AW 16,96
AW 17,97
AW 18,98
s_add_u32 s41, s41, 0x4000
AW 19,99
CV 104,168,169
CV 105,170,171
CV 106,184,185
CV 107,186,187
v_permlane16_swap_b32 v100, v102
s_and_b32 s41, s41, 0x1ffff
v_permlane16_swap_b32 v101, v103
AW 20,100
AW 21,101
AW 22,102
AW 23,103
CV 108,172,173
s_add_u32 m0, s27, 49152
CV 109,174,175
CV 110,188,189
CV 111,190,191
v_permlane16_swap_b32 v104, v106
v_permlane16_swap_b32 v105, v107
AW 24,104
DM 24,20,41,0
AW 25,105
AW 26,106
AW 27,107
CV 96,192,193
CV 97,194,195
CV 98,208,209
DM 25,20,41,1024
CV 99,210,211
v_permlane16_swap_b32 v108, v110
v_permlane16_swap_b32 v109, v111
AW 28,108
AW 29,109
AW 30,110
AW 31,111
DM 26,20,41,2048
CV 100,196,197
CV 101,198,199
CV 102,212,213
CV 103,214,215
v_permlane16_swap_b32 v96, v98
v_permlane16_swap_b32 v97, v99
DM 27,20,41,3072
AW 32,96
AW 33,97
AW 34,98
AW 35,99
CV 104,200,201
CV 105,202,203
s_add_u32 s41, s41, 0x4000
CV 106,216,217
CV 107,218,219
v_permlane16_swap_b32 v100, v102
v_permlane16_swap_b32 v101, v103
AW 36,100
AW 37,101
s_and_b32 s41, s41, 0x1ffff
AW 38,102
AW 39,103
CV 108,204,205
CV 109,206,207
CV 110,220,221
CV 111,222,223
s_add_u32 m0, s27, 81920
v_permlane16_swap_b32 v104, v106
v_permlane16_swap_b32 v105, v107
AW 40,104
AW 41,105
AW 42,106
AW 43,107
DM 28,28,42,0
CV 96,224,225
CV 97,226,227
CV 98,240,241
CV 99,242,243
v_permlane16_swap_b32 v108, v110
v_permlane16_swap_b32 v109, v111
DM 29,28,42,1024
AW 44,108
AW 45,109
AW 46,110
AW 47,111
CV 100,228,229
CV 101,230,231
DM 28,28,42,2048
CV 102,244,245
CV 103,246,247
v_permlane16_swap_b32 v96, v98
v_permlane16_swap_b32 v97, v99
AW 48,96
AW 49,97
DM 29,28,42,3072
AW 50,98
AW 51,99
CV 104,232,233
CV 105,234,235
CV 106,248,249
CV 107,250,251
s_add_u32 s42, s42, 0x4000
v_permlane16_swap_b32 v100, v102
v_permlane16_swap_b32 v101, v103
AW 52,100
AW 53,101
AW 54,102
AW 55,103
s_and_b32 s42, s42, 0x1ffff
CV 108,236,237
CV 109,238,239
CV 110,252,253
CV 111,254,255
v_permlane16_swap_b32 v104, v106
v_permlane16_swap_b32 v105, v107
AW 56,104
AW 57,105
AW 58,106
AW 59,107
v_permlane16_swap_b32 v108, v110
v_permlane16_swap_b32 v109, v111
AW 60,108
AW 61,109
AW 62,110
AW 63,111
WL 4
AR 192,128
AR 193,129
AR 194,130
AR 195,131
Zvva 128,64,0
AR 196,144
AR 197,145
AR 198,146
AR 199,147
Mvva 128,68,16
CV 96,192,193
CV 97,194,195
CV 98,196,197
Mvva 128,72,32
CV 99,198,199
AR 200,132
AR 201,133
AR 202,134
Mvva 128,76,48
AR 203,135
AR 204,148
AR 205,149
Zvva 132,64,4
AR 206,150
AR 207,151
v_permlane16_swap_b32 v96, v98
v_permlane16_swap_b32 v97, v99
Mvva 132,68,20
AW 128,96
AW 129,97
AW 130,98
Mvva 132,72,36
AW 131,99
CV 100,200,201
CV 101,202,203
CV 102,204,205
Mvva 132,76,52
CV 103,206,207
AR 208,136
AR 209,137
AR 210,138
Zvva 136,64,8
AR 211,139
AR 212,152
AR 213,153
Mvva 136,68,24
AR 214,154
AR 215,155
v_permlane16_swap_b32 v100, v102
v_permlane16_swap_b32 v101, v103
Mvva 136,72,40
AW 132,100
AW 133,101
AW 134,102
Mvva 136,76,56
AW 135,103
CV 104,208,209
CV 105,210,211
CV 106,212,213
Zvva 140,64,12
CV 107,214,215
AR 216,140
AR 217,141
Mvva 140,68,28
AR 218,142
AR 219,143
AR 220,156
AR 221,157
Mvva 140,72,44
AR 222,158
AR 223,159
v_permlane16_swap_b32 v104, v106
Mvva 140,76,60
v_permlane16_swap_b32 v105, v107
AW 136,104
AW 137,105
AW 138,106
AW 139,107
CV 108,216,217
CV 109,218,219
CV 110,220,221
CV 111,222,223
s_nop 0
v_permlane16_swap_b32 v108, v110
v_permlane16_swap_b32 v109, v111
AW 140,108
AW 141,109
AW 142,110
AW 143,111
AR 192,160
AR 193,161
AR 194,162
AR 195,163
AR 196,176
AR 197,177
AR 198,178
AR 199,179
CV 96,192,193
CV 97,194,195
CV 98,196,197
CV 99,198,199
AR 200,164
AR 201,165
AR 202,166
AR 203,167
AR 204,180
AR 205,181
AR 206,182
AR 207,183
v_permlane16_swap_b32 v96, v98
v_permlane16_swap_b32 v97, v99
AW 160,96
AW 161,97
AW 162,98
v_max3_f32 v32, v128, v129, v130
AW 163,99
CV 100,200,201
CV 101,202,203
v_max3_f32 v36, v132, v133, v134
CV 102,204,205
CV 103,206,207
AR 208,168
v_max3_f32 v40, v136, v137, v138
AR 209,169
AR 210,170
AR 211,171
v_max3_f32 v44, v140, v141, v142
AR 212,184
AR 213,185
AR 214,186
v_max_f32 v32, v32, v131
AR 215,187
v_permlane16_swap_b32 v100, v102
v_permlane16_swap_b32 v101, v103
v_max_f32 v36, v36, v135
AW 164,100
AW 165,101
AW 166,102
AW 167,103
v_max_f32 v40, v40, v139
CV 104,208,209
CV 105,210,211
CV 106,212,213
v_max_f32 v44, v44, v143
CV 107,214,215
AR 216,172
AR 217,173
v_mov_b32 v33, v32
AR 218,174
AR 219,175
AR 220,188
v_mov_b32 v37, v36
AR 221,189
AR 222,190
AR 223,191
v_mov_b32 v41, v40
v_permlane16_swap_b32 v104, v106
v_permlane16_swap_b32 v105, v107
AW 168,104
v_mov_b32 v45, v44
AW 169,105
AW 170,106
AW 171,107
v_permlane16_swap_b32 v33, v32
CV 108,216,217
CV 109,218,219
CV 110,220,221
CV 111,222,223
v_permlane16_swap_b32 v37, v36
AR 192,192
AR 193,193
AR 194,194
v_permlane16_swap_b32 v41, v40
AR 195,195
AR 196,208
AR 197,209
v_permlane16_swap_b32 v45, v44
AR 198,210
AR 199,211
v_permlane16_swap_b32 v108, v110
v_max_f32 v32, v32, v33
v_permlane16_swap_b32 v109, v111
AW 172,108
AW 173,109
v_max_f32 v36, v36, v37
AW 174,110
AW 175,111
CV 96,192,193
v_max_f32 v40, v40, v41
CV 97,194,195
CV 98,196,197
CV 99,198,199
v_max_f32 v44, v44, v45
AR 200,196
AR 201,197
AR 202,198
AR 203,199
v_mov_b32 v33, v32
AR 204,212
AR 205,213
AR 206,214
v_mov_b32 v37, v36
AR 207,215
v_permlane16_swap_b32 v96, v98
v_permlane16_swap_b32 v97, v99
v_mov_b32 v41, v40
AW 192,96
AW 193,97
AW 194,98
v_mov_b32 v45, v44
AW 195,99
CV 100,200,201
CV 101,202,203
v_permlane32_swap_b32 v33, v32
CV 102,204,205
CV 103,206,207
AR 208,200
v_permlane32_swap_b32 v37, v36
AR 209,201
AR 210,202
AR 211,203
v_permlane32_swap_b32 v41, v40
AR 212,216
AR 213,217
AR 214,218
AR 215,219
v_permlane32_swap_b32 v45, v44
v_permlane16_swap_b32 v100, v102
v_permlane16_swap_b32 v101, v103
AW 196,100
v_max_f32 v32, v32, v33
AW 197,101
AW 198,102
AW 199,103
v_max_f32 v36, v36, v37
CV 104,208,209
CV 105,210,211
CV 106,212,213
v_max_f32 v40, v40, v41
CV 107,214,215
AR 216,204
AR 217,205
v_max_f32 v44, v44, v45
AR 218,206
AR 219,207
AR 220,220
v_sub_f32 v32, 0, v32
AR 221,221
AR 222,222
AR 223,223
v_sub_f32 v36, 0, v36
v_permlane16_swap_b32 v104, v106
v_permlane16_swap_b32 v105, v107
AW 200,104
AW 201,105
v_sub_f32 v40, 0, v40
AW 202,106
AW 203,107
CV 108,216,217
v_sub_f32 v44, 0, v44
CV 109,218,219
CV 110,220,221
CV 111,222,223
v_mov_b32 v33, v32
AR 192,224
AR 193,225
AR 194,226
v_mov_b32 v34, v32
AR 195,227
AR 196,240
AR 197,241
v_mov_b32 v35, v32
AR 198,242
AR 199,243
v_permlane16_swap_b32 v108, v110
v_mov_b32 v37, v36
v_permlane16_swap_b32 v109, v111
AW 204,108
AW 205,109
v_mov_b32 v38, v36
AW 206,110
AW 207,111
CV 96,192,193
CV 97,194,195
v_mov_b32 v39, v36
CV 98,196,197
CV 99,198,199
AR 200,228
v_mov_b32 v41, v40
AR 201,229
AR 202,230
AR 203,231
v_mov_b32 v42, v40
AR 204,244
AR 205,245
AR 206,246
v_mov_b32 v43, v40
AR 207,247
v_permlane16_swap_b32 v96, v98
v_permlane16_swap_b32 v97, v99
v_mov_b32 v45, v44
AW 224,96
AW 225,97
AW 226,98
v_mov_b32 v46, v44
AW 227,99
CV 100,200,201
CV 101,202,203
v_mov_b32 v47, v44
CV 102,204,205
CV 103,206,207
AR 208,232
AR 209,233
AR 210,234
AR 211,235
AR 212,248
AR 213,249
AR 214,250
AR 215,251
v_permlane16_swap_b32 v100, v102
v_permlane16_swap_b32 v101, v103
AW 228,100
AW 229,101
AW 230,102
AW 231,103
CV 104,208,209
CV 105,210,211
CV 106,212,213
CV 107,214,215
AR 216,236
AR 217,237
AR 218,238
AR 219,239
AR 220,252
AR 221,253
AR 222,254
AR 223,255
v_permlane16_swap_b32 v104, v106
v_permlane16_swap_b32 v105, v107
AW 232,104
AW 233,105
AW 234,106
AW 235,107
CV 108,216,217
CV 109,218,219
CV 110,220,221
CV 111,222,223
s_nop 0
v_permlane16_swap_b32 v108, v110
v_permlane16_swap_b32 v109, v111
AW 236,108
AW 237,109
AW 238,110
AW 239,111
A1_havemax:
WL 0
Cvva 144,80,0,32
v_add_f32 v129, v129, v32
v_add_f32 v128, v128, v32
RQ 64,8,8192
Mvva 144,84,16
v_add_f32 v131, v131, v32
v_add_f32 v130, v130, v32
Mvva 144,88,32
v_add_f32 v133, v133, v36
v_add_f32 v132, v132, v36
RQ 68,9,8192
Mvva 144,92,48
v_add_f32 v135, v135, v36
v_add_f32 v134, v134, v36
Cvva 148,80,4,36
v_add_f32 v137, v137, v40
v_add_f32 v136, v136, v40
RQ 72,10,8192
Mvva 148,84,20
v_add_f32 v139, v139, v40
v_add_f32 v138, v138, v40
Mvva 148,88,36
v_add_f32 v141, v141, v44
v_add_f32 v140, v140, v44
RQ 76,11,8192
Mvva 148,92,52
v_add_f32 v143, v143, v44
v_add_f32 v142, v142, v44
Cvva 152,80,8,40
EX 128
Mvva 152,84,24
EX 129
Mvva 152,88,40
EX 130
Mvva 152,92,56
EX 131
Cvva 156,80,12,44
EX 132
Mvva 156,84,28
EX 133
Mvva 156,88,44
WL 0
Mvva 156,92,60
EX 134
Cvva 160,64,0,32
RQ 80,8,12288
Mvva 160,68,16
EX 135
Mvva 160,72,32
RQ 84,9,12288
Mvva 160,76,48
EX 136
Cvva 164,64,4,36
RQ 88,10,12288
Mvva 164,68,20
EX 137
Mvva 164,72,36
RQ 92,11,12288
Mvva 164,76,52
EX 138
Cvva 168,64,8,40
EX 139
Mvva 168,68,24
EX 140
Mvva 168,72,40
EX 141
Mvva 168,76,56
EX 142
Cvva 172,64,12,44
EX 143
Mvva 172,68,28
EX 144
Mvva 172,72,44
WL 0
Mvva 172,76,60
EX 145
Cvva 176,80,0,32
s_waitcnt vmcnt(13)
s_barrier
RQ 64,8,16384
Mvva 176,84,16
EX 146
Mvva 176,88,32
RQ 68,9,16384
s_add_u32 m0, s27, 98304
Mvva 176,92,48
EX 147
Cvva 180,80,4,36
RQ 72,10,16384
DM 28,28,42,0
Mvva 180,84,20
EX 148
Mvva 180,88,36
RQ 76,11,16384
DM 29,28,42,1024
Mvva 180,92,52
EX 149
Cvva 184,80,8,40
DM 28,28,42,2048
CV 128,128,129
Mvva 184,84,24
EX 150
Mvva 184,88,40
DM 29,28,42,3072
CV 129,130,131
Mvva 184,92,56
EX 151
Cvva 188,80,12,44
s_add_u32 s42, s42, 0x4000
CV 130,144,145
Mvva 188,84,28
EX 152
Mvva 188,88,44
WL 0
s_and_b32 s42, s42, 0x1ffff
Mvva 188,92,60
EX 153
Cvva 192,64,0,32
RQ 80,8,20480
buffer_load_dword v7, v6, s[92:95], 0 offen
Mvva 192,68,16
EX 154
Mvva 192,72,32
RQ 84,9,20480
s_add_u32 s92, s92, 0x100000
s_addc_u32 s93, s93, 0
Mvva 192,76,48
EX 155
Cvva 196,64,4,36
RQ 88,10,20480
s_add_u32 s63, s63, 1
Mvva 196,68,20
EX 156
Mvva 196,72,36
RQ 92,11,20480
s_cmp_eq_u32 s63, 24
s_cselect_b64 s[92:93], s[54:55], s[92:93]
Mvva 196,76,52
EX 157
Cvva 200,64,8,40
s_cmp_ge_u32 s63, 31
s_cselect_b32 s94, 0, s94
CV 131,146,147
Mvva 200,68,24
EX 158
Mvva 200,72,40
v_lshlrev_b32 v2, 7, v1
CV 132,132,133
Mvva 200,76,56
EX 159
Cvva 204,64,12,44
s_lshl_b32 s36, s3, 13
CV 133,134,135
Mvva 204,68,28
EX 160
Mvva 204,72,44
WL 0
v_add_u32 v2, s36, v2
Mvva 204,76,60
EX 161
Cvva 208,80,0,32
RQ 64,8,24576
v_add_u32 v2, B3_ep-M1_pc, v2
Mvva 208,84,16
EX 162
Mvva 208,88,32
RQ 68,9,24576
v_min_u32 v2, M1_last-M1_pc, v2
Mvva 208,92,48
EX 163
Cvva 212,80,4,36
RQ 72,10,24576
v_add_co_u32 v2, vcc, s100, v2
Mvva 212,84,20
EX 164
Mvva 212,88,36
RQ 76,11,24576
v_mov_b32 v3, s101
Mvva 212,92,52
EX 165
Cvva 216,80,8,40
v_addc_co_u32 v3, vcc, 0, v3, vcc
CV 134,148,149
Mvva 216,84,24
EX 166
Mvva 216,88,40
global_load_dword v7, v[2:3], off
CV 135,150,151
Mvva 216,92,56
EX 167
Cvva 220,80,12,44
EX 168
Mvva 220,84,28
EX 169
Mvva 220,88,44
WL 0
CV 136,136,137
Mvva 220,92,60
EX 170
Cvva 224,64,0,32
RQ 80,8,28672
CV 137,138,139
Mvva 224,68,16
EX 171
Mvva 224,72,32
RQ 84,9,28672
CV 138,152,153
Mvva 224,76,48
EX 172
Cvva 228,64,4,36
RQ 88,10,28672
CV 139,154,155
Mvva 228,68,20
EX 173
Mvva 228,72,36
RQ 92,11,28672
CV 140,140,141
Mvva 228,76,52
EX 174
Cvva 232,64,8,40
EX 175
Mvva 232,68,24
EX 176
Mvva 232,72,40
EX 177
Mvva 232,76,56
EX 178
Cvva 236,64,12,44
EX 179
Mvva 236,68,28
EX 180
Mvva 236,72,44
WL 0
CV 141,142,143
Mvva 236,76,60
EX 181
Cvva 240,80,0,32
TR 96,16,0
CV 142,156,157
Mvva 240,84,16
EX 182
Mvva 240,88,32
TR 98,16,4096
CV 143,158,159
Mvva 240,92,48
EX 183
Cvva 244,80,4,36
TR 100,16,8192
CV 160,160,161
Mvva 244,84,20
EX 184
Mvva 244,88,36
TR 102,16,12288
CV 161,162,163
Mvva 244,92,52
EX 185
Cvva 248,80,8,40
TR 104,17,0
CV 162,176,177
Mvva 248,84,24
EX 186
Mvva 248,88,40
TR 106,17,4096
EX 187
EX 188
EX 189
EX 190
EX 191
Mvva 248,92,56
CV 163,178,179
Cvva 252,80,12,44
TR 108,17,8192
CV 164,164,165
Mvva 252,84,28
CV 165,166,167
Mvva 252,88,44
TR 110,17,12288
WL 4
CV 166,180,181
CV 167,182,183
CV 168,168,169
CV 169,170,171
CV 170,184,185
CV 171,186,187
CV 172,172,173
CV 173,174,175
CV 174,188,189
CV 175,190,191
Mvva 252,92,60
EX 192
Zavv 64,96,128
TR 112,18,0
Mavv 64,100,160
EX 193
Zavv 68,96,132
TR 114,18,4096
Mavv 68,100,164
EX 194
Zavv 72,96,136
TR 116,18,8192
Mavv 72,100,168
EX 195
Zavv 76,96,140
TR 118,18,12288
WL 4
Mavv 76,100,172
EX 196
Zavv 80,104,128
TR 120,19,0
Mavv 80,108,160
EX 197
Zavv 84,104,132
TR 122,19,4096
Mavv 84,108,164
EX 198
Zavv 88,104,136
TR 124,19,8192
Mavv 88,108,168
EX 199
Zavv 92,104,140
TR 126,19,12288
Mavv 92,108,172
EX 200
Zvvv 48,12,128
WL 4
Mvvv 48,12,160
EX 201
Zavv 96,112,128
TR 96,20,0
Mavv 96,116,160
EX 202
Zavv 100,112,132
TR 98,20,4096
Mavv 100,116,164
EX 203
Zavv 104,112,136
TR 100,20,8192
Mavv 104,116,168
EX 204
Zavv 108,112,140
TR 102,20,12288
WL 4
Mavv 108,116,172
EX 205
Zavv 112,120,128
TR 104,21,0
Mavv 112,124,160
EX 206
Zavv 116,120,132
TR 106,21,4096
Mavv 116,124,164
EX 207
Zavv 120,120,136
TR 108,21,8192
Mavv 120,124,168
EX 208
Zavv 124,120,140
TR 110,21,12288
Mavv 124,124,172
EX 209
Zvvv 52,12,132
WL 4
Mvvv 52,12,164
EX 210
Zavv 144,96,128
TR 112,22,0
Mavv 144,100,160
EX 211
Zavv 148,96,132
TR 114,22,4096
CV 192,192,193
Mavv 148,100,164
EX 212
Zavv 152,96,136
TR 116,22,8192
CV 193,194,195
Mavv 152,100,168
EX 213
Zavv 156,96,140
TR 118,22,12288
WL 4
Mavv 156,100,172
EX 214
Zavv 176,104,128
TR 120,23,0
CV 194,208,209
Mavv 176,108,160
EX 215
Zavv 180,104,132
TR 122,23,4096
CV 195,210,211
Mavv 180,108,164
EX 216
Zavv 184,104,136
TR 124,23,8192
CV 196,196,197
Mavv 184,108,168
EX 217
Zavv 188,104,140
TR 126,23,12288
CV 197,198,199
Mavv 188,108,172
EX 218
Zvvv 56,12,136
WL 4
CV 198,212,213
Mvvv 56,12,168
EX 219
Zavv 208,112,128
s_waitcnt vmcnt(6)
s_barrier
s_sub_u32 s36, s44, s45
s_cmp_lg_u32 s36, 1
s_cbranch_scc1 A1_sg0
s_cmp_lg_u32 s3, 0
s_cbranch_scc1 A1_sg0
s_mov_b64 exec, 1
v_mov_b32 v3, 1
buffer_atomic_add v3, off, s[84:87], s48 sc1
s_mov_b64 exec, -1
A1_sg0:
RQ 64,8,32768
CV 199,214,215
Mavv 208,116,160
EX 220
Zavv 212,112,132
RQ 68,9,32768
s_add_u32 m0, s27, 0
Mavv 212,116,164
EX 221
Zavv 216,112,136
RQ 72,10,32768
DM 24,20,41,0
Mavv 216,116,168
EX 222
Zavv 220,112,140
RQ 76,11,32768
WL 4
Mavv 220,116,172
EX 223
Zavv 240,120,128
DM 25,20,41,1024
CV 200,200,201
Mavv 240,124,160
EX 224
Zavv 244,120,132
DM 26,20,41,2048
CV 201,202,203
Mavv 244,124,164
EX 225
Zavv 248,120,136
DM 27,20,41,3072
CV 202,216,217
Mavv 248,124,168
EX 226
Zavv 252,120,140
s_add_u32 s41, s41, 0x4000
CV 203,218,219
Mavv 252,124,172
EX 227
Zvvv 60,12,140
WL 0
s_and_b32 s41, s41, 0x1ffff
Mvvv 60,12,172
EX 228
Cvva 128,64,0,32
RQ 80,8,36864
s_add_u32 m0, s27, 16384
Mvva 128,68,16
EX 229
Mvva 128,72,32
RQ 84,9,36864
DM 24,20,41,0
Mvva 128,76,48
EX 230
Cvva 132,64,4,36
RQ 88,10,36864
DM 25,20,41,1024
Mvva 132,68,20
EX 231
Mvva 132,72,36
RQ 92,11,36864
DM 26,20,41,2048
Mvva 132,76,52
EX 232
Cvva 136,64,8,40
DM 27,20,41,3072
CV 204,204,205
Mvva 136,68,24
EX 233
Mvva 136,72,40
s_add_u32 s41, s41, 0x4000
CV 205,206,207
Mvva 136,76,56
EX 234
Cvva 140,64,12,44
s_and_b32 s41, s41, 0x1ffff
CV 206,220,221
Mvva 140,68,28
EX 235
Mvva 140,72,44
WL 0
s_add_u32 m0, s27, 114688
Mvva 140,76,60
EX 236
Cvva 144,80,0,32
RQ 64,8,40960
DM 28,28,42,0
Mvva 144,84,16
EX 237
Mvva 144,88,32
RQ 68,9,40960
DM 29,28,42,1024
Mvva 144,92,48
EX 238
Cvva 148,80,4,36
RQ 72,10,40960
DM 28,28,42,2048
Mvva 148,84,20
EX 239
Mvva 148,88,36
RQ 76,11,40960
DM 29,28,42,3072
Mvva 148,92,52
EX 240
Cvva 152,80,8,40
s_add_u32 s42, s42, 0x4000
CV 207,222,223
Mvva 152,84,24
EX 241
Mvva 152,88,40
s_and_b32 s42, s42, 0x1ffff
Mvva 152,92,56
EX 242
Cvva 156,80,12,44
buffer_load_dword v7, v6, s[92:95], 0 offen
Mvva 156,84,28
EX 243
Mvva 156,88,44
WL 0
s_add_u32 s92, s92, 0x100000
s_addc_u32 s93, s93, 0
Mvva 156,92,60
EX 244
Cvva 160,64,0,32
RQ 80,8,45056
s_add_u32 s63, s63, 1
Mvva 160,68,16
EX 245
Mvva 160,72,32
RQ 84,9,45056
s_cmp_eq_u32 s63, 24
s_cselect_b64 s[92:93], s[54:55], s[92:93]
Mvva 160,76,48
EX 246
Cvva 164,64,4,36
RQ 88,10,45056
s_cmp_ge_u32 s63, 31
s_cselect_b32 s94, 0, s94
Mvva 164,68,20
EX 247
Mvva 164,72,36
RQ 92,11,45056
CV 224,224,225
Mvva 164,76,52
EX 248
Cvva 168,64,8,40
EX 249
Mvva 168,68,24
EX 250
Mvva 168,72,40
EX 251
Mvva 168,76,56
EX 252
Cvva 172,64,12,44
EX 253
Mvva 172,68,28
EX 254
Mvva 172,72,44
WL 0
CV 225,226,227
Mvva 172,76,60
EX 255
Cvva 176,80,0,32
TR 96,16,16384
CV 226,240,241
Mvva 176,84,16
EX 128
Mvva 176,88,32
TR 98,16,20480
CV 227,242,243
Mvva 176,92,48
CV 228,228,229
Cvva 180,80,4,36
TR 100,16,24576
CV 229,230,231
Mvva 180,84,20
CV 230,244,245
Mvva 180,88,36
TR 102,16,28672
CV 231,246,247
Mvva 180,92,52
CV 232,232,233
Cvva 184,80,8,40
TR 104,17,16384
CV 233,234,235
Mvva 184,84,24
CV 234,248,249
Mvva 184,88,40
TR 106,17,20480
CV 235,250,251
Mvva 184,92,56
CV 236,236,237
Cvva 188,80,12,44
TR 108,17,24576
CV 237,238,239
Mvva 188,84,28
CV 238,252,253
Mvva 188,88,44
TR 110,17,28672
WL 4
CV 239,254,255
Mvva 188,92,60
EX 129
Mavv 64,96,192
TR 112,18,16384
Mavv 64,100,224
EX 130
Mavv 68,96,196
TR 114,18,20480
Mavv 68,100,228
EX 131
Mavv 72,96,200
TR 116,18,24576
Mavv 72,100,232
EX 132
Mavv 76,96,204
TR 118,18,28672
WL 4
Mavv 76,100,236
EX 133
Mavv 80,104,192
TR 120,19,16384
Mavv 80,108,224
EX 134
Mavv 84,104,196
TR 122,19,20480
Mavv 84,108,228
EX 135
Mavv 88,104,200
TR 124,19,24576
Mavv 88,108,232
EX 136
Mavv 92,104,204
TR 126,19,28672
Mavv 92,108,236
EX 137
Mvvv 48,12,192
WL 4
Mvvv 48,12,224
EX 138
Mavv 96,112,192
TR 96,20,16384
Mavv 96,116,224
EX 139
Mavv 100,112,196
TR 98,20,20480
Mavv 100,116,228
EX 140
Mavv 104,112,200
TR 100,20,24576
Mavv 104,116,232
EX 141
Mavv 108,112,204
TR 102,20,28672
WL 4
Mavv 108,116,236
EX 142
Mavv 112,120,192
TR 104,21,16384
Mavv 112,124,224
EX 143
Mavv 116,120,196
TR 106,21,20480
Mavv 116,124,228
EX 144
Mavv 120,120,200
TR 108,21,24576
Mavv 120,124,232
EX 145
Mavv 124,120,204
TR 110,21,28672
Mavv 124,124,236
EX 146
Mvvv 52,12,196
WL 4
Mvvv 52,12,228
EX 147
Mavv 144,96,192
TR 112,22,16384
CV 128,128,129
Mavv 144,100,224
EX 148
Mavv 148,96,196
TR 114,22,20480
CV 129,130,131
Mavv 148,100,228
EX 149
Mavv 152,96,200
TR 116,22,24576
CV 130,144,145
Mavv 152,100,232
EX 150
Mavv 156,96,204
TR 118,22,28672
WL 4
Mavv 156,100,236
EX 151
Mavv 176,104,192
TR 120,23,16384
CV 131,146,147
Mavv 176,108,224
EX 152
Mavv 180,104,196
TR 122,23,20480
CV 132,132,133
Mavv 180,108,228
EX 153
Mavv 184,104,200
TR 124,23,24576
CV 133,134,135
Mavv 184,108,232
EX 154
Mavv 188,104,204
TR 126,23,28672
CV 134,148,149
Mavv 188,108,236
EX 155
Mvvv 56,12,200
WL 4
CV 135,150,151
Mvvv 56,12,232
EX 156
Mavv 208,112,192
s_waitcnt vmcnt(15)
s_barrier
RQ 64,8,49152
CV 136,136,137
Mavv 208,116,224
EX 157
Mavv 212,112,196
RQ 68,9,49152
s_add_u32 m0, s27, 32768
Mavv 212,116,228
EX 158
Mavv 216,112,200
RQ 72,10,49152
DM 24,20,41,0
Mavv 216,116,232
EX 159
Mavv 220,112,204
RQ 76,11,49152
WL 4
Mavv 220,116,236
EX 160
Mavv 240,120,192
DM 25,20,41,1024
CV 137,138,139
Mavv 240,124,224
EX 161
Mavv 244,120,196
DM 26,20,41,2048
CV 138,152,153
Mavv 244,124,228
EX 162
Mavv 248,120,200
DM 27,20,41,3072
CV 139,154,155
Mavv 248,124,232
EX 163
Mavv 252,120,204
s_add_u32 s41, s41, 0x4000
CV 140,140,141
Mavv 252,124,236
EX 164
Mvvv 60,12,204
WL 0
s_and_b32 s41, s41, 0x1ffff
Mvvv 60,12,236
EX 165
Cvva 192,64,0,32
RQ 80,8,53248
s_add_u32 m0, s27, 65536
Mvva 192,68,16
EX 166
Mvva 192,72,32
RQ 84,9,53248
DM 28,28,42,0
Mvva 192,76,48
EX 167
Cvva 196,64,4,36
RQ 88,10,53248
DM 29,28,42,1024
Mvva 196,68,20
EX 168
Mvva 196,72,36
RQ 92,11,53248
DM 28,28,42,2048
Mvva 196,76,52
EX 169
Cvva 200,64,8,40
DM 29,28,42,3072
CV 141,142,143
Mvva 200,68,24
EX 170
Mvva 200,72,40
s_add_u32 s42, s42, 0x4000
CV 142,156,157
Mvva 200,76,56
EX 171
Cvva 204,64,12,44
s_and_b32 s42, s42, 0x1ffff
CV 143,158,159
Mvva 204,68,28
EX 172
Mvva 204,72,44
WL 0
buffer_load_dword v7, v6, s[92:95], 0 offen
Mvva 204,76,60
EX 173
Cvva 208,80,0,32
RQ 64,8,57344
s_add_u32 s92, s92, 0x100000
s_addc_u32 s93, s93, 0
Mvva 208,84,16
EX 174
Mvva 208,88,32
RQ 68,9,57344
s_add_u32 s63, s63, 1
Mvva 208,92,48
EX 175
Cvva 212,80,4,36
RQ 72,10,57344
s_cmp_eq_u32 s63, 24
s_cselect_b64 s[92:93], s[54:55], s[92:93]
Mvva 212,84,20
EX 176
Mvva 212,88,36
RQ 76,11,57344
s_cmp_ge_u32 s63, 31
s_cselect_b32 s94, 0, s94
Mvva 212,92,52
EX 177
Cvva 216,80,8,40
EX 178
Mvva 216,84,24
EX 179
Mvva 216,88,40
EX 180
Mvva 216,92,56
EX 181
Cvva 220,80,12,44
EX 182
Mvva 220,84,28
EX 183
Mvva 220,88,44
WL 0
CV 160,160,161
Mvva 220,92,60
EX 184
Cvva 224,64,0,32
RQ 80,8,61440
CV 161,162,163
Mvva 224,68,16
EX 185
Mvva 224,72,32
RQ 84,9,61440
CV 162,176,177
Mvva 224,76,48
EX 186
Cvva 228,64,4,36
RQ 88,10,61440
CV 163,178,179
Mvva 228,68,20
EX 187
Mvva 228,72,36
RQ 92,11,61440
CV 164,164,165
Mvva 228,76,52
EX 188
Cvva 232,64,8,40
EX 189
Mvva 232,68,24
EX 190
Mvva 232,72,40
EX 191
Mvva 232,76,56
EX 192
Cvva 236,64,12,44
CV 165,166,167
Mvva 236,68,28
EX 193
Mvva 236,72,44
WL 0
CV 166,180,181
Mvva 236,76,60
EX 194
Cvva 240,80,0,32
TR 96,16,32768
CV 167,182,183
Mvva 240,84,16
EX 195
Mvva 240,88,32
TR 98,16,36864
CV 168,168,169
Mvva 240,92,48
CV 169,170,171
Cvva 244,80,4,36
TR 100,16,40960
CV 170,184,185
Mvva 244,84,20
CV 171,186,187
Mvva 244,88,36
TR 102,16,45056
CV 172,172,173
Mvva 244,92,52
CV 173,174,175
Cvva 248,80,8,40
TR 104,17,32768
CV 174,188,189
Mvva 248,84,24
CV 175,190,191
Mvva 248,88,40
TR 106,17,36864
Mvva 248,92,56
EX 196
Cvva 252,80,12,44
TR 108,17,40960
Mvva 252,84,28
EX 197
Mvva 252,88,44
TR 110,17,45056
WL 4
Mvva 252,92,60
EX 198
Mavv 64,96,128
TR 112,18,32768
Mavv 64,100,160
EX 199
Mavv 68,96,132
TR 114,18,36864
Mavv 68,100,164
EX 200
Mavv 72,96,136
TR 116,18,40960
Mavv 72,100,168
EX 201
Mavv 76,96,140
TR 118,18,45056
WL 4
Mavv 76,100,172
EX 202
Mavv 80,104,128
TR 120,19,32768
Mavv 80,108,160
EX 203
Mavv 84,104,132
TR 122,19,36864
Mavv 84,108,164
EX 204
Mavv 88,104,136
TR 124,19,40960
Mavv 88,108,168
EX 205
Mavv 92,104,140
TR 126,19,45056
Mavv 92,108,172
EX 206
Mvvv 48,12,128
WL 4
Mvvv 48,12,160
EX 207
Mavv 96,112,128
TR 96,20,32768
Mavv 96,116,160
EX 208
Mavv 100,112,132
TR 98,20,36864
Mavv 100,116,164
EX 209
Mavv 104,112,136
TR 100,20,40960
Mavv 104,116,168
EX 210
Mavv 108,112,140
TR 102,20,45056
WL 4
Mavv 108,116,172
EX 211
Mavv 112,120,128
TR 104,21,32768
CV 192,192,193
Mavv 112,124,160
EX 212
Mavv 116,120,132
TR 106,21,36864
CV 193,194,195
Mavv 116,124,164
EX 213
Mavv 120,120,136
TR 108,21,40960
CV 194,208,209
Mavv 120,124,168
EX 214
Mavv 124,120,140
TR 110,21,45056
CV 195,210,211
Mavv 124,124,172
EX 215
Mvvv 52,12,132
WL 4
CV 196,196,197
Mvvv 52,12,164
EX 216
Mavv 144,96,128
TR 112,22,32768
CV 197,198,199
Mavv 144,100,160
EX 217
Mavv 148,96,132
TR 114,22,36864
CV 198,212,213
Mavv 148,100,164
EX 218
Mavv 152,96,136
TR 116,22,40960
CV 199,214,215
Mavv 152,100,168
EX 219
Mavv 156,96,140
TR 118,22,45056
WL 4
Mavv 156,100,172
EX 220
Mavv 176,104,128
TR 120,23,32768
CV 200,200,201
Mavv 176,108,160
EX 221
Mavv 180,104,132
TR 122,23,36864
CV 201,202,203
Mavv 180,108,164
EX 222
Mavv 184,104,136
TR 124,23,40960
CV 202,216,217
Mavv 184,108,168
EX 223
Mavv 188,104,140
TR 126,23,45056
CV 203,218,219
Mavv 188,108,172
EX 224
Mvvv 56,12,136
WL 4
CV 204,204,205
Mvvv 56,12,168
EX 225
Mavv 208,112,128
s_waitcnt vmcnt(10)
s_barrier
RQ 64,8,0
CV 205,206,207
Mavv 208,116,160
EX 226
Mavv 212,112,132
RQ 68,9,0
s_add_u32 m0, s27, 49152
Mavv 212,116,164
EX 227
Mavv 216,112,136
RQ 72,10,0
DM 24,20,41,0
Mavv 216,116,168
EX 228
Mavv 220,112,140
RQ 76,11,0
WL 4
Mavv 220,116,172
EX 229
Mavv 240,120,128
DM 25,20,41,1024
CV 206,220,221
Mavv 240,124,160
EX 230
Mavv 244,120,132
DM 26,20,41,2048
CV 207,222,223
Mavv 244,124,164
EX 231
Mavv 248,120,136
DM 27,20,41,3072
Mavv 248,124,168
EX 232
Mavv 252,120,140
s_add_u32 s41, s41, 0x4000
Mavv 252,124,172
EX 233
Mvvv 60,12,140
WL 0
s_and_b32 s41, s41, 0x1ffff
Mvvv 60,12,172
EX 234
Cvva 128,64,0,32
RQ 80,8,4096
s_add_u32 m0, s27, 81920
Mvva 128,68,16
EX 235
Mvva 128,72,32
RQ 84,9,4096
DM 28,28,42,0
Mvva 128,76,48
EX 236
Cvva 132,64,4,36
RQ 88,10,4096
DM 29,28,42,1024
Mvva 132,68,20
EX 237
Mvva 132,72,36
RQ 92,11,4096
DM 28,28,42,2048
Mvva 132,76,52
EX 238
Cvva 136,64,8,40
DM 29,28,42,3072
Mvva 136,68,24
EX 239
Mvva 136,72,40
s_add_u32 s42, s42, 0x4000
Mvva 136,76,56
EX 240
Cvva 140,64,12,44
s_and_b32 s42, s42, 0x1ffff
Mvva 140,68,28
EX 241
Mvva 140,72,44
WL 0
buffer_load_dword v7, v6, s[92:95], 0 offen
Mvva 140,76,60
EX 242
Cvva 144,80,0,32
RQ 64,8,8192
s_add_u32 s92, s92, 0x100000
s_addc_u32 s93, s93, 0
Mvva 144,84,16
EX 243
Mvva 144,88,32
RQ 68,9,8192
s_add_u32 s63, s63, 1
Mvva 144,92,48
EX 244
Cvva 148,80,4,36
RQ 72,10,8192
s_cmp_eq_u32 s63, 24
s_cselect_b64 s[92:93], s[54:55], s[92:93]
Mvva 148,84,20
EX 245
Mvva 148,88,36
RQ 76,11,8192
s_cmp_ge_u32 s63, 31
s_cselect_b32 s94, 0, s94
Mvva 148,92,52
EX 246
Cvva 152,80,8,40
EX 247
Mvva 152,84,24
EX 248
Mvva 152,88,40
EX 249
Mvva 152,92,56
EX 250
Cvva 156,80,12,44
EX 251
Mvva 156,84,28
EX 252
Mvva 156,88,44
WL 0
CV 224,224,225
Mvva 156,92,60
EX 253
Cvva 160,64,0,32
RQ 80,8,12288
CV 225,226,227
Mvva 160,68,16
EX 254
Mvva 160,72,32
RQ 84,9,12288
CV 226,240,241
Mvva 160,76,48
EX 255
Cvva 164,64,4,36
RQ 88,10,12288
CV 227,242,243
Mvva 164,68,20
EX 128
Mvva 164,72,36
RQ 92,11,12288
CV 228,228,229
Mvva 164,76,52
EX 129
Cvva 168,64,8,40
CV 229,230,231
Mvva 168,68,24
EX 130
Mvva 168,72,40
CV 230,244,245
Mvva 168,76,56
EX 131
Cvva 172,64,12,44
CV 231,246,247
Mvva 172,68,28
EX 132
Mvva 172,72,44
WL 0
CV 232,232,233
Mvva 172,76,60
EX 133
Cvva 176,80,0,32
TR 96,16,49152
CV 233,234,235
Mvva 176,84,16
EX 134
Mvva 176,88,32
TR 98,16,53248
CV 234,248,249
Mvva 176,92,48
CV 235,250,251
Cvva 180,80,4,36
TR 100,16,57344
CV 236,236,237
Mvva 180,84,20
CV 237,238,239
Mvva 180,88,36
TR 102,16,61440
CV 238,252,253
Mvva 180,92,52
CV 239,254,255
Cvva 184,80,8,40
TR 104,17,49152
Mvva 184,84,24
EX 135
Mvva 184,88,40
TR 106,17,53248
Mvva 184,92,56
EX 136
Cvva 188,80,12,44
TR 108,17,57344
Mvva 188,84,28
EX 137
Mvva 188,88,44
TR 110,17,61440
WL 4
Mvva 188,92,60
EX 138
Mavv 64,96,192
TR 112,18,49152
Mavv 64,100,224
EX 139
Mavv 68,96,196
TR 114,18,53248
Mavv 68,100,228
EX 140
Mavv 72,96,200
TR 116,18,57344
Mavv 72,100,232
EX 141
Mavv 76,96,204
TR 118,18,61440
WL 4
Mavv 76,100,236
EX 142
Mavv 80,104,192
TR 120,19,49152
Mavv 80,108,224
EX 143
Mavv 84,104,196
TR 122,19,53248
Mavv 84,108,228
EX 144
Mavv 88,104,200
TR 124,19,57344
Mavv 88,108,232
EX 145
Mavv 92,104,204
TR 126,19,61440
Mavv 92,108,236
EX 146
Mvvv 48,12,192
WL 4
Mvvv 48,12,224
EX 147
Mavv 96,112,192
TR 96,20,49152
CV 128,128,129
Mavv 96,116,224
EX 148
Mavv 100,112,196
TR 98,20,53248
CV 129,130,131
Mavv 100,116,228
EX 149
Mavv 104,112,200
TR 100,20,57344
CV 130,144,145
Mavv 104,116,232
EX 150
Mavv 108,112,204
TR 102,20,61440
WL 4
Mavv 108,116,236
EX 151
Mavv 112,120,192
TR 104,21,49152
CV 131,146,147
Mavv 112,124,224
EX 152
Mavv 116,120,196
TR 106,21,53248
CV 132,132,133
Mavv 116,124,228
EX 153
Mavv 120,120,200
TR 108,21,57344
CV 133,134,135
Mavv 120,124,232
EX 154
Mavv 124,120,204
TR 110,21,61440
CV 134,148,149
Mavv 124,124,236
EX 155
Mvvv 52,12,196
WL 4
CV 135,150,151
Mvvv 52,12,228
EX 156
Mavv 144,96,192
TR 112,22,49152
CV 136,136,137
Mavv 144,100,224
EX 157
Mavv 148,96,196
TR 114,22,53248
CV 137,138,139
Mavv 148,100,228
EX 158
Mavv 152,96,200
TR 116,22,57344
CV 138,152,153
Mavv 152,100,232
EX 159
Mavv 156,96,204
TR 118,22,61440
WL 4
Mavv 156,100,236
EX 160
Mavv 176,104,192
TR 120,23,49152
CV 139,154,155
Mavv 176,108,224
EX 161
Mavv 180,104,196
TR 122,23,53248
CV 140,140,141
Mavv 180,108,228
EX 162
Mavv 184,104,200
TR 124,23,57344
CV 141,142,143
Mavv 184,108,232
EX 163
Mavv 188,104,204
TR 126,23,61440
CV 142,156,157
Mavv 188,108,236
EX 164
Mvvv 56,12,200
WL 4
CV 143,158,159
Mvvv 56,12,232
EX 165
Mavv 208,112,192
s_waitcnt vmcnt(10)
s_barrier
RQ 64,8,16384
Mavv 208,116,224
EX 166
Mavv 212,112,196
RQ 68,9,16384
s_cmp_lg_u32 s44, 0
s_cselect_b32 s22, 0, 0x20000
Mavv 212,116,228
EX 167
Mavv 216,112,200
RQ 72,10,16384
s_add_u32 m0, s27, 0
Mavv 216,116,232
EX 168
Mavv 220,112,204
RQ 76,11,16384
WL 4
Mavv 220,116,236
EX 169
Mavv 240,120,192
DM 24,20,41,0
Mavv 240,124,224
EX 170
Mavv 244,120,196
DM 25,20,41,1024
Mavv 244,124,228
EX 171
Mavv 248,120,200
DM 26,20,41,2048
Mavv 248,124,232
EX 172
Mavv 252,120,204
DM 27,20,41,3072
Mavv 252,124,236
EX 173
Mvvv 60,12,204
WL 0
s_add_u32 s41, s41, 0x4000
Mvvv 60,12,236
EX 174
Cvva 192,64,0,32
RQ 80,8,20480
s_and_b32 s41, s41, 0x1ffff
Mvva 192,68,16
EX 175
Mvva 192,72,32
RQ 84,9,20480
s_add_u32 m0, s27, 98304
Mvva 192,76,48
EX 176
Cvva 196,64,4,36
RQ 88,10,20480
DM 28,28,42,0
Mvva 196,68,20
EX 177
Mvva 196,72,36
RQ 92,11,20480
DM 29,28,42,1024
Mvva 196,76,52
EX 178
Cvva 200,64,8,40
DM 28,28,42,2048
Mvva 200,68,24
EX 179
Mvva 200,72,40
DM 29,28,42,3072
CV 160,160,161
Mvva 200,76,56
EX 180
Cvva 204,64,12,44
s_add_u32 s42, s42, 0x4000
CV 161,162,163
Mvva 204,68,28
EX 181
Mvva 204,72,44
WL 0
s_and_b32 s42, s42, 0x1ffff
Mvva 204,76,60
EX 182
Cvva 208,80,0,32
RQ 64,8,24576
buffer_load_dword v7, v6, s[92:95], 0 offen
Mvva 208,84,16
EX 183
Mvva 208,88,32
RQ 68,9,24576
s_add_u32 s92, s92, 0x100000
s_addc_u32 s93, s93, 0
Mvva 208,92,48
EX 184
Cvva 212,80,4,36
RQ 72,10,24576
s_add_u32 s63, s63, 1
Mvva 212,84,20
EX 185
Mvva 212,88,36
RQ 76,11,24576
s_cmp_eq_u32 s63, 24
s_cselect_b64 s[92:93], s[54:55], s[92:93]
Mvva 212,92,52
EX 186
Cvva 216,80,8,40
s_cmp_ge_u32 s63, 31
s_cselect_b32 s94, 0, s94
CV 162,176,177
Mvva 216,84,24
EX 187
Mvva 216,88,40
EX 188
Mvva 216,92,56
EX 189
Cvva 220,80,12,44
EX 190
Mvva 220,84,28
EX 191
Mvva 220,88,44
WL 0
CV 163,178,179
Mvva 220,92,60
EX 192
Cvva 224,64,0,32
RQ 80,8,28672
CV 164,164,165
Mvva 224,68,16
EX 193
Mvva 224,72,32
RQ 84,9,28672
CV 165,166,167
Mvva 224,76,48
EX 194
Cvva 228,64,4,36
RQ 88,10,28672
CV 166,180,181
Mvva 228,68,20
EX 195
Mvva 228,72,36
RQ 92,11,28672
CV 167,182,183
Mvva 228,76,52
EX 196
Cvva 232,64,8,40
CV 168,168,169
Mvva 232,68,24
EX 197
Mvva 232,72,40
CV 169,170,171
Mvva 232,76,56
EX 198
Cvva 236,64,12,44
CV 170,184,185
Mvva 236,68,28
EX 199
Mvva 236,72,44
WL 0
CV 171,186,187
Mvva 236,76,60
EX 200
Cvva 240,80,0,32
TR 96,16,0
CV 172,172,173
Mvva 240,84,16
EX 201
Mvva 240,88,32
TR 98,16,4096
CV 173,174,175
Mvva 240,92,48
CV 174,188,189
Cvva 244,80,4,36
TR 100,16,8192
CV 175,190,191
Mvva 244,84,20
EX 202
Mvva 244,88,36
TR 102,16,12288
Mvva 244,92,52
EX 203
Cvva 248,80,8,40
TR 104,17,0
Mvva 248,84,24
EX 204
Mvva 248,88,40
TR 106,17,4096
Mvva 248,92,56
EX 205
Cvva 252,80,12,44
TR 108,17,8192
Mvva 252,84,28
EX 206
Mvva 252,88,44
TR 110,17,12288
WL 4
Mvva 252,92,60
EX 207
Mavv 64,96,128
TR 112,18,0
Mavv 64,100,160
EX 208
Mavv 68,96,132
TR 114,18,4096
Mavv 68,100,164
EX 209
Mavv 72,96,136
TR 116,18,8192
Mavv 72,100,168
EX 210
Mavv 76,96,140
TR 118,18,12288
WL 4
Mavv 76,100,172
EX 211
Mavv 80,104,128
TR 120,19,0
CV 192,192,193
Mavv 80,108,160
EX 212
Mavv 84,104,132
TR 122,19,4096
CV 193,194,195
Mavv 84,108,164
EX 213
Mavv 88,104,136
TR 124,19,8192
CV 194,208,209
Mavv 88,108,168
EX 214
Mavv 92,104,140
TR 126,19,12288
CV 195,210,211
Mavv 92,108,172
EX 215
Mvvv 48,12,128
WL 4
CV 196,196,197
Mvvv 48,12,160
EX 216
Mavv 96,112,128
TR 96,20,0
CV 197,198,199
Mavv 96,116,160
EX 217
Mavv 100,112,132
TR 98,20,4096
CV 198,212,213
Mavv 100,116,164
EX 218
Mavv 104,112,136
TR 100,20,8192
CV 199,214,215
Mavv 104,116,168
EX 219
Mavv 108,112,140
TR 102,20,12288
WL 4
Mavv 108,116,172
EX 220
Mavv 112,120,128
TR 104,21,0
CV 200,200,201
Mavv 112,124,160
EX 221
Mavv 116,120,132
TR 106,21,4096
CV 201,202,203
Mavv 116,124,164
EX 222
Mavv 120,120,136
TR 108,21,8192
CV 202,216,217
Mavv 120,124,168
EX 223
Mavv 124,120,140
TR 110,21,12288
CV 203,218,219
Mavv 124,124,172
EX 224
Mvvv 52,12,132
WL 4
CV 204,204,205
Mvvv 52,12,164
EX 225
Mavv 144,96,128
TR 112,22,0
CV 205,206,207
Mavv 144,100,160
EX 226
Mavv 148,96,132
TR 114,22,4096
CV 206,220,221
Mavv 148,100,164
EX 227
Mavv 152,96,136
TR 116,22,8192
CV 207,222,223
Mavv 152,100,168
Mavv 156,96,140
TR 118,22,12288
WL 4
Mavv 156,100,172
EX 228
Mavv 176,104,128
TR 120,23,0
Mavv 176,108,160
EX 229
Mavv 180,104,132
TR 122,23,4096
Mavv 180,108,164
EX 230
Mavv 184,104,136
TR 124,23,8192
Mavv 184,108,168
EX 231
Mavv 188,104,140
TR 126,23,12288
Mavv 188,108,172
EX 232
Mvvv 56,12,136
WL 4
Mvvv 56,12,168
EX 233
Mavv 208,112,128
s_waitcnt vmcnt(10)
s_barrier
RQ 64,8,32768
Mavv 208,116,160
EX 234
Mavv 212,112,132
RQ 68,9,32768
s_add_u32 m0, s27, 16384
Mavv 212,116,164
EX 235
Mavv 216,112,136
RQ 72,10,32768
DM 24,20,41,0
Mavv 216,116,168
EX 236
Mavv 220,112,140
RQ 76,11,32768
WL 4
Mavv 220,116,172
EX 237
Mavv 240,120,128
DM 25,20,41,1024
Mavv 240,124,160
EX 238
Mavv 244,120,132
DM 26,20,41,2048
Mavv 244,124,164
EX 239
Mavv 248,120,136
DM 27,20,41,3072
Mavv 248,124,168
EX 240
Mavv 252,120,140
s_add_u32 s41, s41, 0x4000
Mavv 252,124,172
EX 241
Mvvv 60,12,140
WL 0
s_and_b32 s41, s41, 0x1ffff
Mvvv 60,12,172
Cvva 128,64,0,32
RQ 80,8,36864
s_add_u32 m0, s27, 114688
Mvva 128,68,16
EX 242
Mvva 128,72,32
RQ 84,9,36864
DM 28,28,42,0
Mvva 128,76,48
EX 243
Cvva 132,64,4,36
RQ 88,10,36864
DM 29,28,42,1024
Mvva 132,68,20
EX 244
Mvva 132,72,36
RQ 92,11,36864
DM 28,28,42,2048
Mvva 132,76,52
EX 245
Cvva 136,64,8,40
DM 29,28,42,3072
CV 224,224,225
Mvva 136,68,24
EX 246
Mvva 136,72,40
s_add_u32 s42, s42, 0x4000
CV 225,226,227
Mvva 136,76,56
EX 247
Cvva 140,64,12,44
s_and_b32 s42, s42, 0x1ffff
CV 226,240,241
Mvva 140,68,28
EX 248
Mvva 140,72,44
WL 0
buffer_load_dword v7, v6, s[92:95], 0 offen
Mvva 140,76,60
EX 249
Cvva 144,80,0,32
RQ 64,8,40960
s_add_u32 s92, s92, 0x100000
s_addc_u32 s93, s93, 0
Mvva 144,84,16
EX 250
Mvva 144,88,32
RQ 68,9,40960
s_add_u32 s63, s63, 1
Mvva 144,92,48
EX 251
Cvva 148,80,4,36
RQ 72,10,40960
s_cmp_eq_u32 s63, 24
s_cselect_b64 s[92:93], s[54:55], s[92:93]
Mvva 148,84,20
EX 252
Mvva 148,88,36
RQ 76,11,40960
s_cmp_ge_u32 s63, 31
s_cselect_b32 s94, 0, s94
Mvva 148,92,52
EX 253
Cvva 152,80,8,40
CV 227,242,243
Mvva 152,84,24
EX 254
Mvva 152,88,40
CV 228,228,229
Mvva 152,92,56
EX 255
Cvva 156,80,12,44
CV 229,230,231
Mvva 156,84,28
EX 128
Mvva 156,88,44
WL 0
CV 230,244,245
Mvva 156,92,60
EX 129
Cvva 160,64,0,32
RQ 80,8,45056
CV 231,246,247
Mvva 160,68,16
EX 130
Mvva 160,72,32
RQ 84,9,45056
CV 232,232,233
Mvva 160,76,48
EX 131
Cvva 164,64,4,36
RQ 88,10,45056
CV 233,234,235
Mvva 164,68,20
EX 132
Mvva 164,72,36
RQ 92,11,45056
CV 234,248,249
Mvva 164,76,52
EX 133
Cvva 168,64,8,40
CV 235,250,251
Mvva 168,68,24
EX 134
Mvva 168,72,40
CV 236,236,237
Mvva 168,76,56
EX 135
Cvva 172,64,12,44
CV 237,238,239
Mvva 172,68,28
EX 136
Mvva 172,72,44
WL 0
CV 238,252,253
Mvva 172,76,60
EX 137
Cvva 176,80,0,32
TR 96,16,16384
CV 239,254,255
Mvva 176,84,16
EX 138
Mvva 176,88,32
TR 98,16,20480
Mvva 176,92,48
EX 139
Cvva 180,80,4,36
TR 100,16,24576
Mvva 180,84,20
EX 140
Mvva 180,88,36
TR 102,16,28672
Mvva 180,92,52
EX 141
Cvva 184,80,8,40
TR 104,17,16384
Mvva 184,84,24
EX 142
Mvva 184,88,40
TR 106,17,20480
Mvva 184,92,56
EX 143
Cvva 188,80,12,44
TR 108,17,24576
Mvva 188,84,28
EX 144
Mvva 188,88,44
TR 110,17,28672
WL 4
Mvva 188,92,60
EX 145
Mavv 64,96,192
TR 112,18,16384
Mavv 64,100,224
Mavv 68,96,196
TR 114,18,20480
Mavv 68,100,228
EX 146
Mavv 72,96,200
TR 116,18,24576
Mavv 72,100,232
EX 147
Mavv 76,96,204
TR 118,18,28672
WL 4
Mavv 76,100,236
EX 148
Mavv 80,104,192
TR 120,19,16384
CV 128,128,129
Mavv 80,108,224
EX 149
Mavv 84,104,196
TR 122,19,20480
CV 129,130,131
Mavv 84,108,228
EX 150
Mavv 88,104,200
TR 124,19,24576
CV 130,144,145
Mavv 88,108,232
EX 151
Mavv 92,104,204
TR 126,19,28672
CV 131,146,147
Mavv 92,108,236
EX 152
Mvvv 48,12,192
WL 4
CV 132,132,133
Mvvv 48,12,224
EX 153
Mavv 96,112,192
TR 96,20,16384
CV 133,134,135
Mavv 96,116,224
EX 154
Mavv 100,112,196
TR 98,20,20480
CV 134,148,149
Mavv 100,116,228
EX 155
Mavv 104,112,200
TR 100,20,24576
CV 135,150,151
Mavv 104,116,232
EX 156
Mavv 108,112,204
TR 102,20,28672
WL 4
Mavv 108,116,236
EX 157
Mavv 112,120,192
TR 104,21,16384
CV 136,136,137
Mavv 112,124,224
Mavv 116,120,196
TR 106,21,20480
CV 137,138,139
Mavv 116,124,228
EX 158
Mavv 120,120,200
TR 108,21,24576
CV 138,152,153
Mavv 120,124,232
EX 159
Mavv 124,120,204
TR 110,21,28672
CV 139,154,155
Mavv 124,124,236
EX 160
Mvvv 52,12,196
WL 4
CV 140,140,141
Mvvv 52,12,228
EX 161
Mavv 144,96,192
TR 112,22,16384
CV 141,142,143
Mavv 144,100,224
EX 162
Mavv 148,96,196
TR 114,22,20480
CV 142,156,157
Mavv 148,100,228
EX 163
Mavv 152,96,200
TR 116,22,24576
CV 143,158,159
Mavv 152,100,232
EX 164
Mavv 156,96,204
TR 118,22,28672
WL 4
Mavv 156,100,236
EX 165
Mavv 176,104,192
TR 120,23,16384
Mavv 176,108,224
EX 166
Mavv 180,104,196
TR 122,23,20480
Mavv 180,108,228
EX 167
Mavv 184,104,200
TR 124,23,24576
Mavv 184,108,232
EX 168
Mavv 188,104,204
TR 126,23,28672
Mavv 188,108,236
Mvvv 56,12,200
WL 4
Mvvv 56,12,232
EX 169
Mavv 208,112,192
s_waitcnt vmcnt(10)
s_barrier
RQ 64,8,49152
Mavv 208,116,224
EX 170
Mavv 212,112,196
RQ 68,9,49152
s_cmp_lg_u32 s44, 0
s_cselect_b32 s30, 0, 0x20000
Mavv 212,116,228
EX 171
Mavv 216,112,200
RQ 72,10,49152
s_add_u32 m0, s27, 65536
Mavv 216,116,232
EX 172
Mavv 220,112,204
RQ 76,11,49152
WL 4
Mavv 220,116,236
EX 173
Mavv 240,120,192
DM 28,28,42,0
Mavv 240,124,224
EX 174
Mavv 244,120,196
DM 29,28,42,1024
Mavv 244,124,228
EX 175
Mavv 248,120,200
DM 28,28,42,2048
Mavv 248,124,232
EX 176
Mavv 252,120,204
DM 29,28,42,3072
Mavv 252,124,236
EX 177
Mvvv 60,12,204
WL 0
s_add_u32 s42, s42, 0x4000
Mvvv 60,12,236
EX 178
Cvva 192,64,0,32
RQ 80,8,53248
s_and_b32 s42, s42, 0x1ffff
Mvva 192,68,16
EX 179
Mvva 192,72,32
RQ 84,9,53248
buffer_load_dword v7, v6, s[92:95], 0 offen
Mvva 192,76,48
EX 180
Cvva 196,64,4,36
RQ 88,10,53248
s_add_u32 s92, s92, 0x100000
s_addc_u32 s93, s93, 0
Mvva 196,68,20
Mvva 196,72,36
RQ 92,11,53248
s_add_u32 s63, s63, 1
Mvva 196,76,52
EX 181
Cvva 200,64,8,40
s_cmp_eq_u32 s63, 24
s_cselect_b64 s[92:93], s[54:55], s[92:93]
CV 160,160,161
Mvva 200,68,24
EX 182
Mvva 200,72,40
s_cmp_ge_u32 s63, 31
s_cselect_b32 s94, 0, s94
CV 161,162,163
Mvva 200,76,56
EX 183
Cvva 204,64,12,44
v_lshlrev_b32 v2, 7, v1
CV 162,176,177
Mvva 204,68,28
EX 184
Mvva 204,72,44
WL 0
s_lshl_b32 s36, s3, 13
Mvva 204,76,60
EX 185
Cvva 208,80,0,32
RQ 64,8,57344
v_add_u32 v2, s36, v2
Mvva 208,84,16
EX 186
Mvva 208,88,32
RQ 68,9,57344
v_add_u32 v2, A1_chk-M1_pc, v2
Mvva 208,92,48
EX 187
Cvva 212,80,4,36
RQ 72,10,57344
v_min_u32 v2, M1_last-M1_pc, v2
Mvva 212,84,20
EX 188
Mvva 212,88,36
RQ 76,11,57344
v_add_co_u32 v2, vcc, s100, v2
Mvva 212,92,52
EX 189
Cvva 216,80,8,40
v_mov_b32 v3, s101
CV 163,178,179
Mvva 216,84,24
EX 190
Mvva 216,88,40
v_addc_co_u32 v3, vcc, 0, v3, vcc
CV 164,164,165
Mvva 216,92,56
EX 191
Cvva 220,80,12,44
global_load_dword v7, v[2:3], off
CV 165,166,167
Mvva 220,84,28
EX 192
Mvva 220,88,44
WL 0
CV 166,180,181
Mvva 220,92,60
EX 193
Cvva 224,64,0,32
RQ 80,8,61440
CV 167,182,183
Mvva 224,68,16
EX 194
Mvva 224,72,32
RQ 84,9,61440
CV 168,168,169
Mvva 224,76,48
EX 195
Cvva 228,64,4,36
RQ 88,10,61440
CV 169,170,171
Mvva 228,68,20
EX 196
Mvva 228,72,36
RQ 92,11,61440
CV 170,184,185
Mvva 228,76,52
EX 197
Cvva 232,64,8,40
CV 171,186,187
Mvva 232,68,24
EX 198
Mvva 232,72,40
CV 172,172,173
Mvva 232,76,56
EX 199
Cvva 236,64,12,44
CV 173,174,175
Mvva 236,68,28
EX 200
Mvva 236,72,44
WL 0
CV 174,188,189
Mvva 236,76,60
EX 201
Cvva 240,80,0,32
TR 96,16,32768
CV 175,190,191
Mvva 240,84,16
EX 202
Mvva 240,88,32
TR 98,16,36864
Mvva 240,92,48
EX 203
Cvva 244,80,4,36
TR 100,16,40960
Mvva 244,84,20
EX 204
Mvva 244,88,36
TR 102,16,45056
Mvva 244,92,52
EX 205
Cvva 248,80,8,40
TR 104,17,32768
Mvva 248,84,24
EX 206
Mvva 248,88,40
TR 106,17,36864
Mvva 248,92,56
EX 207
Cvva 252,80,12,44
TR 108,17,40960
Mvva 252,84,28
EX 208
Mvva 252,88,44
TR 110,17,45056
WL 4
Mvva 252,92,60
EX 209
Mavv 64,96,128
TR 112,18,32768
Mavv 64,100,160
EX 210
Mavv 68,96,132
TR 114,18,36864
Mavv 68,100,164
EX 211
Mavv 72,96,136
TR 116,18,40960
CV 192,192,193
Mavv 72,100,168
EX 212
Mavv 76,96,140
TR 118,18,45056
WL 4
Mavv 76,100,172
EX 213
Mavv 80,104,128
TR 120,19,32768
CV 193,194,195
Mavv 80,108,160
EX 214
Mavv 84,104,132
TR 122,19,36864
CV 194,208,209
Mavv 84,108,164
EX 215
Mavv 88,104,136
TR 124,19,40960
CV 195,210,211
Mavv 88,108,168
EX 216
Mavv 92,104,140
TR 126,19,45056
CV 196,196,197
Mavv 92,108,172
EX 217
Mvvv 48,12,128
WL 4
CV 197,198,199
Mvvv 48,12,160
EX 218
Mavv 96,112,128
TR 96,20,32768
CV 198,212,213
Mavv 96,116,160
EX 219
Mavv 100,112,132
TR 98,20,36864
CV 199,214,215
Mavv 100,116,164
Mavv 104,112,136
TR 100,20,40960
CV 200,200,201
Mavv 104,116,168
EX 220
Mavv 108,112,140
TR 102,20,45056
WL 4
Mavv 108,116,172
EX 221
Mavv 112,120,128
TR 104,21,32768
CV 201,202,203
Mavv 112,124,160
EX 222
Mavv 116,120,132
TR 106,21,36864
CV 202,216,217
Mavv 116,124,164
EX 223
Mavv 120,120,136
TR 108,21,40960
CV 203,218,219
Mavv 120,124,168
EX 224
Mavv 124,120,140
TR 110,21,45056
CV 204,204,205
Mavv 124,124,172
EX 225
Mvvv 52,12,132
WL 4
CV 205,206,207
Mvvv 52,12,164
EX 226
Mavv 144,96,128
TR 112,22,32768
CV 206,220,221
Mavv 144,100,160
EX 227
Mavv 148,96,132
TR 114,22,36864
CV 207,222,223
Mavv 148,100,164
EX 228
Mavv 152,96,136
TR 116,22,40960
Mavv 152,100,168
EX 229
Mavv 156,96,140
TR 118,22,45056
WL 4
Mavv 156,100,172
EX 230
Mavv 176,104,128
TR 120,23,32768
Mavv 176,108,160
EX 231
Mavv 180,104,132
TR 122,23,36864
Mavv 180,108,164
EX 232
Mavv 184,104,136
TR 124,23,40960
Mavv 184,108,168
EX 233
Mavv 188,104,140
TR 126,23,45056
Mavv 188,108,172
EX 234
Mvvv 56,12,136
WL 4
Mvvv 56,12,168
EX 235
Mavv 208,112,128
s_waitcnt vmcnt(7)
s_barrier
TR 96,16,49152
Mavv 208,116,160
EX 236
Mavv 212,112,132
TR 98,16,53248
buffer_load_dword v7, v6, s[92:95], 0 offen
Mavv 212,116,164
EX 237
Mavv 216,112,136
TR 100,17,49152
s_add_u32 s92, s92, 0x100000
s_addc_u32 s93, s93, 0
Mavv 216,116,168
Mavv 220,112,140
TR 102,17,53248
WL 4
Mavv 220,116,172
EX 238
Mavv 240,120,128
TR 104,18,49152
s_add_u32 s63, s63, 1
Mavv 240,124,160
EX 239
Mavv 244,120,132
TR 106,18,53248
s_cmp_eq_u32 s63, 24
s_cselect_b64 s[92:93], s[54:55], s[92:93]
Mavv 244,124,164
EX 240
Mavv 248,120,136
TR 108,19,49152
s_cmp_ge_u32 s63, 31
s_cselect_b32 s94, 0, s94
Mavv 248,124,168
EX 241
Mavv 252,120,140
TR 110,19,53248
buffer_load_dword v5, off, s[84:87], s50 sc1
Mavv 252,124,172
EX 242
Mvvv 60,12,140
WL 6
Mvvv 60,12,172
EX 243
Mavv 64,96,192
TR 112,20,49152
CV 224,224,225
Mavv 68,96,196
EX 244
Mavv 72,96,200
TR 114,20,53248
WL 6
Mavv 76,96,204
EX 245
Mavv 80,100,192
TR 116,21,49152
CV 225,226,227
Mavv 84,100,196
EX 246
Mavv 88,100,200
TR 118,21,53248
CV 226,240,241
Mavv 92,100,204
WL 6
CV 227,242,243
Mvvv 48,12,192
EX 247
Mavv 96,104,192
TR 120,22,49152
CV 228,228,229
Mavv 100,104,196
EX 248
Mavv 104,104,200
TR 122,22,53248
WL 6
Mavv 108,104,204
EX 249
Mavv 112,108,192
TR 124,23,49152
CV 229,230,231
Mavv 116,108,196
EX 250
Mavv 120,108,200
TR 126,23,53248
CV 230,244,245
Mavv 124,108,204
WL 6
CV 231,246,247
Mvvv 52,12,196
EX 251
Mavv 144,112,192
TR 96,16,57344
CV 232,232,233
Mavv 148,112,196
EX 252
Mavv 152,112,200
TR 98,16,61440
WL 6
Mavv 156,112,204
EX 253
Mavv 176,116,192
TR 100,17,57344
CV 233,234,235
Mavv 180,116,196
EX 254
Mavv 184,116,200
TR 102,17,61440
CV 234,248,249
Mavv 188,116,204
WL 6
CV 235,250,251
Mvvv 56,12,200
EX 255
Mavv 208,120,192
TR 104,18,57344
CV 236,236,237
Mavv 212,120,196
CV 237,238,239
Mavv 216,120,200
TR 106,18,61440
WL 6
Mavv 220,120,204
CV 238,252,253
Mavv 240,124,192
TR 108,19,57344
CV 239,254,255
Mavv 244,124,196
Mavv 248,124,200
TR 110,19,61440
Mavv 252,124,204
WL 6
Mvvv 60,12,204
Mavv 64,96,224
TR 112,20,57344
Mavv 68,96,228
Mavv 72,96,232
TR 114,20,61440
WL 6
Mavv 76,96,236
Mavv 80,100,224
TR 116,21,57344
Mavv 84,100,228
Mavv 88,100,232
TR 118,21,61440
Mavv 92,100,236
WL 6
Mvvv 48,12,224
Mavv 96,104,224
TR 120,22,57344
Mavv 100,104,228
Mavv 104,104,232
TR 122,22,61440
WL 6
Mavv 108,104,236
Mavv 112,108,224
TR 124,23,57344
Mavv 116,108,228
Mavv 120,108,232
TR 126,23,61440
Mavv 124,108,236
WL 6
Mvvv 52,12,228
Mavv 144,112,224
Mavv 148,112,228
Mavv 152,112,232
WL 4
Mavv 156,112,236
Mavv 176,116,224
Mavv 180,116,228
Mavv 184,116,232
Mavv 188,116,236
WL 2
Mvvv 56,12,232
Mavv 208,120,224
Mavv 212,120,228
Mavv 216,120,232
WL 0
Mavv 220,120,236
Mavv 240,124,224
Mavv 244,124,228
Mavv 248,124,232
Mavv 252,124,236
Mvvv 60,12,236
A1_chk:
s_nop 7
s_mov_b32 s36, 0x53800000
v_cmp_nlt_f32 s[46:47], v48, s36
v_cmp_nlt_f32 vcc, v52, s36
s_nop 0
s_or_b64 s[46:47], s[46:47], vcc
v_cmp_nlt_f32 vcc, v56, s36
s_nop 0
s_or_b64 s[46:47], s[46:47], vcc
v_cmp_nlt_f32 vcc, v60, s36
s_nop 0
s_or_b64 s[46:47], s[46:47], vcc
s_cmp_lg_u64 s[46:47], 0
s_cselect_b32 s36, 1, 0
v_mov_b32 v2, s36
ds_write_b32 v31, v2
RC 48
RC 52
RC 56
RC 60
v_mov_b32 v2, 0x20000
WL 0
s_barrier
ds_read_b128 v[192:195], v2
v_mov_b32 v49, v48
v_mov_b32 v53, v52
v_mov_b32 v57, v56
v_mov_b32 v61, v60
s_add_u32 s46, s43, 0x20000
s_add_u32 s47, s43, 0x40000
s_add_u32 s40, s43, 0x60000
WL 0
v_or3_b32 v4, v192, v193, v194
v_or_b32 v4, v4, v195
s_nop 0
v_readfirstlane_b32 s36, v4
s_nop 0
s_andn2_b32 s36, s36, s45
s_cmp_lg_u32 s36, 0
s_cbranch_scc1 A1_slow
s_cmp_lg_u32 s44, 0
s_cbranch_scc1 A1_last
RQ 64,8,0
RQ 68,9,0
RQ 72,10,0
RQ 76,11,0
RQ 80,8,4096
RQ 84,9,4096
RQ 88,10,4096
RQ 92,11,4096
v_accvgpr_mov_b32 a0, a128
v_accvgpr_mov_b32 a1, a129
v_accvgpr_mov_b32 a2, a130
v_accvgpr_mov_b32 a3, a131
s_add_u32 m0, s27, 32768
v_accvgpr_mov_b32 a4, a132
v_accvgpr_mov_b32 a5, a133
v_accvgpr_mov_b32 a6, a134
DM 24,20,41,0
v_accvgpr_mov_b32 a7, a135
v_accvgpr_mov_b32 a8, a136
v_accvgpr_mov_b32 a9, a137
DM 25,20,41,1024
v_accvgpr_mov_b32 a10, a138
v_accvgpr_mov_b32 a11, a139
v_accvgpr_mov_b32 a12, a140
DM 26,20,41,2048
v_accvgpr_mov_b32 a13, a141
v_accvgpr_mov_b32 a14, a142
v_accvgpr_mov_b32 a15, a143
DM 27,20,41,3072
v_accvgpr_mov_b32 a16, a160
v_accvgpr_mov_b32 a17, a161
v_accvgpr_mov_b32 a18, a162
s_add_u32 s41, s41, 0x4000
v_accvgpr_mov_b32 a19, a163
v_accvgpr_mov_b32 a20, a164
v_accvgpr_mov_b32 a21, a165
s_and_b32 s41, s41, 0x1ffff
v_accvgpr_mov_b32 a22, a166
v_accvgpr_mov_b32 a23, a167
v_accvgpr_mov_b32 a24, a168
s_add_u32 m0, s27, 49152
v_accvgpr_mov_b32 a25, a169
v_accvgpr_mov_b32 a26, a170
v_accvgpr_mov_b32 a27, a171
DM 24,20,41,0
v_accvgpr_mov_b32 a28, a172
v_accvgpr_mov_b32 a29, a173
v_accvgpr_mov_b32 a30, a174
DM 25,20,41,1024
v_accvgpr_mov_b32 a31, a175
v_accvgpr_mov_b32 a32, a192
v_accvgpr_mov_b32 a33, a193
DM 26,20,41,2048
v_accvgpr_mov_b32 a34, a194
v_accvgpr_mov_b32 a35, a195
v_accvgpr_mov_b32 a36, a196
DM 27,20,41,3072
v_accvgpr_mov_b32 a37, a197
v_accvgpr_mov_b32 a38, a198
v_accvgpr_mov_b32 a39, a199
s_add_u32 s41, s41, 0x4000
v_accvgpr_mov_b32 a40, a200
v_accvgpr_mov_b32 a41, a201
v_accvgpr_mov_b32 a42, a202
s_and_b32 s41, s41, 0x1ffff
v_accvgpr_mov_b32 a43, a203
v_accvgpr_mov_b32 a44, a204
v_accvgpr_mov_b32 a45, a205
s_add_u32 m0, s27, 81920
v_accvgpr_mov_b32 a46, a206
v_accvgpr_mov_b32 a47, a207
v_accvgpr_mov_b32 a48, a224
DM 28,28,42,0
v_accvgpr_mov_b32 a49, a225
v_accvgpr_mov_b32 a50, a226
v_accvgpr_mov_b32 a51, a227
DM 29,28,42,1024
v_accvgpr_mov_b32 a52, a228
v_accvgpr_mov_b32 a53, a229
v_accvgpr_mov_b32 a54, a230
DM 28,28,42,2048
v_accvgpr_mov_b32 a55, a231
v_accvgpr_mov_b32 a56, a232
v_accvgpr_mov_b32 a57, a233
DM 29,28,42,3072
v_accvgpr_mov_b32 a58, a234
v_accvgpr_mov_b32 a59, a235
v_accvgpr_mov_b32 a60, a236
s_add_u32 s42, s42, 0x4000
v_accvgpr_mov_b32 a61, a237
v_accvgpr_mov_b32 a62, a238
v_accvgpr_mov_b32 a63, a239
s_and_b32 s42, s42, 0x1ffff
WL 4
AR 192,64
AR 193,65
AR 194,66
AR 195,67
Zvva 128,64,0
AR 196,80
AR 197,81
AR 198,82
Mvva 128,68,16
AR 199,83
v_mul_f32 v192, v192, v48
v_mul_f32 v193, v193, v48
Mvva 128,72,32
v_mul_f32 v194, v194, v48
v_mul_f32 v195, v195, v48
v_mul_f32 v196, v196, v48
Mvva 128,76,48
v_mul_f32 v197, v197, v48
v_mul_f32 v198, v198, v48
v_mul_f32 v199, v199, v48
Zvva 132,64,4
CV 224,192,193
CV 225,194,195
CV 226,196,197
Mvva 132,68,20
CV 227,198,199
buffer_store_dwordx4 v[224:227], v30, s[16:19], s43 offen offset:0 sc1
AR 200,68
Mvva 132,72,36
AR 201,69
AR 202,70
AR 203,71
Mvva 132,76,52
AR 204,84
AR 205,85
AR 206,86
AR 207,87
Zvva 136,64,8
v_mul_f32 v200, v200, v52
v_mul_f32 v201, v201, v52
v_mul_f32 v202, v202, v52
Mvva 136,68,24
v_mul_f32 v203, v203, v52
v_mul_f32 v204, v204, v52
v_mul_f32 v205, v205, v52
Mvva 136,72,40
v_mul_f32 v206, v206, v52
v_mul_f32 v207, v207, v52
CV 228,200,201
Mvva 136,76,56
CV 229,202,203
CV 230,204,205
CV 231,206,207
Zvva 140,64,12
buffer_store_dwordx4 v[228:231], v30, s[16:19], s46 offen offset:0 sc1
AR 208,72
AR 209,73
Mvva 140,68,28
AR 210,74
AR 211,75
AR 212,88
Mvva 140,72,44
AR 213,89
AR 214,90
AR 215,91
Mvva 140,76,60
v_mul_f32 v208, v208, v56
v_mul_f32 v209, v209, v56
v_mul_f32 v210, v210, v56
v_mul_f32 v211, v211, v56
v_mul_f32 v212, v212, v56
v_mul_f32 v213, v213, v56
v_mul_f32 v214, v214, v56
v_mul_f32 v215, v215, v56
CV 232,208,209
CV 233,210,211
CV 234,212,213
CV 235,214,215
buffer_store_dwordx4 v[232:235], v30, s[16:19], s47 offen offset:0 sc1
AR 216,76
AR 217,77
AR 218,78
AR 219,79
AR 220,92
AR 221,93
AR 222,94
AR 223,95
PM 216,216,60
PM 218,218,60
PM 220,220,60
PM 222,222,60
CV 236,216,217
CV 237,218,219
CV 238,220,221
CV 239,222,223
buffer_store_dwordx4 v[236:239], v30, s[16:19], s40 offen offset:0 sc1
AR 192,96
AR 193,97
AR 194,98
AR 195,99
AR 196,112
AR 197,113
AR 198,114
AR 199,115
v_max3_f32 v32, v128, v129, v130
PM 192,192,48
PM 194,194,48
PM 196,196,48
v_max3_f32 v36, v132, v133, v134
PM 198,198,48
CV 224,192,193
CV 225,194,195
v_max3_f32 v40, v136, v137, v138
CV 226,196,197
CV 227,198,199
v_max3_f32 v44, v140, v141, v142
buffer_store_dwordx4 v[224:227], v30, s[16:19], s43 offen offset:1024 sc1
AR 200,100
AR 201,101
v_max_f32 v32, v32, v131
AR 202,102
AR 203,103
AR 204,116
v_max_f32 v36, v36, v135
AR 205,117
AR 206,118
AR 207,119
v_max_f32 v40, v40, v139
PM 200,200,52
PM 202,202,52
v_max_f32 v44, v44, v143
PM 204,204,52
PM 206,206,52
CV 228,200,201
v_mov_b32 v33, v32
CV 229,202,203
CV 230,204,205
CV 231,206,207
v_mov_b32 v37, v36
buffer_store_dwordx4 v[228:231], v30, s[16:19], s46 offen offset:1024 sc1
AR 208,104
AR 209,105
v_mov_b32 v41, v40
AR 210,106
AR 211,107
v_mov_b32 v45, v44
AR 212,120
AR 213,121
AR 214,122
v_permlane16_swap_b32 v33, v32
AR 215,123
PM 208,208,56
PM 210,210,56
v_permlane16_swap_b32 v37, v36
PM 212,212,56
PM 214,214,56
CV 232,208,209
v_permlane16_swap_b32 v41, v40
CV 233,210,211
CV 234,212,213
v_permlane16_swap_b32 v45, v44
CV 235,214,215
buffer_store_dwordx4 v[232:235], v30, s[16:19], s47 offen offset:1024 sc1
AR 216,108
v_max_f32 v32, v32, v33
AR 217,109
AR 218,110
AR 219,111
v_max_f32 v36, v36, v37
AR 220,124
AR 221,125
AR 222,126
v_max_f32 v40, v40, v41
AR 223,127
PM 216,216,60
v_max_f32 v44, v44, v45
PM 218,218,60
PM 220,220,60
PM 222,222,60
v_mov_b32 v33, v32
CV 236,216,217
CV 237,218,219
CV 238,220,221
v_mov_b32 v37, v36
CV 239,222,223
buffer_store_dwordx4 v[236:239], v30, s[16:19], s40 offen offset:1024 sc1
AR 192,144
v_mov_b32 v41, v40
AR 193,145
AR 194,146
v_mov_b32 v45, v44
AR 195,147
AR 196,176
AR 197,177
v_permlane32_swap_b32 v33, v32
AR 198,178
AR 199,179
PM 192,192,48
v_permlane32_swap_b32 v37, v36
PM 194,194,48
PM 196,196,48
PM 198,198,48
v_permlane32_swap_b32 v41, v40
CV 224,192,193
CV 225,194,195
v_permlane32_swap_b32 v45, v44
CV 226,196,197
CV 227,198,199
buffer_store_dwordx4 v[224:227], v30, s[16:19], s43 offen offset:2048 sc1
v_max_f32 v32, v32, v33
AR 200,148
AR 201,149
AR 202,150
v_max_f32 v36, v36, v37
AR 203,151
AR 204,180
AR 205,181
v_max_f32 v40, v40, v41
AR 206,182
AR 207,183
v_max_f32 v44, v44, v45
PM 200,200,52
PM 202,202,52
PM 204,204,52
v_sub_f32 v32, 0, v32
PM 206,206,52
CV 228,200,201
CV 229,202,203
v_sub_f32 v36, 0, v36
CV 230,204,205
CV 231,206,207
buffer_store_dwordx4 v[228:231], v30, s[16:19], s46 offen offset:2048 sc1
v_sub_f32 v40, 0, v40
AR 208,152
AR 209,153
v_sub_f32 v44, 0, v44
AR 210,154
AR 211,155
AR 212,184
v_mov_b32 v33, v32
AR 213,185
AR 214,186
AR 215,187
v_mov_b32 v34, v32
PM 208,208,56
PM 210,210,56
PM 212,212,56
v_mov_b32 v35, v32
PM 214,214,56
CV 232,208,209
v_mov_b32 v37, v36
CV 233,210,211
CV 234,212,213
CV 235,214,215
v_mov_b32 v38, v36
buffer_store_dwordx4 v[232:235], v30, s[16:19], s47 offen offset:2048 sc1
AR 216,156
AR 217,157
v_mov_b32 v39, v36
AR 218,158
AR 219,159
AR 220,188
v_mov_b32 v41, v40
AR 221,189
AR 222,190
v_mov_b32 v42, v40
AR 223,191
PM 216,216,60
PM 218,218,60
v_mov_b32 v43, v40
PM 220,220,60
PM 222,222,60
CV 236,216,217
v_mov_b32 v45, v44
CV 237,218,219
CV 238,220,221
CV 239,222,223
v_mov_b32 v46, v44
buffer_store_dwordx4 v[236:239], v30, s[16:19], s40 offen offset:2048 sc1
AR 192,208
v_mov_b32 v47, v44
AR 193,209
AR 194,210
AR 195,211
AR 196,240
AR 197,241
AR 198,242
AR 199,243
PM 192,192,48
PM 194,194,48
PM 196,196,48
PM 198,198,48
CV 224,192,193
CV 225,194,195
CV 226,196,197
CV 227,198,199
buffer_store_dwordx4 v[224:227], v30, s[16:19], s43 offen offset:3072 sc1
AR 200,212
AR 201,213
AR 202,214
AR 203,215
AR 204,244
AR 205,245
AR 206,246
AR 207,247
PM 200,200,52
PM 202,202,52
PM 204,204,52
PM 206,206,52
CV 228,200,201
CV 229,202,203
CV 230,204,205
CV 231,206,207
buffer_store_dwordx4 v[228:231], v30, s[16:19], s46 offen offset:3072 sc1
AR 208,216
AR 209,217
AR 210,218
AR 211,219
AR 212,248
AR 213,249
AR 214,250
AR 215,251
PM 208,208,56
PM 210,210,56
PM 212,212,56
PM 214,214,56
CV 232,208,209
CV 233,210,211
CV 234,212,213
CV 235,214,215
buffer_store_dwordx4 v[232:235], v30, s[16:19], s47 offen offset:3072 sc1
AR 216,220
AR 217,221
AR 218,222
AR 219,223
AR 220,252
AR 221,253
AR 222,254
AR 223,255
PM 216,216,60
PM 218,218,60
PM 220,220,60
PM 222,222,60
CV 236,216,217
CV 237,218,219
CV 238,220,221
CV 239,222,223
buffer_store_dwordx4 v[236:239], v30, s[16:19], s40 offen offset:3072 sc1
s_mov_b32 s44, 1
s_mov_b32 s45, 0
s_add_u32 s43, s43, 4096
s_branch A1_havemax
A1_slow:
s_waitcnt vmcnt(0)
s_barrier
s_mov_b32 s22, 0x20000
s_mov_b32 s30, 0x20000
s_mov_b32 s45, 1
s_mov_b32 s41, 0
s_mov_b32 s42, 0
s_mov_b32 s32, 8
v_mov_b32 v32, 0xff800000
v_mov_b32 v36, 0xff800000
v_mov_b32 v40, 0xff800000
v_mov_b32 v44, 0xff800000
A1_mx:
s_add_u32 m0, s27, 0
s_nop 0
DM 24,20,41,0
DM 25,20,41,1024
DM 26,20,41,2048
DM 27,20,41,3072
s_add_u32 s41, s41, 0x4000
s_and_b32 s41, s41, 0x1ffff
s_waitcnt vmcnt(0)
s_barrier
RQ 64,8,0
RQ 68,9,0
RQ 72,10,0
RQ 76,11,0
WL 0
Zvva 128,64,0
Mvva 128,68,16
Mvva 128,72,32
Mvva 128,76,48
Zvva 132,64,4
Mvva 132,68,20
Mvva 132,72,36
Mvva 132,76,52
Zvva 136,64,8
Mvva 136,68,24
Mvva 136,72,40
Mvva 136,76,56
Zvva 140,64,12
Mvva 140,68,28
Mvva 140,72,44
Mvva 140,76,60
RQ 80,8,4096
RQ 84,9,4096
RQ 88,10,4096
RQ 92,11,4096
WL 0
Zvva 144,80,0
Mvva 144,84,16
Mvva 144,88,32
Mvva 144,92,48
Zvva 148,80,4
Mvva 148,84,20
Mvva 148,88,36
Mvva 148,92,52
Zvva 152,80,8
Mvva 152,84,24
Mvva 152,88,40
Mvva 152,92,56
Zvva 156,80,12
Mvva 156,84,28
Mvva 156,88,44
Mvva 156,92,60
RQ 64,8,8192
RQ 68,9,8192
RQ 72,10,8192
RQ 76,11,8192
WL 0
Zvva 160,64,0
Mvva 160,68,16
Mvva 160,72,32
Mvva 160,76,48
Zvva 164,64,4
Mvva 164,68,20
Mvva 164,72,36
Mvva 164,76,52
Zvva 168,64,8
Mvva 168,68,24
Mvva 168,72,40
Mvva 168,76,56
Zvva 172,64,12
Mvva 172,68,28
Mvva 172,72,44
Mvva 172,76,60
RQ 80,8,12288
RQ 84,9,12288
RQ 88,10,12288
RQ 92,11,12288
WL 0
Zvva 176,80,0
Mvva 176,84,16
Mvva 176,88,32
Mvva 176,92,48
Zvva 180,80,4
Mvva 180,84,20
Mvva 180,88,36
Mvva 180,92,52
Zvva 184,80,8
Mvva 184,84,24
Mvva 184,88,40
Mvva 184,92,56
Zvva 188,80,12
Mvva 188,84,28
Mvva 188,88,44
Mvva 188,92,60
s_nop 7
v_max3_f32 v32, v32, v128, v129
v_max3_f32 v32, v32, v130, v131
v_max3_f32 v36, v36, v132, v133
v_max3_f32 v36, v36, v134, v135
v_max3_f32 v40, v40, v136, v137
v_max3_f32 v40, v40, v138, v139
v_max3_f32 v44, v44, v140, v141
v_max3_f32 v44, v44, v142, v143
v_max3_f32 v32, v32, v144, v145
v_max3_f32 v32, v32, v146, v147
v_max3_f32 v36, v36, v148, v149
v_max3_f32 v36, v36, v150, v151
v_max3_f32 v40, v40, v152, v153
v_max3_f32 v40, v40, v154, v155
v_max3_f32 v44, v44, v156, v157
v_max3_f32 v44, v44, v158, v159
v_max3_f32 v32, v32, v160, v161
v_max3_f32 v32, v32, v162, v163
v_max3_f32 v36, v36, v164, v165
v_max3_f32 v36, v36, v166, v167
v_max3_f32 v40, v40, v168, v169
v_max3_f32 v40, v40, v170, v171
v_max3_f32 v44, v44, v172, v173
v_max3_f32 v44, v44, v174, v175
v_max3_f32 v32, v32, v176, v177
v_max3_f32 v32, v32, v178, v179
v_max3_f32 v36, v36, v180, v181
v_max3_f32 v36, v36, v182, v183
v_max3_f32 v40, v40, v184, v185
v_max3_f32 v40, v40, v186, v187
v_max3_f32 v44, v44, v188, v189
v_max3_f32 v44, v44, v190, v191
s_barrier
s_sub_u32 s32, s32, 1
s_cmp_lg_u32 s32, 0
s_cbranch_scc1 A1_mx
v_mov_b32 v33, v32
v_mov_b32 v37, v36
v_mov_b32 v41, v40
v_mov_b32 v45, v44
v_permlane16_swap_b32 v33, v32
v_permlane16_swap_b32 v37, v36
v_permlane16_swap_b32 v41, v40
v_permlane16_swap_b32 v45, v44
v_max_f32 v32, v32, v33
v_max_f32 v36, v36, v37
v_max_f32 v40, v40, v41
v_max_f32 v44, v44, v45
v_mov_b32 v33, v32
v_mov_b32 v37, v36
v_mov_b32 v41, v40
v_mov_b32 v45, v44
v_permlane32_swap_b32 v33, v32
v_permlane32_swap_b32 v37, v36
v_permlane32_swap_b32 v41, v40
v_permlane32_swap_b32 v45, v44
v_max_f32 v32, v32, v33
v_max_f32 v36, v36, v37
v_max_f32 v40, v40, v41
v_max_f32 v44, v44, v45
v_sub_f32 v32, 0, v32
v_sub_f32 v36, 0, v36
v_sub_f32 v40, 0, v40
v_sub_f32 v44, 0, v44
v_mov_b32 v33, v32
v_mov_b32 v34, v32
v_mov_b32 v35, v32
v_mov_b32 v37, v36
v_mov_b32 v38, v36
v_mov_b32 v39, v36
v_mov_b32 v41, v40
v_mov_b32 v42, v40
v_mov_b32 v43, v40
v_mov_b32 v45, v44
v_mov_b32 v46, v44
v_mov_b32 v47, v44
s_add_u32 m0, s27, 0
s_nop 0
DM 24,20,41,0
DM 25,20,41,1024
DM 26,20,41,2048
DM 27,20,41,3072
s_add_u32 s41, s41, 0x4000
s_and_b32 s41, s41, 0x1ffff
s_add_u32 m0, s27, 65536
s_nop 0
DM 28,28,42,0
DM 29,28,42,1024
DM 28,28,42,2048
DM 29,28,42,3072
s_add_u32 s42, s42, 0x4000
s_and_b32 s42, s42, 0x1ffff
s_add_u32 m0, s27, 16384
s_nop 0
DM 24,20,41,0
DM 25,20,41,1024
DM 26,20,41,2048
DM 27,20,41,3072
s_add_u32 s41, s41, 0x4000
s_and_b32 s41, s41, 0x1ffff
s_add_u32 m0, s27, 32768
s_nop 0
DM 24,20,41,0
DM 25,20,41,1024
DM 26,20,41,2048
DM 27,20,41,3072
s_add_u32 s41, s41, 0x4000
s_and_b32 s41, s41, 0x1ffff
s_add_u32 m0, s27, 49152
s_nop 0
DM 24,20,41,0
DM 25,20,41,1024
DM 26,20,41,2048
DM 27,20,41,3072
s_add_u32 s41, s41, 0x4000
s_and_b32 s41, s41, 0x1ffff
s_add_u32 m0, s27, 81920
s_nop 0
DM 28,28,42,0
DM 29,28,42,1024
DM 28,28,42,2048
DM 29,28,42,3072
s_add_u32 s42, s42, 0x4000
s_and_b32 s42, s42, 0x1ffff
s_waitcnt vmcnt(0)
s_barrier
RQ 64,8,0
RQ 68,9,0
RQ 72,10,0
RQ 76,11,0
RQ 80,8,4096
RQ 84,9,4096
RQ 88,10,4096
RQ 92,11,4096
WL 4
Zvva 128,64,0
Mvva 128,68,16
Mvva 128,72,32
Mvva 128,76,48
Zvva 132,64,4
Mvva 132,68,20
Mvva 132,72,36
Mvva 132,76,52
Zvva 136,64,8
Mvva 136,68,24
Mvva 136,72,40
Mvva 136,76,56
Zvva 140,64,12
Mvva 140,68,28
Mvva 140,72,44
Mvva 140,76,60
s_nop 7
s_branch A1_havemax
A1_last:
s_load_dwordx2 s[96:97], s[0:1], 80
s_mov_b32 s12, s54
s_mov_b32 s13, s55
s_mov_b32 s14, 7340032
s_mov_b32 s15, 0x20000
s_mov_b32 s52, s43
s_mov_b32 s53, s46
s_mov_b32 s54, s47
s_mov_b32 s55, s40
s_and_b32 s33, s35, 6
s_lshr_b32 s36, s35, 6
s_add_u32 s33, s33, s36
s_lshr_b32 s34, s35, 3
s_and_b32 s34, s34, 7
s_and_b32 s41, s35, 1
s_add_u32 s40, s41, 2
s_lshl_b32 s39, s33, 4
s_lshl_b32 s36, s3, 2
s_add_u32 s39, s39, s36
s_lshl_b32 s27, s3, 12
s_add_u32 s8, s4, 25165824
s_addc_u32 s9, s5, 0
s_mov_b32 s10, 14680064
s_mov_b32 s11, 0x20000
v_lshrrev_b32 v8, 4, v1
s_lshl_b32 s36, s3, 4
v_add_u32 v9, s36, v8
v_mul_u32_u24 v9, 2048, v9
v_and_b32 v10, 15, v1
v_add_u32 v11, 0, v8
v_lshlrev_b32 v11, 1, v11
v_xor_b32 v11, v11, v10
v_lshl_add_u32 v11, v11, 4, v9
v_add_u32 v24, 0, v11
v_add_u32 v11, 4, v8
v_lshlrev_b32 v11, 1, v11
v_xor_b32 v11, v11, v10
v_lshl_add_u32 v11, v11, 4, v9
v_add_u32 v25, 7168, v11
v_add_u32 v11, 0, v8
v_lshlrev_b32 v11, 1, v11
v_xor_b32 v11, v11, v10
v_lshl_add_u32 v11, v11, 4, v9
v_add_u32 v26, 14336, v11
v_add_u32 v11, 4, v8
v_lshlrev_b32 v11, 1, v11
v_xor_b32 v11, v11, v10
v_lshl_add_u32 v11, v11, 4, v9
v_add_u32 v27, 21504, v11
s_lshl_b32 s25, s34, 8
s_mul_i32 s36, s41, 3670016
s_add_u32 s25, s25, s36
s_mul_i32 s24, s39, 114688
s_mul_i32 s36, s41, 57344
s_add_u32 s24, s24, s36
v_lshlrev_b32 v2, 4, v1
s_add_u32 s36, s40, 0
s_and_b32 s36, s36, 3
s_mul_i32 s36, s36, 114688
v_add_u32 v64, s36, v2
s_add_u32 s36, s40, 1
s_and_b32 s36, s36, 3
s_mul_i32 s36, s36, 114688
v_add_u32 v65, s36, v2
s_add_u32 s36, s40, 2
s_and_b32 s36, s36, 3
s_mul_i32 s36, s36, 114688
v_add_u32 v66, s36, v2
s_add_u32 s36, s40, 3
s_and_b32 s36, s36, 3
s_mul_i32 s36, s36, 114688
v_add_u32 v67, s36, v2
v_mov_b32 v120, v48
v_mov_b32 v121, v48
v_mov_b32 v122, v52
v_mov_b32 v123, v52
v_mov_b32 v124, v56
v_mov_b32 v125, v56
v_mov_b32 v126, v60
v_mov_b32 v127, v60
s_add_u32 m0, s27, 0
s_nop 0
DM 24,12,25,0
DM 25,12,25,1024
DM 26,12,25,2048
DM 27,12,25,3072
s_add_u32 s25, s25, 524288
s_waitcnt vmcnt(4)
v_cmp_ne_u32 vcc, 8, v5
s_nop 1
s_cbranch_vccnz B4_f0_w
B4_f0_k:
buffer_load_dwordx4 a[0:3], v64, s[8:11], s24 offen offset:0 sc1
buffer_load_dwordx4 a[4:7], v64, s[8:11], s24 offen offset:1024 sc1
buffer_load_dwordx4 a[8:11], v65, s[8:11], s24 offen offset:0 sc1
buffer_load_dwordx4 a[12:15], v65, s[8:11], s24 offen offset:1024 sc1
buffer_load_dwordx4 a[16:19], v66, s[8:11], s24 offen offset:0 sc1
buffer_load_dwordx4 a[20:23], v66, s[8:11], s24 offen offset:1024 sc1
buffer_load_dwordx4 a[24:27], v67, s[8:11], s24 offen offset:0 sc1
buffer_load_dwordx4 a[28:31], v67, s[8:11], s24 offen offset:1024 sc1
s_add_u32 s24, s24, 8192
s_add_u32 m0, s27, 16384
s_nop 0
DM 24,12,25,0
DM 25,12,25,1024
DM 26,12,25,2048
DM 27,12,25,3072
s_add_u32 s25, s25, 393216
buffer_load_dwordx4 a[32:35], v64, s[8:11], s24 offen offset:0 sc1
buffer_load_dwordx4 a[36:39], v64, s[8:11], s24 offen offset:1024 sc1
buffer_load_dwordx4 a[40:43], v65, s[8:11], s24 offen offset:0 sc1
buffer_load_dwordx4 a[44:47], v65, s[8:11], s24 offen offset:1024 sc1
buffer_load_dwordx4 a[48:51], v66, s[8:11], s24 offen offset:0 sc1
buffer_load_dwordx4 a[52:55], v66, s[8:11], s24 offen offset:1024 sc1
buffer_load_dwordx4 a[56:59], v67, s[8:11], s24 offen offset:0 sc1
buffer_load_dwordx4 a[60:63], v67, s[8:11], s24 offen offset:1024 sc1
s_add_u32 s24, s24, 6144
v_and_b32 v94, 1, v1
v_lshlrev_b32 v94, 7, v94
s_lshl_b32 s79, s33, 8
s_add_u32 s79, s79, 18432
WL 0
s_mov_b32 s20, s80
s_mov_b32 s21, s81
s_mov_b32 s22, 4194304
s_mov_b32 s23, 0x20000
s_add_u32 s28, s4, 12582912
s_addc_u32 s29, s5, 0
s_mov_b32 s30, 4194304
s_mov_b32 s31, 0x20000
s_add_u32 s88, s4, 67108864
s_addc_u32 s89, s5, 0
s_mov_b32 s90, 33554432
s_mov_b32 s91, 0x20000
v_lshrrev_b32 v2, 4, v1
v_and_b32 v3, 15, v1
v_add_u32 v4, 0, v2
v_xor_b32 v4, v4, v3
v_lshlrev_b32 v4, 4, v4
v_lshl_add_u32 v4, v2, 11, v4
v_add_u32 v90, 0, v4
v_add_u32 v4, 4, v2
v_xor_b32 v4, v4, v3
v_lshlrev_b32 v4, 4, v4
v_lshl_add_u32 v4, v2, 11, v4
v_add_u32 v91, 7168, v4
v_add_u32 v4, 8, v2
v_xor_b32 v4, v4, v3
v_lshlrev_b32 v4, 4, v4
v_lshl_add_u32 v4, v2, 11, v4
v_add_u32 v92, 14336, v4
v_add_u32 v4, 12, v2
v_xor_b32 v4, v4, v3
v_lshlrev_b32 v4, 4, v4
v_lshl_add_u32 v4, v2, 11, v4
v_add_u32 v93, 21504, v4
s_add_u32 s36, s39, s40
s_lshl_b32 s42, s36, 15
s_lshl_b32 s37, s34, 12
s_add_u32 s43, s42, s37
s_lshl_b32 s37, s34, 8
s_add_u32 s42, s42, s37
s_add_u32 s46, s27, 0x20000
v_lshlrev_b32 v88, 4, v1
s_lshl_b32 s36, s33, 3
s_add_u32 s36, s36, s34
s_lshl_b32 s47, s36, 8
s_lshl_b32 s78, s36, 19
s_add_u32 s78, s78, s27
v_lshrrev_b32 v2, 2, v1
v_and_b32 v3, 7, v2
v_lshlrev_b32 v2, 8, v2
v_and_b32 v4, 3, v1
v_lshl_add_u32 v2, v4, 3, v2
v_xor_b32 v4, 0, v3
v_lshl_add_u32 v8, v4, 5, v2
v_xor_b32 v4, 1, v3
v_lshl_add_u32 v9, v4, 5, v2
v_xor_b32 v4, 2, v3
v_lshl_add_u32 v10, v4, 5, v2
v_xor_b32 v4, 3, v3
v_lshl_add_u32 v11, v4, 5, v2
v_xor_b32 v4, 4, v3
v_lshl_add_u32 v12, v4, 5, v2
v_xor_b32 v4, 5, v3
v_lshl_add_u32 v13, v4, 5, v2
v_xor_b32 v4, 6, v3
v_lshl_add_u32 v14, v4, 5, v2
v_xor_b32 v4, 7, v3
v_lshl_add_u32 v15, v4, 5, v2
s_waitcnt vmcnt(12)
s_barrier
TR 32,8,0
TR 34,8,4096
TR 36,8,8192
TR 38,8,12288
TR 40,9,0
TR 42,9,4096
TR 44,9,8192
TR 46,9,12288
TR 48,10,0
TR 50,10,4096
TR 52,10,8192
TR 54,10,12288
WL 8
Zvva 128,32,0
TR 56,11,0
AR 96,64
AR 97,65
Mvva 128,36,4
s_add_u32 m0, s27, 32768
Zvva 132,32,8
TR 58,11,4096
AR 98,66
Mvva 132,36,12
AR 99,67
DM 24,12,25,0
Zvva 136,32,16
TR 60,11,8192
AR 100,80
Mvva 136,36,20
AR 101,81
Zvva 140,32,24
TR 62,11,12288
AR 102,82
Mvva 140,36,28
WL 8
DM 25,12,25,1024
AR 103,83
Zvva 144,40,0
TR 32,12,0
v_mul_f32 v96, v96, v120
Mvva 144,44,4
DM 26,12,25,2048
Zvva 148,40,8
TR 34,12,4096
v_mul_f32 v97, v97, v120
v_mul_f32 v98, v98, v120
Mvva 148,44,12
DM 27,12,25,3072
Zvva 152,40,16
TR 36,12,8192
v_mul_f32 v99, v99, v120
Mvva 152,44,20
v_mul_f32 v100, v100, v120
Zvva 156,40,24
TR 38,12,12288
v_mul_f32 v101, v101, v120
s_add_u32 s25, s25, 524288
Mvva 156,44,28
WL 8
v_mul_f32 v102, v102, v120
Zvva 160,48,0
TR 40,13,0
v_mul_f32 v103, v103, v120
Mvva 160,52,4
buffer_load_dwordx4 a[128:131], v64, s[8:11], s24 offen offset:0 sc1
Zvva 164,48,8
TR 42,13,4096
CV 112,96,97
CV 113,98,99
Mvva 164,52,12
CV 114,100,101
Zvva 168,48,16
TR 44,13,8192
buffer_load_dwordx4 a[132:135], v64, s[8:11], s24 offen offset:1024 sc1
Mvva 168,52,20
CV 115,102,103
buffer_store_dwordx4 v[112:115], v30, s[16:19], s52 offen offset:0 sc1
Zvva 172,48,24
TR 46,13,12288
buffer_load_dwordx4 a[136:139], v65, s[8:11], s24 offen offset:0 sc1
Mvva 172,52,28
WL 8
AR 104,68
Zvva 176,56,0
TR 48,14,0
AR 105,69
Mvva 176,60,4
buffer_load_dwordx4 a[140:143], v65, s[8:11], s24 offen offset:1024 sc1
AR 106,70
Zvva 180,56,8
TR 50,14,4096
AR 107,71
Mvva 180,60,12
AR 108,84
Zvva 184,56,16
TR 52,14,8192
buffer_load_dwordx4 a[160:163], v66, s[8:11], s24 offen offset:0 sc1
Mvva 184,60,20
AR 109,85
AR 110,86
Zvva 188,56,24
TR 54,14,12288
buffer_load_dwordx4 a[164:167], v66, s[8:11], s24 offen offset:1024 sc1
Mvva 188,60,28
WL 8
AR 111,87
Zvva 192,32,0
TR 56,15,0
v_mul_f32 v104, v104, v122
v_mul_f32 v105, v105, v122
Mvva 192,36,4
buffer_load_dwordx4 a[168:171], v67, s[8:11], s24 offen offset:0 sc1
Zvva 196,32,8
TR 58,15,4096
v_mul_f32 v106, v106, v122
Mvva 196,36,12
v_mul_f32 v107, v107, v122
Zvva 200,32,16
TR 60,15,8192
buffer_load_dwordx4 a[172:175], v67, s[8:11], s24 offen offset:1024 sc1
v_mul_f32 v108, v108, v122
Mvva 200,36,20
v_mul_f32 v109, v109, v122
Zvva 204,32,24
TR 62,15,12288
s_add_u32 s24, s24, 8192
Mvva 204,36,28
WL 8
v_mul_f32 v110, v110, v122
s_waitcnt vmcnt(13)
s_barrier
Zvva 208,40,0
TR 32,8,16384
v_mul_f32 v111, v111, v122
CV 116,104,105
Mvva 208,44,4
CV 117,106,107
Zvva 212,40,8
TR 34,8,20480
CV 118,108,109
s_add_u32 m0, s27, 49152
Mvva 212,44,12
CV 119,110,111
Zvva 216,40,16
TR 36,8,24576
buffer_store_dwordx4 v[116:119], v30, s[16:19], s53 offen offset:0 sc1
AR 96,72
Mvva 216,44,20
AR 97,73
Zvva 220,40,24
TR 38,8,28672
AR 98,74
Mvva 220,44,28
WL 8
DM 24,12,25,0
AR 99,75
Zvva 224,48,0
TR 40,9,16384
AR 100,88
Mvva 224,52,4
AR 101,89
AR 102,90
Zvva 228,48,8
TR 42,9,20480
AR 103,91
Mvva 228,52,12
DM 25,12,25,1024
Zvva 232,48,16
TR 44,9,24576
v_mul_f32 v96, v96, v124
v_mul_f32 v97, v97, v124
Mvva 232,52,20
v_mul_f32 v98, v98, v124
Zvva 236,48,24
TR 46,9,28672
v_mul_f32 v99, v99, v124
v_mul_f32 v100, v100, v124
Mvva 236,52,28
WL 8
DM 26,12,25,2048
Zvva 240,56,0
TR 48,10,16384
v_mul_f32 v101, v101, v124
Mvva 240,60,4
v_mul_f32 v102, v102, v124
v_mul_f32 v103, v103, v124
Zvva 244,56,8
TR 50,10,20480
CV 112,96,97
Mvva 244,60,12
CV 113,98,99
DM 27,12,25,3072
Zvva 248,56,16
TR 52,10,24576
CV 114,100,101
Mvva 248,60,20
CV 115,102,103
Zvva 252,56,24
TR 54,10,28672
buffer_store_dwordx4 v[112:115], v30, s[16:19], s54 offen offset:0 sc1
AR 104,76
Mvva 252,60,28
WL 8
AR 105,77
Mvva 128,32,32
TR 56,11,16384
s_add_u32 s25, s25, 393216
AR 106,78
Mvva 128,36,36
AR 107,79
Mvva 132,32,40
TR 58,11,20480
AR 108,92
Mvva 132,36,44
AR 109,93
AR 110,94
Mvva 136,32,48
TR 60,11,24576
buffer_load_dwordx4 a[192:195], v64, s[8:11], s24 offen offset:0 sc1
Mvva 136,36,52
AR 111,95
v_mul_f32 v104, v104, v126
Mvva 140,32,56
TR 62,11,28672
v_mul_f32 v105, v105, v126
Mvva 140,36,60
WL 8
v_mul_f32 v106, v106, v126
Mvva 144,40,32
TR 32,12,16384
v_mul_f32 v107, v107, v126
buffer_load_dwordx4 a[196:199], v64, s[8:11], s24 offen offset:1024 sc1
Mvva 144,44,36
v_mul_f32 v108, v108, v126
Mvva 148,40,40
TR 34,12,20480
v_mul_f32 v109, v109, v126
v_mul_f32 v110, v110, v126
Mvva 148,44,44
v_mul_f32 v111, v111, v126
Mvva 152,40,48
TR 36,12,24576
CV 116,104,105
buffer_load_dwordx4 a[200:203], v65, s[8:11], s24 offen offset:0 sc1
Mvva 152,44,52
CV 117,106,107
Mvva 156,40,56
TR 38,12,28672
CV 118,108,109
Mvva 156,44,60
WL 8
CV 119,110,111
buffer_store_dwordx4 v[116:119], v30, s[16:19], s55 offen offset:0 sc1
Mvva 160,48,32
TR 40,13,16384
AR 96,96
Mvva 160,52,36
buffer_load_dwordx4 a[204:207], v65, s[8:11], s24 offen offset:1024 sc1
AR 97,97
Mvva 164,48,40
TR 42,13,20480
AR 98,98
Mvva 164,52,44
AR 99,99
Mvva 168,48,48
TR 44,13,24576
AR 100,112
AR 101,113
Mvva 168,52,52
buffer_load_dwordx4 a[224:227], v66, s[8:11], s24 offen offset:0 sc1
Mvva 172,48,56
TR 46,13,28672
AR 102,114
AR 103,115
Mvva 172,52,60
WL 8
v_mul_f32 v96, v96, v120
Mvva 176,56,32
TR 48,14,16384
v_mul_f32 v97, v97, v120
Mvva 176,60,36
v_mul_f32 v98, v98, v120
buffer_load_dwordx4 a[228:231], v66, s[8:11], s24 offen offset:1024 sc1
Mvva 180,56,40
TR 50,14,20480
v_mul_f32 v99, v99, v120
Mvva 180,60,44
v_mul_f32 v100, v100, v120
v_mul_f32 v101, v101, v120
Mvva 184,56,48
TR 52,14,24576
v_mul_f32 v102, v102, v120
Mvva 184,60,52
v_mul_f32 v103, v103, v120
Mvva 188,56,56
TR 54,14,28672
buffer_load_dwordx4 a[232:235], v67, s[8:11], s24 offen offset:0 sc1
CV 112,96,97
Mvva 188,60,60
WL 8
CV 113,98,99
Mvva 192,32,32
TR 56,15,16384
CV 114,100,101
CV 115,102,103
Mvva 192,36,36
buffer_store_dwordx4 v[112:115], v30, s[16:19], s52 offen offset:1024 sc1
Mvva 196,32,40
TR 58,15,20480
buffer_load_dwordx4 a[236:239], v67, s[8:11], s24 offen offset:1024 sc1
Mvva 196,36,44
AR 104,100
AR 105,101
Mvva 200,32,48
TR 60,15,24576
AR 106,102
Mvva 200,36,52
AR 107,103
AR 108,116
Mvva 204,32,56
TR 62,15,28672
s_add_u32 s24, s24, 6144
Mvva 204,36,60
WL 8
AR 109,117
s_waitcnt vmcnt(16)
s_barrier
Mvva 208,40,32
TR 32,8,32768
AR 110,118
AR 111,119
Mvva 208,44,36
v_mul_f32 v104, v104, v122
Mvva 212,40,40
TR 34,8,36864
v_mul_f32 v105, v105, v122
s_add_u32 m0, s27, 0
Mvva 212,44,44
v_mul_f32 v106, v106, v122
Mvva 216,40,48
TR 36,8,40960
v_mul_f32 v107, v107, v122
v_mul_f32 v108, v108, v122
Mvva 216,44,52
v_mul_f32 v109, v109, v122
Mvva 220,40,56
TR 38,8,45056
v_mul_f32 v110, v110, v122
Mvva 220,44,60
WL 8
DM 24,12,25,0
v_mul_f32 v111, v111, v122
Mvva 224,48,32
TR 40,9,32768
CV 116,104,105
Mvva 224,52,36
CV 117,106,107
CV 118,108,109
Mvva 228,48,40
TR 42,9,36864
CV 119,110,111
Mvva 228,52,44
DM 25,12,25,1024
Mvva 232,48,48
TR 44,9,40960
buffer_store_dwordx4 v[116:119], v30, s[16:19], s53 offen offset:1024 sc1
AR 96,104
Mvva 232,52,52
AR 97,105
Mvva 236,48,56
TR 46,9,45056
AR 98,106
AR 99,107
Mvva 236,52,60
WL 8
DM 26,12,25,2048
Mvva 240,56,32
TR 48,10,32768
AR 100,120
Mvva 240,60,36
AR 101,121
AR 102,122
Mvva 244,56,40
TR 50,10,36864
AR 103,123
Mvva 244,60,44
v_mul_f32 v96, v96, v124
DM 27,12,25,3072
Mvva 248,56,48
TR 52,10,40960
v_mul_f32 v97, v97, v124
Mvva 248,60,52
v_mul_f32 v98, v98, v124
Mvva 252,56,56
TR 54,10,45056
v_mul_f32 v99, v99, v124
v_mul_f32 v100, v100, v124
Mvva 252,60,60
WL 8
v_mul_f32 v101, v101, v124
Mvva 128,32,128
TR 56,11,32768
s_add_u32 s25, s25, 524288
v_mul_f32 v102, v102, v124
Mvva 128,36,132
v_mul_f32 v103, v103, v124
Mvva 132,32,136
TR 58,11,36864
CV 112,96,97
Mvva 132,36,140
CV 113,98,99
CV 114,100,101
Mvva 136,32,160
TR 60,11,40960
buffer_load_dwordx4 a[0:3], v64, s[8:11], s24 offen offset:0 sc1
Mvva 136,36,164
CV 115,102,103
buffer_store_dwordx4 v[112:115], v30, s[16:19], s54 offen offset:1024 sc1
Mvva 140,32,168
TR 62,11,45056
AR 104,108
Mvva 140,36,172
WL 8
AR 105,109
Mvva 144,40,128
TR 32,12,32768
AR 106,110
buffer_load_dwordx4 a[4:7], v64, s[8:11], s24 offen offset:1024 sc1
Mvva 144,44,132
AR 107,111
Mvva 148,40,136
TR 34,12,36864
AR 108,124
AR 109,125
Mvva 148,44,140
AR 110,126
Mvva 152,40,160
TR 36,12,40960
AR 111,127
buffer_load_dwordx4 a[8:11], v65, s[8:11], s24 offen offset:0 sc1
Mvva 152,44,164
v_mul_f32 v104, v104, v126
Mvva 156,40,168
TR 38,12,45056
v_mul_f32 v105, v105, v126
Mvva 156,44,172
WL 8
v_mul_f32 v106, v106, v126
v_mul_f32 v107, v107, v126
Mvva 160,48,128
TR 40,13,32768
v_mul_f32 v108, v108, v126
Mvva 160,52,132
buffer_load_dwordx4 a[12:15], v65, s[8:11], s24 offen offset:1024 sc1
v_mul_f32 v109, v109, v126
Mvva 164,48,136
TR 42,13,36864
v_mul_f32 v110, v110, v126
Mvva 164,52,140
v_mul_f32 v111, v111, v126
Mvva 168,48,160
TR 44,13,40960
CV 116,104,105
CV 117,106,107
Mvva 168,52,164
buffer_load_dwordx4 a[16:19], v66, s[8:11], s24 offen offset:0 sc1
Mvva 172,48,168
TR 46,13,45056
CV 118,108,109
CV 119,110,111
Mvva 172,52,172
WL 8
buffer_store_dwordx4 v[116:119], v30, s[16:19], s55 offen offset:1024 sc1
Mvva 176,56,128
TR 48,14,32768
AR 96,144
Mvva 176,60,132
AR 97,145
buffer_load_dwordx4 a[20:23], v66, s[8:11], s24 offen offset:1024 sc1
Mvva 180,56,136
TR 50,14,36864
AR 98,146
Mvva 180,60,140
AR 99,147
AR 100,176
Mvva 184,56,160
TR 52,14,40960
AR 101,177
Mvva 184,60,164
AR 102,178
Mvva 188,56,168
TR 54,14,45056
buffer_load_dwordx4 a[24:27], v67, s[8:11], s24 offen offset:0 sc1
AR 103,179
Mvva 188,60,172
WL 8
v_mul_f32 v96, v96, v120
Mvva 192,32,128
TR 56,15,32768
v_mul_f32 v97, v97, v120
v_mul_f32 v98, v98, v120
Mvva 192,36,132
v_mul_f32 v99, v99, v120
Mvva 196,32,136
TR 58,15,36864
buffer_load_dwordx4 a[28:31], v67, s[8:11], s24 offen offset:1024 sc1
Mvva 196,36,140
v_mul_f32 v100, v100, v120
v_mul_f32 v101, v101, v120
Mvva 200,32,160
TR 60,15,40960
v_mul_f32 v102, v102, v120
Mvva 200,36,164
v_mul_f32 v103, v103, v120
CV 112,96,97
Mvva 204,32,168
TR 62,15,45056
s_add_u32 s24, s24, 8192
Mvva 204,36,172
WL 8
CV 113,98,99
s_waitcnt vmcnt(15)
s_barrier
Mvva 208,40,128
TR 32,8,49152
CV 114,100,101
CV 115,102,103
Mvva 208,44,132
buffer_store_dwordx4 v[112:115], v30, s[16:19], s52 offen offset:2048 sc1
Mvva 212,40,136
TR 34,8,53248
AR 104,148
s_add_u32 m0, s27, 16384
Mvva 212,44,140
AR 105,149
Mvva 216,40,160
TR 36,8,57344
AR 106,150
AR 107,151
Mvva 216,44,164
AR 108,180
Mvva 220,40,168
TR 38,8,61440
AR 109,181
Mvva 220,44,172
WL 8
DM 24,12,25,0
AR 110,182
Mvva 224,48,128
TR 40,9,49152
AR 111,183
Mvva 224,52,132
v_mul_f32 v104, v104, v122
v_mul_f32 v105, v105, v122
Mvva 228,48,136
TR 42,9,53248
v_mul_f32 v106, v106, v122
Mvva 228,52,140
DM 25,12,25,1024
Mvva 232,48,160
TR 44,9,57344
v_mul_f32 v107, v107, v122
v_mul_f32 v108, v108, v122
Mvva 232,52,164
v_mul_f32 v109, v109, v122
Mvva 236,48,168
TR 46,9,61440
v_mul_f32 v110, v110, v122
v_mul_f32 v111, v111, v122
Mvva 236,52,172
WL 8
DM 26,12,25,2048
Mvva 240,56,128
TR 48,10,49152
CV 116,104,105
Mvva 240,60,132
CV 117,106,107
CV 118,108,109
Mvva 244,56,136
TR 50,10,53248
CV 119,110,111
Mvva 244,60,140
buffer_store_dwordx4 v[116:119], v30, s[16:19], s53 offen offset:2048 sc1
DM 27,12,25,3072
Mvva 248,56,160
TR 52,10,57344
AR 96,152
Mvva 248,60,164
AR 97,153
Mvva 252,56,168
TR 54,10,61440
AR 98,154
AR 99,155
Mvva 252,60,172
WL 8
AR 100,184
Mvva 128,32,192
TR 56,11,49152
s_add_u32 s25, s25, 393216
AR 101,185
Mvva 128,36,196
AR 102,186
Mvva 132,32,200
TR 58,11,53248
AR 103,187
Mvva 132,36,204
v_mul_f32 v96, v96, v124
v_mul_f32 v97, v97, v124
Mvva 136,32,224
TR 60,11,57344
buffer_load_dwordx4 a[32:35], v64, s[8:11], s24 offen offset:0 sc1
Mvva 136,36,228
v_mul_f32 v98, v98, v124
v_mul_f32 v99, v99, v124
Mvva 140,32,232
TR 62,11,61440
v_mul_f32 v100, v100, v124
Mvva 140,36,236
WL 8
v_mul_f32 v101, v101, v124
Mvva 144,40,192
TR 32,12,49152
v_mul_f32 v102, v102, v124
buffer_load_dwordx4 a[36:39], v64, s[8:11], s24 offen offset:1024 sc1
Mvva 144,44,196
v_mul_f32 v103, v103, v124
Mvva 148,40,200
TR 34,12,53248
CV 112,96,97
CV 113,98,99
Mvva 148,44,204
CV 114,100,101
Mvva 152,40,224
TR 36,12,57344
CV 115,102,103
buffer_load_dwordx4 a[40:43], v65, s[8:11], s24 offen offset:0 sc1
Mvva 152,44,228
buffer_store_dwordx4 v[112:115], v30, s[16:19], s54 offen offset:2048 sc1
Mvva 156,40,232
TR 38,12,61440
AR 104,156
Mvva 156,44,236
WL 8
AR 105,157
AR 106,158
Mvva 160,48,192
TR 40,13,49152
AR 107,159
Mvva 160,52,196
buffer_load_dwordx4 a[44:47], v65, s[8:11], s24 offen offset:1024 sc1
AR 108,188
Mvva 164,48,200
TR 42,13,53248
AR 109,189
Mvva 164,52,204
AR 110,190
Mvva 168,48,224
TR 44,13,57344
AR 111,191
v_mul_f32 v104, v104, v126
Mvva 168,52,228
buffer_load_dwordx4 a[48:51], v66, s[8:11], s24 offen offset:0 sc1
Mvva 172,48,232
TR 46,13,61440
v_mul_f32 v105, v105, v126
v_mul_f32 v106, v106, v126
Mvva 172,52,236
WL 8
v_mul_f32 v107, v107, v126
Mvva 176,56,192
TR 48,14,49152
v_mul_f32 v108, v108, v126
Mvva 176,60,196
v_mul_f32 v109, v109, v126
buffer_load_dwordx4 a[52:55], v66, s[8:11], s24 offen offset:1024 sc1
Mvva 180,56,200
TR 50,14,53248
v_mul_f32 v110, v110, v126
Mvva 180,60,204
v_mul_f32 v111, v111, v126
CV 116,104,105
Mvva 184,56,224
TR 52,14,57344
CV 117,106,107
Mvva 184,60,228
CV 118,108,109
Mvva 188,56,232
TR 54,14,61440
buffer_load_dwordx4 a[56:59], v67, s[8:11], s24 offen offset:0 sc1
CV 119,110,111
Mvva 188,60,236
WL 8
buffer_store_dwordx4 v[116:119], v30, s[16:19], s55 offen offset:2048 sc1
Mvva 192,32,192
TR 56,15,49152
AR 96,208
AR 97,209
Mvva 192,36,196
AR 98,210
Mvva 196,32,200
TR 58,15,53248
buffer_load_dwordx4 a[60:63], v67, s[8:11], s24 offen offset:1024 sc1
Mvva 196,36,204
AR 99,211
AR 100,240
Mvva 200,32,224
TR 60,15,57344
AR 101,241
Mvva 200,36,228
AR 102,242
AR 103,243
Mvva 204,32,232
TR 62,15,61440
s_add_u32 s24, s24, 6144
Mvva 204,36,236
WL 8
v_mul_f32 v96, v96, v120
s_waitcnt vmcnt(16)
s_barrier
Mvva 208,40,192
TR 32,8,0
v_mul_f32 v97, v97, v120
v_mul_f32 v98, v98, v120
Mvva 208,44,196
v_mul_f32 v99, v99, v120
Mvva 212,40,200
TR 34,8,4096
v_mul_f32 v100, v100, v120
s_add_u32 m0, s27, 32768
Mvva 212,44,204
v_mul_f32 v101, v101, v120
Mvva 216,40,224
TR 36,8,8192
v_mul_f32 v102, v102, v120
v_mul_f32 v103, v103, v120
Mvva 216,44,228
CV 112,96,97
Mvva 220,40,232
TR 38,8,12288
CV 113,98,99
Mvva 220,44,236
WL 8
DM 24,12,25,0
CV 114,100,101
Mvva 224,48,192
TR 40,9,0
CV 115,102,103
Mvva 224,52,196
buffer_store_dwordx4 v[112:115], v30, s[16:19], s52 offen offset:3072 sc1
AR 104,212
Mvva 228,48,200
TR 42,9,4096
AR 105,213
Mvva 228,52,204
DM 25,12,25,1024
Mvva 232,48,224
TR 44,9,8192
AR 106,214
AR 107,215
Mvva 232,52,228
AR 108,244
Mvva 236,48,232
TR 46,9,12288
AR 109,245
AR 110,246
Mvva 236,52,236
WL 8
DM 26,12,25,2048
Mvva 240,56,192
TR 48,10,0
AR 111,247
Mvva 240,60,196
v_mul_f32 v104, v104, v122
v_mul_f32 v105, v105, v122
Mvva 244,56,200
TR 50,10,4096
v_mul_f32 v106, v106, v122
Mvva 244,60,204
v_mul_f32 v107, v107, v122
DM 27,12,25,3072
Mvva 248,56,224
TR 52,10,8192
v_mul_f32 v108, v108, v122
Mvva 248,60,228
v_mul_f32 v109, v109, v122
Mvva 252,56,232
TR 54,10,12288
v_mul_f32 v110, v110, v122
v_mul_f32 v111, v111, v122
Mvva 252,60,236
WL 8
CV 116,104,105
Mvva 128,32,0
TR 56,11,0
s_add_u32 s25, s25, 524288
CV 117,106,107
Mvva 128,36,4
CV 118,108,109
Mvva 132,32,8
TR 58,11,4096
CV 119,110,111
Mvva 132,36,12
buffer_store_dwordx4 v[116:119], v30, s[16:19], s53 offen offset:3072 sc1
AR 96,216
Mvva 136,32,16
TR 60,11,8192
buffer_load_dwordx4 a[128:131], v64, s[8:11], s24 offen offset:0 sc1
Mvva 136,36,20
AR 97,217
AR 98,218
Mvva 140,32,24
TR 62,11,12288
AR 99,219
Mvva 140,36,28
WL 8
AR 100,248
Mvva 144,40,0
TR 32,12,0
AR 101,249
buffer_load_dwordx4 a[132:135], v64, s[8:11], s24 offen offset:1024 sc1
Mvva 144,44,4
AR 102,250
Mvva 148,40,8
TR 34,12,4096
AR 103,251
v_mul_f32 v96, v96, v124
Mvva 148,44,12
v_mul_f32 v97, v97, v124
Mvva 152,40,16
TR 36,12,8192
v_mul_f32 v98, v98, v124
buffer_load_dwordx4 a[136:139], v65, s[8:11], s24 offen offset:0 sc1
Mvva 152,44,20
v_mul_f32 v99, v99, v124
Mvva 156,40,24
TR 38,12,12288
v_mul_f32 v100, v100, v124
Mvva 156,44,28
WL 8
v_mul_f32 v101, v101, v124
v_mul_f32 v102, v102, v124
Mvva 160,48,0
TR 40,13,0
v_mul_f32 v103, v103, v124
Mvva 160,52,4
buffer_load_dwordx4 a[140:143], v65, s[8:11], s24 offen offset:1024 sc1
CV 112,96,97
Mvva 164,48,8
TR 42,13,4096
CV 113,98,99
Mvva 164,52,12
CV 114,100,101
Mvva 168,48,16
TR 44,13,8192
CV 115,102,103
buffer_store_dwordx4 v[112:115], v30, s[16:19], s54 offen offset:3072 sc1
Mvva 168,52,20
buffer_load_dwordx4 a[160:163], v66, s[8:11], s24 offen offset:0 sc1
Mvva 172,48,24
TR 46,13,12288
AR 104,220
AR 105,221
Mvva 172,52,28
WL 8
AR 106,222
Mvva 176,56,0
TR 48,14,0
AR 107,223
Mvva 176,60,4
AR 108,252
buffer_load_dwordx4 a[164:167], v66, s[8:11], s24 offen offset:1024 sc1
Mvva 180,56,8
TR 50,14,4096
AR 109,253
Mvva 180,60,12
AR 110,254
AR 111,255
Mvva 184,56,16
TR 52,14,8192
v_mul_f32 v104, v104, v126
Mvva 184,60,20
v_mul_f32 v105, v105, v126
Mvva 188,56,24
TR 54,14,12288
buffer_load_dwordx4 a[168:171], v67, s[8:11], s24 offen offset:0 sc1
v_mul_f32 v106, v106, v126
Mvva 188,60,28
WL 8
v_mul_f32 v107, v107, v126
Mvva 192,32,0
TR 56,15,0
v_mul_f32 v108, v108, v126
v_mul_f32 v109, v109, v126
Mvva 192,36,4
v_mul_f32 v110, v110, v126
Mvva 196,32,8
TR 58,15,4096
buffer_load_dwordx4 a[172:175], v67, s[8:11], s24 offen offset:1024 sc1
Mvva 196,36,12
v_mul_f32 v111, v111, v126
CV 116,104,105
Mvva 200,32,16
TR 60,15,8192
CV 117,106,107
Mvva 200,36,20
CV 118,108,109
CV 119,110,111
Mvva 204,32,24
TR 62,15,12288
s_add_u32 s24, s24, 8192
Mvva 204,36,28
WL 8
buffer_store_dwordx4 v[116:119], v30, s[16:19], s55 offen offset:3072 sc1
s_waitcnt vmcnt(16)
s_barrier
Mvva 208,40,0
TR 32,8,16384
s_add_u32 m0, s27, 49152
Mvva 208,44,4
Mvva 212,40,8
TR 34,8,20480
DM 24,12,25,0
Mvva 212,44,12
Mvva 216,40,16
TR 36,8,24576
Mvva 216,44,20
DM 25,12,25,1024
Mvva 220,40,24
TR 38,8,28672
Mvva 220,44,28
WL 8
DM 26,12,25,2048
Mvva 224,48,0
TR 40,9,16384
Mvva 224,52,4
Mvva 228,48,8
TR 42,9,20480
DM 27,12,25,3072
Mvva 228,52,12
Mvva 232,48,16
TR 44,9,24576
s_sub_u32 s25, s25, 3145728
Mvva 232,52,20
Mvva 236,48,24
TR 46,9,28672
Mvva 236,52,28
WL 8
buffer_load_dwordx4 a[192:195], v64, s[8:11], s24 offen offset:0 sc1
Mvva 240,56,0
TR 48,10,16384
Mvva 240,60,4
buffer_load_dwordx4 a[196:199], v64, s[8:11], s24 offen offset:1024 sc1
Mvva 244,56,8
TR 50,10,20480
Mvva 244,60,12
Mvva 248,56,16
TR 52,10,24576
buffer_load_dwordx4 a[200:203], v65, s[8:11], s24 offen offset:0 sc1
Mvva 248,60,20
Mvva 252,56,24
TR 54,10,28672
Mvva 252,60,28
WL 8
buffer_load_dwordx4 a[204:207], v65, s[8:11], s24 offen offset:1024 sc1
Mvva 128,32,32
TR 56,11,16384
Mvva 128,36,36
buffer_load_dwordx4 a[224:227], v66, s[8:11], s24 offen offset:0 sc1
Mvva 132,32,40
TR 58,11,20480
Mvva 132,36,44
Mvva 136,32,48
TR 60,11,24576
buffer_load_dwordx4 a[228:231], v66, s[8:11], s24 offen offset:1024 sc1
Mvva 136,36,52
Mvva 140,32,56
TR 62,11,28672
buffer_load_dwordx4 a[232:235], v67, s[8:11], s24 offen offset:0 sc1
Mvva 140,36,60
WL 8
Mvva 144,40,32
TR 32,12,16384
Mvva 144,44,36
buffer_load_dwordx4 a[236:239], v67, s[8:11], s24 offen offset:1024 sc1
Mvva 148,40,40
TR 34,12,20480
Mvva 148,44,44
s_sub_u32 s24, s24, 49152
Mvva 152,40,48
TR 36,12,24576
Mvva 152,44,52
Mvva 156,40,56
TR 38,12,28672
s_mov_b32 m0, s46
Mvva 156,44,60
WL 8
Mvva 160,48,32
TR 40,13,16384
DM 90,20,42,0
Mvva 160,52,36
Mvva 164,48,40
TR 42,13,20480
Mvva 164,52,44
DM 91,20,42,1024
Mvva 168,48,48
TR 44,13,24576
Mvva 168,52,52
Mvva 172,48,56
TR 46,13,28672
DM 92,20,42,2048
Mvva 172,52,60
WL 8
Mvva 176,56,32
TR 48,14,16384
DM 93,20,42,3072
Mvva 176,60,36
Mvva 180,56,40
TR 50,14,20480
Mvva 180,60,44
buffer_load_dwordx4 v[72:75], v88, s[28:31], s43 offen offset:0 sc1
Mvva 184,56,48
TR 52,14,24576
Mvva 184,60,52
buffer_load_dwordx4 v[76:79], v88, s[28:31], s43 offen offset:1024 sc1
Mvva 188,56,56
TR 54,14,28672
Mvva 188,60,60
WL 8
Mvva 192,32,32
TR 56,15,16384
buffer_load_dwordx4 v[80:83], v88, s[28:31], s43 offen offset:2048 sc1
Mvva 192,36,36
Mvva 196,32,40
TR 58,15,20480
buffer_load_dwordx4 v[84:87], v88, s[28:31], s43 offen offset:3072 sc1
Mvva 196,36,44
Mvva 200,32,48
TR 60,15,24576
Mvva 200,36,52
buffer_load_dword v89, off, s[84:87], s51 sc1
Mvva 204,32,56
TR 62,15,28672
Mvva 204,36,60
WL 8
s_waitcnt vmcnt(0)
s_barrier
s_cmp_lg_u32 s3, 0
s_cbranch_scc1 A1_sg1
s_mov_b64 exec, 1
v_mov_b32 v3, 1
buffer_atomic_add v3, off, s[84:87], s49 sc1
s_mov_b64 exec, -1
A1_sg1:
v_cmp_ne_u32 vcc, 8, v89
s_nop 1
s_cbranch_vccnz B4_f1_w
B4_f1_k:
Mvva 208,40,32
TR 32,8,32768
Mvva 208,44,36
s_add_u32 m0, s27, 0
Mvva 212,40,40
TR 34,8,36864
Mvva 212,44,44
DM 24,12,25,0
Mvva 216,40,48
TR 36,8,40960
Mvva 216,44,52
Mvva 220,40,56
TR 38,8,45056
Mvva 220,44,60
WL 8
Mvva 224,48,32
TR 40,9,32768
Mvva 224,52,36
DM 25,12,25,1024
Mvva 228,48,40
TR 42,9,36864
Mvva 228,52,44
DM 26,12,25,2048
Mvva 232,48,48
TR 44,9,40960
Mvva 232,52,52
Mvva 236,48,56
TR 46,9,45056
Mvva 236,52,60
WL 8
Mvva 240,56,32
TR 48,10,32768
Mvva 240,60,36
DM 27,12,25,3072
Mvva 244,56,40
TR 50,10,36864
Mvva 244,60,44
Mvva 248,56,48
TR 52,10,40960
Mvva 248,60,52
s_add_u32 s25, s25, 917504
Mvva 252,56,56
TR 54,10,45056
Mvva 252,60,60
WL 8
Mvva 128,32,128
TR 56,11,32768
Mvva 128,36,132
buffer_load_dwordx4 a[0:3], v64, s[8:11], s24 offen offset:0 sc1
Mvva 132,32,136
TR 58,11,36864
Mvva 132,36,140
Mvva 136,32,160
TR 60,11,40960
Mvva 136,36,164
buffer_load_dwordx4 a[4:7], v64, s[8:11], s24 offen offset:1024 sc1
Mvva 140,32,168
TR 62,11,45056
Mvva 140,36,172
WL 8
Mvva 144,40,128
TR 32,12,32768
Mvva 144,44,132
buffer_load_dwordx4 a[8:11], v65, s[8:11], s24 offen offset:0 sc1
Mvva 148,40,136
TR 34,12,36864
Mvva 148,44,140
Mvva 152,40,160
TR 36,12,40960
Mvva 152,44,164
buffer_load_dwordx4 a[12:15], v65, s[8:11], s24 offen offset:1024 sc1
Mvva 156,40,168
TR 38,12,45056
Mvva 156,44,172
WL 8
Mvva 160,48,128
TR 40,13,32768
Mvva 160,52,132
Mvva 164,48,136
TR 42,13,36864
Mvva 164,52,140
buffer_load_dwordx4 a[16:19], v66, s[8:11], s24 offen offset:0 sc1
Mvva 168,48,160
TR 44,13,40960
Mvva 168,52,164
buffer_load_dwordx4 a[20:23], v66, s[8:11], s24 offen offset:1024 sc1
Mvva 172,48,168
TR 46,13,45056
Mvva 172,52,172
WL 8
Mvva 176,56,128
TR 48,14,32768
Mvva 176,60,132
Mvva 180,56,136
TR 50,14,36864
Mvva 180,60,140
buffer_load_dwordx4 a[24:27], v67, s[8:11], s24 offen offset:0 sc1
Mvva 184,56,160
TR 52,14,40960
Mvva 184,60,164
buffer_load_dwordx4 a[28:31], v67, s[8:11], s24 offen offset:1024 sc1
Mvva 188,56,168
TR 54,14,45056
Mvva 188,60,172
WL 8
Mvva 192,32,128
TR 56,15,32768
Mvva 192,36,132
Mvva 196,32,136
TR 58,15,36864
Mvva 196,36,140
s_add_u32 s24, s24, 14336
Mvva 200,32,160
TR 60,15,40960
Mvva 200,36,164
Mvva 204,32,168
TR 62,15,45056
Mvva 204,36,172
WL 8
s_mov_b32 s32, 2
B4_loop:
s_waitcnt vmcnt(12)
s_barrier
Mvva 208,40,128
TR 32,8,49152
Mvva 208,44,132
s_add_u32 m0, s27, 16384
Mvva 212,40,136
TR 34,8,53248
Mvva 212,44,140
DM 24,12,25,0
Mvva 216,40,160
TR 36,8,57344
Mvva 216,44,164
Mvva 220,40,168
TR 38,8,61440
Mvva 220,44,172
WL 8
Mvva 224,48,128
TR 40,9,49152
Mvva 224,52,132
DM 25,12,25,1024
Mvva 228,48,136
TR 42,9,53248
Mvva 228,52,140
DM 26,12,25,2048
Mvva 232,48,160
TR 44,9,57344
Mvva 232,52,164
Mvva 236,48,168
TR 46,9,61440
Mvva 236,52,172
WL 8
Mvva 240,56,128
TR 48,10,49152
Mvva 240,60,132
DM 27,12,25,3072
Mvva 244,56,136
TR 50,10,53248
Mvva 244,60,140
Mvva 248,56,160
TR 52,10,57344
Mvva 248,60,164
s_add_u32 s25, s25, 917504
Mvva 252,56,168
TR 54,10,61440
Mvva 252,60,172
WL 8
Mvva 128,32,192
TR 56,11,49152
Mvva 128,36,196
buffer_load_dwordx4 a[32:35], v64, s[8:11], s24 offen offset:0 sc1
Mvva 132,32,200
TR 58,11,53248
Mvva 132,36,204
Mvva 136,32,224
TR 60,11,57344
Mvva 136,36,228
buffer_load_dwordx4 a[36:39], v64, s[8:11], s24 offen offset:1024 sc1
Mvva 140,32,232
TR 62,11,61440
Mvva 140,36,236
WL 8
Mvva 144,40,192
TR 32,12,49152
Mvva 144,44,196
buffer_load_dwordx4 a[40:43], v65, s[8:11], s24 offen offset:0 sc1
Mvva 148,40,200
TR 34,12,53248
Mvva 148,44,204
Mvva 152,40,224
TR 36,12,57344
Mvva 152,44,228
buffer_load_dwordx4 a[44:47], v65, s[8:11], s24 offen offset:1024 sc1
Mvva 156,40,232
TR 38,12,61440
Mvva 156,44,236
WL 8
Mvva 160,48,192
TR 40,13,49152
Mvva 160,52,196
Mvva 164,48,200
TR 42,13,53248
Mvva 164,52,204
buffer_load_dwordx4 a[48:51], v66, s[8:11], s24 offen offset:0 sc1
Mvva 168,48,224
TR 44,13,57344
Mvva 168,52,228
buffer_load_dwordx4 a[52:55], v66, s[8:11], s24 offen offset:1024 sc1
Mvva 172,48,232
TR 46,13,61440
Mvva 172,52,236
WL 8
Mvva 176,56,192
TR 48,14,49152
Mvva 176,60,196
Mvva 180,56,200
TR 50,14,53248
Mvva 180,60,204
buffer_load_dwordx4 a[56:59], v67, s[8:11], s24 offen offset:0 sc1
Mvva 184,56,224
TR 52,14,57344
Mvva 184,60,228
buffer_load_dwordx4 a[60:63], v67, s[8:11], s24 offen offset:1024 sc1
Mvva 188,56,232
TR 54,14,61440
Mvva 188,60,236
WL 8
Mvva 192,32,192
TR 56,15,49152
Mvva 192,36,196
Mvva 196,32,200
TR 58,15,53248
Mvva 196,36,204
s_add_u32 s24, s24, 14336
Mvva 200,32,224
TR 60,15,57344
Mvva 200,36,228
Mvva 204,32,232
TR 62,15,61440
Mvva 204,36,236
WL 8
s_waitcnt vmcnt(12)
s_barrier
Mvva 208,40,192
TR 32,8,0
Mvva 208,44,196
s_add_u32 m0, s27, 32768
Mvva 212,40,200
TR 34,8,4096
Mvva 212,44,204
DM 24,12,25,0
Mvva 216,40,224
TR 36,8,8192
Mvva 216,44,228
Mvva 220,40,232
TR 38,8,12288
Mvva 220,44,236
WL 8
Mvva 224,48,192
TR 40,9,0
Mvva 224,52,196
DM 25,12,25,1024
Mvva 228,48,200
TR 42,9,4096
Mvva 228,52,204
DM 26,12,25,2048
Mvva 232,48,224
TR 44,9,8192
Mvva 232,52,228
Mvva 236,48,232
TR 46,9,12288
Mvva 236,52,236
WL 8
Mvva 240,56,192
TR 48,10,0
Mvva 240,60,196
DM 27,12,25,3072
Mvva 244,56,200
TR 50,10,4096
Mvva 244,60,204
Mvva 248,56,224
TR 52,10,8192
Mvva 248,60,228
s_add_u32 s25, s25, 917504
Mvva 252,56,232
TR 54,10,12288
Mvva 252,60,236
WL 8
Mvva 128,32,0
TR 56,11,0
Mvva 128,36,4
buffer_load_dwordx4 a[128:131], v64, s[8:11], s24 offen offset:0 sc1
Mvva 132,32,8
TR 58,11,4096
Mvva 132,36,12
Mvva 136,32,16
TR 60,11,8192
Mvva 136,36,20
buffer_load_dwordx4 a[132:135], v64, s[8:11], s24 offen offset:1024 sc1
Mvva 140,32,24
TR 62,11,12288
Mvva 140,36,28
WL 8
Mvva 144,40,0
TR 32,12,0
Mvva 144,44,4
buffer_load_dwordx4 a[136:139], v65, s[8:11], s24 offen offset:0 sc1
Mvva 148,40,8
TR 34,12,4096
Mvva 148,44,12
Mvva 152,40,16
TR 36,12,8192
Mvva 152,44,20
buffer_load_dwordx4 a[140:143], v65, s[8:11], s24 offen offset:1024 sc1
Mvva 156,40,24
TR 38,12,12288
Mvva 156,44,28
WL 8
Mvva 160,48,0
TR 40,13,0
Mvva 160,52,4
Mvva 164,48,8
TR 42,13,4096
Mvva 164,52,12
buffer_load_dwordx4 a[160:163], v66, s[8:11], s24 offen offset:0 sc1
Mvva 168,48,16
TR 44,13,8192
Mvva 168,52,20
buffer_load_dwordx4 a[164:167], v66, s[8:11], s24 offen offset:1024 sc1
Mvva 172,48,24
TR 46,13,12288
Mvva 172,52,28
WL 8
Mvva 176,56,0
TR 48,14,0
Mvva 176,60,4
Mvva 180,56,8
TR 50,14,4096
Mvva 180,60,12
buffer_load_dwordx4 a[168:171], v67, s[8:11], s24 offen offset:0 sc1
Mvva 184,56,16
TR 52,14,8192
Mvva 184,60,20
buffer_load_dwordx4 a[172:175], v67, s[8:11], s24 offen offset:1024 sc1
Mvva 188,56,24
TR 54,14,12288
Mvva 188,60,28
WL 8
Mvva 192,32,0
TR 56,15,0
Mvva 192,36,4
Mvva 196,32,8
TR 58,15,4096
Mvva 196,36,12
s_add_u32 s24, s24, 14336
Mvva 200,32,16
TR 60,15,8192
Mvva 200,36,20
Mvva 204,32,24
TR 62,15,12288
Mvva 204,36,28
WL 8
s_waitcnt vmcnt(12)
s_barrier
Mvva 208,40,0
TR 32,8,16384
Mvva 208,44,4
s_add_u32 m0, s27, 49152
Mvva 212,40,8
TR 34,8,20480
Mvva 212,44,12
DM 24,12,25,0
Mvva 216,40,16
TR 36,8,24576
Mvva 216,44,20
Mvva 220,40,24
TR 38,8,28672
Mvva 220,44,28
WL 8
Mvva 224,48,0
TR 40,9,16384
Mvva 224,52,4
DM 25,12,25,1024
Mvva 228,48,8
TR 42,9,20480
Mvva 228,52,12
DM 26,12,25,2048
Mvva 232,48,16
TR 44,9,24576
Mvva 232,52,20
Mvva 236,48,24
TR 46,9,28672
Mvva 236,52,28
WL 8
Mvva 240,56,0
TR 48,10,16384
Mvva 240,60,4
DM 27,12,25,3072
Mvva 244,56,8
TR 50,10,20480
Mvva 244,60,12
Mvva 248,56,16
TR 52,10,24576
Mvva 248,60,20
s_sub_u32 s25, s25, 2621440
Mvva 252,56,24
TR 54,10,28672
Mvva 252,60,28
WL 8
Mvva 128,32,32
TR 56,11,16384
Mvva 128,36,36
buffer_load_dwordx4 a[192:195], v64, s[8:11], s24 offen offset:0 sc1
Mvva 132,32,40
TR 58,11,20480
Mvva 132,36,44
Mvva 136,32,48
TR 60,11,24576
Mvva 136,36,52
buffer_load_dwordx4 a[196:199], v64, s[8:11], s24 offen offset:1024 sc1
Mvva 140,32,56
TR 62,11,28672
Mvva 140,36,60
WL 8
Mvva 144,40,32
TR 32,12,16384
Mvva 144,44,36
buffer_load_dwordx4 a[200:203], v65, s[8:11], s24 offen offset:0 sc1
Mvva 148,40,40
TR 34,12,20480
Mvva 148,44,44
Mvva 152,40,48
TR 36,12,24576
Mvva 152,44,52
buffer_load_dwordx4 a[204:207], v65, s[8:11], s24 offen offset:1024 sc1
Mvva 156,40,56
TR 38,12,28672
Mvva 156,44,60
WL 8
Mvva 160,48,32
TR 40,13,16384
Mvva 160,52,36
Mvva 164,48,40
TR 42,13,20480
Mvva 164,52,44
buffer_load_dwordx4 a[224:227], v66, s[8:11], s24 offen offset:0 sc1
Mvva 168,48,48
TR 44,13,24576
Mvva 168,52,52
buffer_load_dwordx4 a[228:231], v66, s[8:11], s24 offen offset:1024 sc1
Mvva 172,48,56
TR 46,13,28672
Mvva 172,52,60
WL 8
Mvva 176,56,32
TR 48,14,16384
Mvva 176,60,36
Mvva 180,56,40
TR 50,14,20480
Mvva 180,60,44
buffer_load_dwordx4 a[232:235], v67, s[8:11], s24 offen offset:0 sc1
Mvva 184,56,48
TR 52,14,24576
Mvva 184,60,52
buffer_load_dwordx4 a[236:239], v67, s[8:11], s24 offen offset:1024 sc1
Mvva 188,56,56
TR 54,14,28672
Mvva 188,60,60
WL 8
Mvva 192,32,32
TR 56,15,16384
Mvva 192,36,36
Mvva 196,32,40
TR 58,15,20480
Mvva 196,36,44
s_sub_u32 s24, s24, 40960
Mvva 200,32,48
TR 60,15,24576
Mvva 200,36,52
Mvva 204,32,56
TR 62,15,28672
Mvva 204,36,60
WL 8
s_waitcnt vmcnt(12)
s_barrier
Mvva 208,40,32
TR 32,8,32768
Mvva 208,44,36
s_add_u32 m0, s27, 0
Mvva 212,40,40
TR 34,8,36864
Mvva 212,44,44
DM 24,12,25,0
Mvva 216,40,48
TR 36,8,40960
Mvva 216,44,52
Mvva 220,40,56
TR 38,8,45056
Mvva 220,44,60
WL 8
Mvva 224,48,32
TR 40,9,32768
Mvva 224,52,36
DM 25,12,25,1024
Mvva 228,48,40
TR 42,9,36864
Mvva 228,52,44
DM 26,12,25,2048
Mvva 232,48,48
TR 44,9,40960
Mvva 232,52,52
Mvva 236,48,56
TR 46,9,45056
Mvva 236,52,60
WL 8
Mvva 240,56,32
TR 48,10,32768
Mvva 240,60,36
DM 27,12,25,3072
Mvva 244,56,40
TR 50,10,36864
Mvva 244,60,44
Mvva 248,56,48
TR 52,10,40960
Mvva 248,60,52
s_add_u32 s25, s25, 917504
Mvva 252,56,56
TR 54,10,45056
Mvva 252,60,60
WL 8
Mvva 128,32,128
TR 56,11,32768
Mvva 128,36,132
buffer_load_dwordx4 a[0:3], v64, s[8:11], s24 offen offset:0 sc1
Mvva 132,32,136
TR 58,11,36864
Mvva 132,36,140
Mvva 136,32,160
TR 60,11,40960
Mvva 136,36,164
buffer_load_dwordx4 a[4:7], v64, s[8:11], s24 offen offset:1024 sc1
Mvva 140,32,168
TR 62,11,45056
Mvva 140,36,172
WL 8
Mvva 144,40,128
TR 32,12,32768
Mvva 144,44,132
buffer_load_dwordx4 a[8:11], v65, s[8:11], s24 offen offset:0 sc1
Mvva 148,40,136
TR 34,12,36864
Mvva 148,44,140
Mvva 152,40,160
TR 36,12,40960
Mvva 152,44,164
buffer_load_dwordx4 a[12:15], v65, s[8:11], s24 offen offset:1024 sc1
Mvva 156,40,168
TR 38,12,45056
Mvva 156,44,172
WL 8
Mvva 160,48,128
TR 40,13,32768
Mvva 160,52,132
Mvva 164,48,136
TR 42,13,36864
Mvva 164,52,140
buffer_load_dwordx4 a[16:19], v66, s[8:11], s24 offen offset:0 sc1
Mvva 168,48,160
TR 44,13,40960
Mvva 168,52,164
buffer_load_dwordx4 a[20:23], v66, s[8:11], s24 offen offset:1024 sc1
Mvva 172,48,168
TR 46,13,45056
Mvva 172,52,172
WL 8
Mvva 176,56,128
TR 48,14,32768
Mvva 176,60,132
Mvva 180,56,136
TR 50,14,36864
Mvva 180,60,140
buffer_load_dwordx4 a[24:27], v67, s[8:11], s24 offen offset:0 sc1
Mvva 184,56,160
TR 52,14,40960
Mvva 184,60,164
buffer_load_dwordx4 a[28:31], v67, s[8:11], s24 offen offset:1024 sc1
Mvva 188,56,168
TR 54,14,45056
Mvva 188,60,172
WL 8
Mvva 192,32,128
TR 56,15,32768
Mvva 192,36,132
Mvva 196,32,136
TR 58,15,36864
Mvva 196,36,140
s_add_u32 s24, s24, 14336
Mvva 200,32,160
TR 60,15,40960
Mvva 200,36,164
Mvva 204,32,168
TR 62,15,45056
s_sub_u32 s32, s32, 1
Mvva 204,36,172
WL 8
s_cmp_lg_u32 s32, 0
s_cbranch_scc1 B4_loop
s_waitcnt vmcnt(12)
s_barrier
Mvva 208,40,128
TR 32,8,49152
Mvva 208,44,132
s_add_u32 m0, s27, 16384
Mvva 212,40,136
TR 34,8,53248
Mvva 212,44,140
DM 24,12,25,0
Mvva 216,40,160
TR 36,8,57344
Mvva 216,44,164
Mvva 220,40,168
TR 38,8,61440
Mvva 220,44,172
WL 8
Mvva 224,48,128
TR 40,9,49152
Mvva 224,52,132
DM 25,12,25,1024
Mvva 228,48,136
TR 42,9,53248
Mvva 228,52,140
DM 26,12,25,2048
Mvva 232,48,160
TR 44,9,57344
Mvva 232,52,164
Mvva 236,48,168
TR 46,9,61440
Mvva 236,52,172
WL 8
Mvva 240,56,128
TR 48,10,49152
Mvva 240,60,132
DM 27,12,25,3072
Mvva 244,56,136
TR 50,10,53248
Mvva 244,60,140
Mvva 248,56,160
TR 52,10,57344
Mvva 248,60,164
s_add_u32 s25, s25, 917504
Mvva 252,56,168
TR 54,10,61440
Mvva 252,60,172
WL 8
Mvva 128,32,192
TR 56,11,49152
Mvva 128,36,196
buffer_load_dwordx4 a[32:35], v64, s[8:11], s24 offen offset:0 sc1
Mvva 132,32,200
TR 58,11,53248
Mvva 132,36,204
Mvva 136,32,224
TR 60,11,57344
Mvva 136,36,228
buffer_load_dwordx4 a[36:39], v64, s[8:11], s24 offen offset:1024 sc1
Mvva 140,32,232
TR 62,11,61440
Mvva 140,36,236
WL 8
Mvva 144,40,192
TR 32,12,49152
Mvva 144,44,196
buffer_load_dwordx4 a[40:43], v65, s[8:11], s24 offen offset:0 sc1
Mvva 148,40,200
TR 34,12,53248
Mvva 148,44,204
Mvva 152,40,224
TR 36,12,57344
Mvva 152,44,228
buffer_load_dwordx4 a[44:47], v65, s[8:11], s24 offen offset:1024 sc1
Mvva 156,40,232
TR 38,12,61440
Mvva 156,44,236
WL 8
Mvva 160,48,192
TR 40,13,49152
Mvva 160,52,196
Mvva 164,48,200
TR 42,13,53248
Mvva 164,52,204
buffer_load_dwordx4 a[48:51], v66, s[8:11], s24 offen offset:0 sc1
Mvva 168,48,224
TR 44,13,57344
Mvva 168,52,228
buffer_load_dwordx4 a[52:55], v66, s[8:11], s24 offen offset:1024 sc1
Mvva 172,48,232
TR 46,13,61440
Mvva 172,52,236
WL 8
Mvva 176,56,192
TR 48,14,49152
Mvva 176,60,196
Mvva 180,56,200
TR 50,14,53248
Mvva 180,60,204
buffer_load_dwordx4 a[56:59], v67, s[8:11], s24 offen offset:0 sc1
Mvva 184,56,224
TR 52,14,57344
Mvva 184,60,228
buffer_load_dwordx4 a[60:63], v67, s[8:11], s24 offen offset:1024 sc1
Mvva 188,56,232
TR 54,14,61440
Mvva 188,60,236
WL 8
Mvva 192,32,192
TR 56,15,49152
Mvva 192,36,196
Mvva 196,32,200
TR 58,15,53248
Mvva 196,36,204
s_add_u32 s24, s24, 14336
Mvva 200,32,224
TR 60,15,57344
Mvva 200,36,228
Mvva 204,32,232
TR 62,15,61440
Mvva 204,36,236
WL 8
s_waitcnt vmcnt(12)
s_barrier
Mvva 208,40,192
TR 32,8,0
Mvva 208,44,196
s_add_u32 m0, s27, 32768
Mvva 212,40,200
TR 34,8,4096
Mvva 212,44,204
DM 24,12,25,0
Mvva 216,40,224
TR 36,8,8192
Mvva 216,44,228
Mvva 220,40,232
TR 38,8,12288
Mvva 220,44,236
WL 8
Mvva 224,48,192
TR 40,9,0
Mvva 224,52,196
DM 25,12,25,1024
Mvva 228,48,200
TR 42,9,4096
Mvva 228,52,204
DM 26,12,25,2048
Mvva 232,48,224
TR 44,9,8192
Mvva 232,52,228
Mvva 236,48,232
TR 46,9,12288
Mvva 236,52,236
WL 8
Mvva 240,56,192
TR 48,10,0
Mvva 240,60,196
DM 27,12,25,3072
Mvva 244,56,200
TR 50,10,4096
Mvva 244,60,204
Mvva 248,56,224
TR 52,10,8192
Mvva 248,60,228
s_add_u32 s25, s25, 917504
Mvva 252,56,232
TR 54,10,12288
Mvva 252,60,236
WL 8
Mvva 128,32,0
TR 56,11,0
Mvva 128,36,4
buffer_load_dwordx4 a[128:131], v64, s[8:11], s24 offen offset:0 sc1
Mvva 132,32,8
TR 58,11,4096
Mvva 132,36,12
Mvva 136,32,16
TR 60,11,8192
Mvva 136,36,20
buffer_load_dwordx4 a[132:135], v64, s[8:11], s24 offen offset:1024 sc1
Mvva 140,32,24
TR 62,11,12288
Mvva 140,36,28
WL 8
Mvva 144,40,0
TR 32,12,0
Mvva 144,44,4
buffer_load_dwordx4 a[136:139], v65, s[8:11], s24 offen offset:0 sc1
Mvva 148,40,8
TR 34,12,4096
Mvva 148,44,12
Mvva 152,40,16
TR 36,12,8192
Mvva 152,44,20
buffer_load_dwordx4 a[140:143], v65, s[8:11], s24 offen offset:1024 sc1
Mvva 156,40,24
TR 38,12,12288
Mvva 156,44,28
WL 8
Mvva 160,48,0
TR 40,13,0
Mvva 160,52,4
Mvva 164,48,8
TR 42,13,4096
Mvva 164,52,12
buffer_load_dwordx4 a[160:163], v66, s[8:11], s24 offen offset:0 sc1
Mvva 168,48,16
TR 44,13,8192
Mvva 168,52,20
buffer_load_dwordx4 a[164:167], v66, s[8:11], s24 offen offset:1024 sc1
Mvva 172,48,24
TR 46,13,12288
Mvva 172,52,28
WL 8
Mvva 176,56,0
TR 48,14,0
Mvva 176,60,4
Mvva 180,56,8
TR 50,14,4096
Mvva 180,60,12
buffer_load_dwordx4 a[168:171], v67, s[8:11], s24 offen offset:0 sc1
Mvva 184,56,16
TR 52,14,8192
Mvva 184,60,20
buffer_load_dwordx4 a[172:175], v67, s[8:11], s24 offen offset:1024 sc1
Mvva 188,56,24
TR 54,14,12288
Mvva 188,60,28
WL 8
Mvva 192,32,0
TR 56,15,0
Mvva 192,36,4
Mvva 196,32,8
TR 58,15,4096
Mvva 196,36,12
s_add_u32 s24, s24, 14336
Mvva 200,32,16
TR 60,15,8192
Mvva 200,36,20
Mvva 204,32,24
TR 62,15,12288
Mvva 204,36,28
WL 8
s_waitcnt vmcnt(12)
s_barrier
Mvva 208,40,0
TR 32,8,16384
Mvva 208,44,4
s_add_u32 m0, s27, 49152
Mvva 212,40,8
TR 34,8,20480
Mvva 212,44,12
DM 24,12,25,0
Mvva 216,40,16
TR 36,8,24576
Mvva 216,44,20
Mvva 220,40,24
TR 38,8,28672
Mvva 220,44,28
WL 8
Mvva 224,48,0
TR 40,9,16384
Mvva 224,52,4
DM 25,12,25,1024
Mvva 228,48,8
TR 42,9,20480
Mvva 228,52,12
DM 26,12,25,2048
Mvva 232,48,16
TR 44,9,24576
Mvva 232,52,20
Mvva 236,48,24
TR 46,9,28672
Mvva 236,52,28
WL 8
Mvva 240,56,0
TR 48,10,16384
Mvva 240,60,4
DM 27,12,25,3072
Mvva 244,56,8
TR 50,10,20480
Mvva 244,60,12
Mvva 248,56,16
TR 52,10,24576
Mvva 248,60,20
s_sub_u32 s25, s25, 2490368
Mvva 252,56,24
TR 54,10,28672
Mvva 252,60,28
WL 8
Mvva 128,32,32
TR 56,11,16384
Mvva 128,36,36
buffer_load_dwordx4 a[192:195], v64, s[8:11], s24 offen offset:0 sc1
Mvva 132,32,40
TR 58,11,20480
Mvva 132,36,44
Mvva 136,32,48
TR 60,11,24576
Mvva 136,36,52
buffer_load_dwordx4 a[196:199], v64, s[8:11], s24 offen offset:1024 sc1
Mvva 140,32,56
TR 62,11,28672
Mvva 140,36,60
WL 8
Mvva 144,40,32
TR 32,12,16384
Mvva 144,44,36
buffer_load_dwordx4 a[200:203], v65, s[8:11], s24 offen offset:0 sc1
Mvva 148,40,40
TR 34,12,20480
Mvva 148,44,44
Mvva 152,40,48
TR 36,12,24576
Mvva 152,44,52
buffer_load_dwordx4 a[204:207], v65, s[8:11], s24 offen offset:1024 sc1
Mvva 156,40,56
TR 38,12,28672
Mvva 156,44,60
WL 8
Mvva 160,48,32
TR 40,13,16384
Mvva 160,52,36
Mvva 164,48,40
TR 42,13,20480
Mvva 164,52,44
buffer_load_dwordx4 a[224:227], v66, s[8:11], s24 offen offset:0 sc1
Mvva 168,48,48
TR 44,13,24576
Mvva 168,52,52
buffer_load_dwordx4 a[228:231], v66, s[8:11], s24 offen offset:1024 sc1
Mvva 172,48,56
TR 46,13,28672
Mvva 172,52,60
WL 8
Mvva 176,56,32
TR 48,14,16384
Mvva 176,60,36
Mvva 180,56,40
TR 50,14,20480
Mvva 180,60,44
buffer_load_dwordx4 a[232:235], v67, s[8:11], s24 offen offset:0 sc1
Mvva 184,56,48
TR 52,14,24576
Mvva 184,60,52
buffer_load_dwordx4 a[236:239], v67, s[8:11], s24 offen offset:1024 sc1
Mvva 188,56,56
TR 54,14,28672
Mvva 188,60,60
WL 8
Mvva 192,32,32
TR 56,15,16384
Mvva 192,36,36
Mvva 196,32,40
TR 58,15,20480
Mvva 196,36,44
s_sub_u32 s24, s24, 38912
Mvva 200,32,48
TR 60,15,24576
Mvva 200,36,52
Mvva 204,32,56
TR 62,15,28672
Mvva 204,36,60
WL 8
s_waitcnt vmcnt(12)
s_barrier
Mvva 208,40,32
TR 32,8,32768
Mvva 208,44,36
s_add_u32 m0, s27, 0
Mvva 212,40,40
TR 34,8,36864
Mvva 212,44,44
DM 24,12,25,0
Mvva 216,40,48
TR 36,8,40960
Mvva 216,44,52
Mvva 220,40,56
TR 38,8,45056
Mvva 220,44,60
WL 8
Mvva 224,48,32
TR 40,9,32768
Mvva 224,52,36
DM 25,12,25,1024
Mvva 228,48,40
TR 42,9,36864
Mvva 228,52,44
DM 26,12,25,2048
Mvva 232,48,48
TR 44,9,40960
Mvva 232,52,52
Mvva 236,48,56
TR 46,9,45056
Mvva 236,52,60
WL 8
Mvva 240,56,32
TR 48,10,32768
Mvva 240,60,36
DM 27,12,25,3072
Mvva 244,56,40
TR 50,10,36864
Mvva 244,60,44
Mvva 248,56,48
TR 52,10,40960
Mvva 248,60,52
s_add_u32 s25, s25, 917504
Mvva 252,56,56
TR 54,10,45056
Mvva 252,60,60
WL 8
Mvva 128,32,128
TR 56,11,32768
Mvva 128,36,132
buffer_load_dwordx4 a[0:3], v64, s[8:11], s24 offen offset:0 sc1
Mvva 132,32,136
TR 58,11,36864
Mvva 132,36,140
Mvva 136,32,160
TR 60,11,40960
Mvva 136,36,164
buffer_load_dwordx4 a[4:7], v64, s[8:11], s24 offen offset:1024 sc1
Mvva 140,32,168
TR 62,11,45056
Mvva 140,36,172
WL 8
Mvva 144,40,128
TR 32,12,32768
Mvva 144,44,132
buffer_load_dwordx4 a[8:11], v65, s[8:11], s24 offen offset:0 sc1
Mvva 148,40,136
TR 34,12,36864
Mvva 148,44,140
Mvva 152,40,160
TR 36,12,40960
Mvva 152,44,164
buffer_load_dwordx4 a[12:15], v65, s[8:11], s24 offen offset:1024 sc1
Mvva 156,40,168
TR 38,12,45056
Mvva 156,44,172
WL 8
Mvva 160,48,128
TR 40,13,32768
Mvva 160,52,132
Mvva 164,48,136
TR 42,13,36864
Mvva 164,52,140
buffer_load_dwordx4 a[16:19], v66, s[8:11], s24 offen offset:0 sc1
Mvva 168,48,160
TR 44,13,40960
Mvva 168,52,164
buffer_load_dwordx4 a[20:23], v66, s[8:11], s24 offen offset:1024 sc1
Mvva 172,48,168
TR 46,13,45056
Mvva 172,52,172
WL 8
Mvva 176,56,128
TR 48,14,32768
Mvva 176,60,132
Mvva 180,56,136
TR 50,14,36864
Mvva 180,60,140
buffer_load_dwordx4 a[24:27], v67, s[8:11], s24 offen offset:0 sc1
Mvva 184,56,160
TR 52,14,40960
Mvva 184,60,164
buffer_load_dwordx4 a[28:31], v67, s[8:11], s24 offen offset:1024 sc1
Mvva 188,56,168
TR 54,14,45056
Mvva 188,60,172
WL 8
Mvva 192,32,128
TR 56,15,32768
Mvva 192,36,132
Mvva 196,32,136
TR 58,15,36864
Mvva 196,36,140
s_add_u32 s24, s24, 14336
Mvva 200,32,160
TR 60,15,40960
Mvva 200,36,164
Mvva 204,32,168
TR 62,15,45056
Mvva 204,36,172
WL 8
s_waitcnt vmcnt(12)
s_barrier
Mvva 208,40,128
TR 32,8,49152
Mvva 208,44,132
s_add_u32 m0, s27, 16384
Mvva 212,40,136
TR 34,8,53248
Mvva 212,44,140
DM 24,12,25,0
Mvva 216,40,160
TR 36,8,57344
Mvva 216,44,164
Mvva 220,40,168
TR 38,8,61440
Mvva 220,44,172
WL 8
Mvva 224,48,128
TR 40,9,49152
Mvva 224,52,132
DM 25,12,25,1024
Mvva 228,48,136
TR 42,9,53248
Mvva 228,52,140
DM 26,12,25,2048
Mvva 232,48,160
TR 44,9,57344
Mvva 232,52,164
Mvva 236,48,168
TR 46,9,61440
Mvva 236,52,172
WL 8
Mvva 240,56,128
TR 48,10,49152
Mvva 240,60,132
DM 27,12,25,3072
Mvva 244,56,136
TR 50,10,53248
Mvva 244,60,140
Mvva 248,56,160
TR 52,10,57344
Mvva 248,60,164
s_add_u32 s25, s25, 917504
Mvva 252,56,168
TR 54,10,61440
Mvva 252,60,172
WL 8
Mvva 128,32,192
TR 56,11,49152
Mvva 128,36,196
buffer_load_dwordx4 a[32:35], v64, s[8:11], s24 offen offset:0 sc1
Mvva 132,32,200
TR 58,11,53248
Mvva 132,36,204
Mvva 136,32,224
TR 60,11,57344
Mvva 136,36,228
buffer_load_dwordx4 a[36:39], v64, s[8:11], s24 offen offset:1024 sc1
Mvva 140,32,232
TR 62,11,61440
Mvva 140,36,236
WL 8
Mvva 144,40,192
TR 32,12,49152
Mvva 144,44,196
buffer_load_dwordx4 a[40:43], v65, s[8:11], s24 offen offset:0 sc1
Mvva 148,40,200
TR 34,12,53248
Mvva 148,44,204
Mvva 152,40,224
TR 36,12,57344
Mvva 152,44,228
buffer_load_dwordx4 a[44:47], v65, s[8:11], s24 offen offset:1024 sc1
Mvva 156,40,232
TR 38,12,61440
Mvva 156,44,236
WL 8
Mvva 160,48,192
TR 40,13,49152
Mvva 160,52,196
Mvva 164,48,200
TR 42,13,53248
Mvva 164,52,204
buffer_load_dwordx4 a[48:51], v66, s[8:11], s24 offen offset:0 sc1
Mvva 168,48,224
TR 44,13,57344
Mvva 168,52,228
buffer_load_dwordx4 a[52:55], v66, s[8:11], s24 offen offset:1024 sc1
Mvva 172,48,232
TR 46,13,61440
Mvva 172,52,236
WL 8
Mvva 176,56,192
TR 48,14,49152
Mvva 176,60,196
Mvva 180,56,200
TR 50,14,53248
Mvva 180,60,204
buffer_load_dwordx4 a[56:59], v67, s[8:11], s24 offen offset:0 sc1
Mvva 184,56,224
TR 52,14,57344
Mvva 184,60,228
buffer_load_dwordx4 a[60:63], v67, s[8:11], s24 offen offset:1024 sc1
Mvva 188,56,232
TR 54,14,61440
Mvva 188,60,236
WL 8
Mvva 192,32,192
TR 56,15,49152
Mvva 192,36,196
Mvva 196,32,200
TR 58,15,53248
Mvva 196,36,204
s_add_u32 s24, s24, 14336
Mvva 200,32,224
TR 60,15,57344
Mvva 200,36,228
Mvva 204,32,232
TR 62,15,61440
Mvva 204,36,236
WL 8
s_waitcnt vmcnt(12)
s_barrier
Mvva 208,40,192
TR 32,8,0
Mvva 208,44,196
s_add_u32 m0, s27, 32768
Mvva 212,40,200
TR 34,8,4096
Mvva 212,44,204
DM 24,12,25,0
Mvva 216,40,224
TR 36,8,8192
Mvva 216,44,228
Mvva 220,40,232
TR 38,8,12288
Mvva 220,44,236
WL 8
Mvva 224,48,192
TR 40,9,0
Mvva 224,52,196
DM 25,12,25,1024
Mvva 228,48,200
TR 42,9,4096
Mvva 228,52,204
DM 26,12,25,2048
Mvva 232,48,224
TR 44,9,8192
Mvva 232,52,228
Mvva 236,48,232
TR 46,9,12288
Mvva 236,52,236
WL 8
Mvva 240,56,192
TR 48,10,0
Mvva 240,60,196
DM 27,12,25,3072
Mvva 244,56,200
TR 50,10,4096
Mvva 244,60,204
Mvva 248,56,224
TR 52,10,8192
Mvva 248,60,228
s_add_u32 s25, s25, 917504
Mvva 252,56,232
TR 54,10,12288
Mvva 252,60,236
WL 8
Mvva 128,32,0
TR 56,11,0
Mvva 128,36,4
buffer_load_dwordx4 a[128:131], v64, s[8:11], s24 offen offset:0 sc1
Mvva 132,32,8
TR 58,11,4096
Mvva 132,36,12
Mvva 136,32,16
TR 60,11,8192
Mvva 136,36,20
buffer_load_dwordx4 a[132:135], v64, s[8:11], s24 offen offset:1024 sc1
Mvva 140,32,24
TR 62,11,12288
Mvva 140,36,28
WL 8
Mvva 144,40,0
TR 32,12,0
Mvva 144,44,4
buffer_load_dwordx4 a[136:139], v65, s[8:11], s24 offen offset:0 sc1
Mvva 148,40,8
TR 34,12,4096
Mvva 148,44,12
Mvva 152,40,16
TR 36,12,8192
Mvva 152,44,20
buffer_load_dwordx4 a[140:143], v65, s[8:11], s24 offen offset:1024 sc1
Mvva 156,40,24
TR 38,12,12288
Mvva 156,44,28
WL 8
Mvva 160,48,0
TR 40,13,0
Mvva 160,52,4
Mvva 164,48,8
TR 42,13,4096
Mvva 164,52,12
buffer_load_dwordx4 a[160:163], v66, s[8:11], s24 offen offset:0 sc1
Mvva 168,48,16
TR 44,13,8192
Mvva 168,52,20
buffer_load_dwordx4 a[164:167], v66, s[8:11], s24 offen offset:1024 sc1
Mvva 172,48,24
TR 46,13,12288
Mvva 172,52,28
WL 8
Mvva 176,56,0
TR 48,14,0
Mvva 176,60,4
Mvva 180,56,8
TR 50,14,4096
Mvva 180,60,12
buffer_load_dwordx4 a[168:171], v67, s[8:11], s24 offen offset:0 sc1
Mvva 184,56,16
TR 52,14,8192
Mvva 184,60,20
buffer_load_dwordx4 a[172:175], v67, s[8:11], s24 offen offset:1024 sc1
Mvva 188,56,24
TR 54,14,12288
Mvva 188,60,28
WL 8
Mvva 192,32,0
TR 56,15,0
Mvva 192,36,4
Mvva 196,32,8
TR 58,15,4096
Mvva 196,36,12
s_add_u32 s24, s24, 14336
Mvva 200,32,16
TR 60,15,8192
Mvva 200,36,20
Mvva 204,32,24
TR 62,15,12288
Mvva 204,36,28
WL 8
s_waitcnt vmcnt(12)
s_barrier
Mvva 208,40,0
TR 32,8,16384
Mvva 208,44,4
s_add_u32 m0, s27, 49152
Mvva 212,40,8
TR 34,8,20480
Mvva 212,44,12
DM 24,12,25,0
Mvva 216,40,16
TR 36,8,24576
Mvva 216,44,20
Mvva 220,40,24
TR 38,8,28672
Mvva 220,44,28
WL 8
Mvva 224,48,0
TR 40,9,16384
Mvva 224,52,4
DM 25,12,25,1024
Mvva 228,48,8
TR 42,9,20480
Mvva 228,52,12
DM 26,12,25,2048
Mvva 232,48,16
TR 44,9,24576
Mvva 232,52,20
Mvva 236,48,24
TR 46,9,28672
Mvva 236,52,28
WL 8
Mvva 240,56,0
TR 48,10,16384
Mvva 240,60,4
DM 27,12,25,3072
Mvva 244,56,8
TR 50,10,20480
Mvva 244,60,12
Mvva 248,56,16
TR 52,10,24576
Mvva 248,60,20
s_sub_u32 s25, s25, 2621440
Mvva 252,56,24
TR 54,10,28672
Mvva 252,60,28
WL 8
Mvva 128,32,32
TR 56,11,16384
Mvva 128,36,36
buffer_load_dwordx4 a[192:195], v64, s[8:11], s24 offen offset:0 sc1
Mvva 132,32,40
TR 58,11,20480
Mvva 132,36,44
Mvva 136,32,48
TR 60,11,24576
Mvva 136,36,52
buffer_load_dwordx4 a[196:199], v64, s[8:11], s24 offen offset:1024 sc1
Mvva 140,32,56
TR 62,11,28672
Mvva 140,36,60
WL 8
Mvva 144,40,32
TR 32,12,16384
Mvva 144,44,36
buffer_load_dwordx4 a[200:203], v65, s[8:11], s24 offen offset:0 sc1
Mvva 148,40,40
TR 34,12,20480
Mvva 148,44,44
Mvva 152,40,48
TR 36,12,24576
Mvva 152,44,52
buffer_load_dwordx4 a[204:207], v65, s[8:11], s24 offen offset:1024 sc1
Mvva 156,40,56
TR 38,12,28672
Mvva 156,44,60
WL 8
Mvva 160,48,32
TR 40,13,16384
Mvva 160,52,36
Mvva 164,48,40
TR 42,13,20480
Mvva 164,52,44
buffer_load_dwordx4 a[224:227], v66, s[8:11], s24 offen offset:0 sc1
Mvva 168,48,48
TR 44,13,24576
Mvva 168,52,52
buffer_load_dwordx4 a[228:231], v66, s[8:11], s24 offen offset:1024 sc1
Mvva 172,48,56
TR 46,13,28672
Mvva 172,52,60
WL 8
Mvva 176,56,32
TR 48,14,16384
Mvva 176,60,36
Mvva 180,56,40
TR 50,14,20480
Mvva 180,60,44
buffer_load_dwordx4 a[232:235], v67, s[8:11], s24 offen offset:0 sc1
Mvva 184,56,48
TR 52,14,24576
Mvva 184,60,52
buffer_load_dwordx4 a[236:239], v67, s[8:11], s24 offen offset:1024 sc1
Mvva 188,56,56
TR 54,14,28672
Mvva 188,60,60
WL 8
Mvva 192,32,32
TR 56,15,16384
Mvva 192,36,36
Mvva 196,32,40
TR 58,15,20480
Mvva 196,36,44
s_sub_u32 s24, s24, 40960
Mvva 200,32,48
TR 60,15,24576
Mvva 200,36,52
Mvva 204,32,56
TR 62,15,28672
Mvva 204,36,60
WL 8
s_waitcnt vmcnt(12)
s_barrier
Mvva 208,40,32
TR 32,8,32768
Mvva 208,44,36
s_add_u32 m0, s27, 0
Mvva 212,40,40
TR 34,8,36864
Mvva 212,44,44
DM 24,12,25,0
Mvva 216,40,48
TR 36,8,40960
Mvva 216,44,52
Mvva 220,40,56
TR 38,8,45056
Mvva 220,44,60
WL 8
Mvva 224,48,32
TR 40,9,32768
Mvva 224,52,36
DM 25,12,25,1024
Mvva 228,48,40
TR 42,9,36864
Mvva 228,52,44
DM 26,12,25,2048
Mvva 232,48,48
TR 44,9,40960
Mvva 232,52,52
Mvva 236,48,56
TR 46,9,45056
Mvva 236,52,60
WL 8
Mvva 240,56,32
TR 48,10,32768
Mvva 240,60,36
DM 27,12,25,3072
Mvva 244,56,40
TR 50,10,36864
Mvva 244,60,44
Mvva 248,56,48
TR 52,10,40960
Mvva 248,60,52
s_add_u32 s25, s25, 917504
Mvva 252,56,56
TR 54,10,45056
Mvva 252,60,60
WL 8
Mvva 128,32,128
TR 56,11,32768
Mvva 128,36,132
buffer_load_dwordx4 a[0:3], v64, s[8:11], s24 offen offset:0 sc1
Mvva 132,32,136
TR 58,11,36864
Mvva 132,36,140
Mvva 136,32,160
TR 60,11,40960
Mvva 136,36,164
buffer_load_dwordx4 a[4:7], v64, s[8:11], s24 offen offset:1024 sc1
Mvva 140,32,168
TR 62,11,45056
Mvva 140,36,172
WL 8
Mvva 144,40,128
TR 32,12,32768
Mvva 144,44,132
buffer_load_dwordx4 a[8:11], v65, s[8:11], s24 offen offset:0 sc1
Mvva 148,40,136
TR 34,12,36864
Mvva 148,44,140
Mvva 152,40,160
TR 36,12,40960
Mvva 152,44,164
buffer_load_dwordx4 a[12:15], v65, s[8:11], s24 offen offset:1024 sc1
Mvva 156,40,168
TR 38,12,45056
Mvva 156,44,172
WL 8
Mvva 160,48,128
TR 40,13,32768
Mvva 160,52,132
Mvva 164,48,136
TR 42,13,36864
Mvva 164,52,140
buffer_load_dwordx4 a[16:19], v66, s[8:11], s24 offen offset:0 sc1
Mvva 168,48,160
TR 44,13,40960
Mvva 168,52,164
buffer_load_dwordx4 a[20:23], v66, s[8:11], s24 offen offset:1024 sc1
Mvva 172,48,168
TR 46,13,45056
Mvva 172,52,172
WL 8
Mvva 176,56,128
TR 48,14,32768
Mvva 176,60,132
Mvva 180,56,136
TR 50,14,36864
Mvva 180,60,140
buffer_load_dwordx4 a[24:27], v67, s[8:11], s24 offen offset:0 sc1
Mvva 184,56,160
TR 52,14,40960
Mvva 184,60,164
buffer_load_dwordx4 a[28:31], v67, s[8:11], s24 offen offset:1024 sc1
Mvva 188,56,168
TR 54,14,45056
Mvva 188,60,172
WL 8
Mvva 192,32,128
TR 56,15,32768
Mvva 192,36,132
Mvva 196,32,136
TR 58,15,36864
Mvva 196,36,140
s_add_u32 s24, s24, 14336
Mvva 200,32,160
TR 60,15,40960
Mvva 200,36,164
Mvva 204,32,168
TR 62,15,45056
Mvva 204,36,172
WL 8
s_waitcnt vmcnt(12)
s_barrier
Mvva 208,40,128
TR 32,8,49152
Mvva 208,44,132
s_add_u32 m0, s27, 16384
Mvva 212,40,136
TR 34,8,53248
Mvva 212,44,140
DM 24,12,25,0
Mvva 216,40,160
TR 36,8,57344
Mvva 216,44,164
Mvva 220,40,168
TR 38,8,61440
Mvva 220,44,172
WL 8
Mvva 224,48,128
TR 40,9,49152
Mvva 224,52,132
DM 25,12,25,1024
Mvva 228,48,136
TR 42,9,53248
Mvva 228,52,140
DM 26,12,25,2048
Mvva 232,48,160
TR 44,9,57344
Mvva 232,52,164
Mvva 236,48,168
TR 46,9,61440
Mvva 236,52,172
WL 8
Mvva 240,56,128
TR 48,10,49152
Mvva 240,60,132
DM 27,12,25,3072
Mvva 244,56,136
TR 50,10,53248
Mvva 244,60,140
Mvva 248,56,160
TR 52,10,57344
Mvva 248,60,164
s_add_u32 s25, s25, 917504
Mvva 252,56,168
TR 54,10,61440
Mvva 252,60,172
WL 8
Mvva 128,32,192
TR 56,11,49152
Mvva 128,36,196
buffer_load_dwordx4 a[32:35], v64, s[8:11], s24 offen offset:0 sc1
Mvva 132,32,200
TR 58,11,53248
Mvva 132,36,204
Mvva 136,32,224
TR 60,11,57344
Mvva 136,36,228
buffer_load_dwordx4 a[36:39], v64, s[8:11], s24 offen offset:1024 sc1
Mvva 140,32,232
TR 62,11,61440
Mvva 140,36,236
WL 8
Mvva 144,40,192
TR 32,12,49152
Mvva 144,44,196
buffer_load_dwordx4 a[40:43], v65, s[8:11], s24 offen offset:0 sc1
Mvva 148,40,200
TR 34,12,53248
Mvva 148,44,204
Mvva 152,40,224
TR 36,12,57344
Mvva 152,44,228
buffer_load_dwordx4 a[44:47], v65, s[8:11], s24 offen offset:1024 sc1
Mvva 156,40,232
TR 38,12,61440
Mvva 156,44,236
WL 8
Mvva 160,48,192
TR 40,13,49152
Mvva 160,52,196
Mvva 164,48,200
TR 42,13,53248
Mvva 164,52,204
buffer_load_dwordx4 a[48:51], v66, s[8:11], s24 offen offset:0 sc1
Mvva 168,48,224
TR 44,13,57344
Mvva 168,52,228
buffer_load_dwordx4 a[52:55], v66, s[8:11], s24 offen offset:1024 sc1
Mvva 172,48,232
TR 46,13,61440
Mvva 172,52,236
WL 8
Mvva 176,56,192
TR 48,14,49152
Mvva 176,60,196
Mvva 180,56,200
TR 50,14,53248
Mvva 180,60,204
buffer_load_dwordx4 a[56:59], v67, s[8:11], s24 offen offset:0 sc1
Mvva 184,56,224
TR 52,14,57344
Mvva 184,60,228
buffer_load_dwordx4 a[60:63], v67, s[8:11], s24 offen offset:1024 sc1
Mvva 188,56,232
TR 54,14,61440
Mvva 188,60,236
WL 8
Mvva 192,32,192
TR 56,15,49152
Mvva 192,36,196
Mvva 196,32,200
TR 58,15,53248
Mvva 196,36,204
s_add_u32 s24, s24, 14336
Mvva 200,32,224
TR 60,15,57344
Mvva 200,36,228
Mvva 204,32,232
TR 62,15,61440
Mvva 204,36,236
WL 8
s_waitcnt vmcnt(12)
s_barrier
Mvva 208,40,192
TR 32,8,0
Mvva 208,44,196
s_add_u32 m0, s27, 32768
Mvva 212,40,200
TR 34,8,4096
Mvva 212,44,204
DM 24,12,25,0
Mvva 216,40,224
TR 36,8,8192
Mvva 216,44,228
Mvva 220,40,232
TR 38,8,12288
Mvva 220,44,236
WL 8
Mvva 224,48,192
TR 40,9,0
Mvva 224,52,196
DM 25,12,25,1024
Mvva 228,48,200
TR 42,9,4096
Mvva 228,52,204
DM 26,12,25,2048
Mvva 232,48,224
TR 44,9,8192
Mvva 232,52,228
Mvva 236,48,232
TR 46,9,12288
Mvva 236,52,236
WL 8
Mvva 240,56,192
TR 48,10,0
Mvva 240,60,196
DM 27,12,25,3072
Mvva 244,56,200
TR 50,10,4096
Mvva 244,60,204
Mvva 248,56,224
TR 52,10,8192
Mvva 248,60,228
s_add_u32 s25, s25, 917504
Mvva 252,56,232
TR 54,10,12288
Mvva 252,60,236
WL 8
Mvva 128,32,0
TR 56,11,0
Mvva 128,36,4
buffer_load_dwordx4 a[128:131], v64, s[8:11], s24 offen offset:0 sc1
Mvva 132,32,8
TR 58,11,4096
Mvva 132,36,12
Mvva 136,32,16
TR 60,11,8192
Mvva 136,36,20
buffer_load_dwordx4 a[132:135], v64, s[8:11], s24 offen offset:1024 sc1
Mvva 140,32,24
TR 62,11,12288
Mvva 140,36,28
WL 8
Mvva 144,40,0
TR 32,12,0
Mvva 144,44,4
buffer_load_dwordx4 a[136:139], v65, s[8:11], s24 offen offset:0 sc1
Mvva 148,40,8
TR 34,12,4096
Mvva 148,44,12
Mvva 152,40,16
TR 36,12,8192
Mvva 152,44,20
buffer_load_dwordx4 a[140:143], v65, s[8:11], s24 offen offset:1024 sc1
Mvva 156,40,24
TR 38,12,12288
Mvva 156,44,28
WL 8
Mvva 160,48,0
TR 40,13,0
Mvva 160,52,4
Mvva 164,48,8
TR 42,13,4096
Mvva 164,52,12
buffer_load_dwordx4 a[160:163], v66, s[8:11], s24 offen offset:0 sc1
Mvva 168,48,16
TR 44,13,8192
Mvva 168,52,20
buffer_load_dwordx4 a[164:167], v66, s[8:11], s24 offen offset:1024 sc1
Mvva 172,48,24
TR 46,13,12288
Mvva 172,52,28
WL 8
Mvva 176,56,0
TR 48,14,0
Mvva 176,60,4
Mvva 180,56,8
TR 50,14,4096
Mvva 180,60,12
buffer_load_dwordx4 a[168:171], v67, s[8:11], s24 offen offset:0 sc1
Mvva 184,56,16
TR 52,14,8192
Mvva 184,60,20
buffer_load_dwordx4 a[172:175], v67, s[8:11], s24 offen offset:1024 sc1
Mvva 188,56,24
TR 54,14,12288
Mvva 188,60,28
WL 8
Mvva 192,32,0
TR 56,15,0
Mvva 192,36,4
Mvva 196,32,8
TR 58,15,4096
Mvva 196,36,12
s_add_u32 s24, s24, 14336
Mvva 200,32,16
TR 60,15,8192
Mvva 200,36,20
Mvva 204,32,24
TR 62,15,12288
Mvva 204,36,28
WL 8
s_waitcnt vmcnt(12)
s_barrier
Mvva 208,40,0
TR 32,8,16384
Mvva 208,44,4
s_add_u32 m0, s27, 49152
Mvva 212,40,8
TR 34,8,20480
Mvva 212,44,12
DM 24,12,25,0
Mvva 216,40,16
TR 36,8,24576
Mvva 216,44,20
Mvva 220,40,24
TR 38,8,28672
Mvva 220,44,28
WL 8
Mvva 224,48,0
TR 40,9,16384
Mvva 224,52,4
DM 25,12,25,1024
Mvva 228,48,8
TR 42,9,20480
Mvva 228,52,12
DM 26,12,25,2048
Mvva 232,48,16
TR 44,9,24576
Mvva 232,52,20
Mvva 236,48,24
TR 46,9,28672
Mvva 236,52,28
WL 8
Mvva 240,56,0
TR 48,10,16384
Mvva 240,60,4
DM 27,12,25,3072
Mvva 244,56,8
TR 50,10,20480
Mvva 244,60,12
Mvva 248,56,16
TR 52,10,24576
Mvva 248,60,20
s_sub_u32 s25, s25, 3538944
Mvva 252,56,24
TR 54,10,28672
Mvva 252,60,28
WL 8
Mvva 128,32,32
TR 56,11,16384
Mvva 128,36,36
buffer_load_dwordx4 a[192:195], v64, s[8:11], s24 offen offset:0 sc1
Mvva 132,32,40
TR 58,11,20480
Mvva 132,36,44
Mvva 136,32,48
TR 60,11,24576
Mvva 136,36,52
buffer_load_dwordx4 a[196:199], v64, s[8:11], s24 offen offset:1024 sc1
Mvva 140,32,56
TR 62,11,28672
Mvva 140,36,60
WL 8
Mvva 144,40,32
TR 32,12,16384
Mvva 144,44,36
buffer_load_dwordx4 a[200:203], v65, s[8:11], s24 offen offset:0 sc1
Mvva 148,40,40
TR 34,12,20480
Mvva 148,44,44
Mvva 152,40,48
TR 36,12,24576
Mvva 152,44,52
buffer_load_dwordx4 a[204:207], v65, s[8:11], s24 offen offset:1024 sc1
Mvva 156,40,56
TR 38,12,28672
Mvva 156,44,60
WL 8
Mvva 160,48,32
TR 40,13,16384
Mvva 160,52,36
Mvva 164,48,40
TR 42,13,20480
Mvva 164,52,44
buffer_load_dwordx4 a[224:227], v66, s[8:11], s24 offen offset:0 sc1
Mvva 168,48,48
TR 44,13,24576
Mvva 168,52,52
buffer_load_dwordx4 a[228:231], v66, s[8:11], s24 offen offset:1024 sc1
Mvva 172,48,56
TR 46,13,28672
Mvva 172,52,60
WL 8
Mvva 176,56,32
TR 48,14,16384
Mvva 176,60,36
Mvva 180,56,40
TR 50,14,20480
Mvva 180,60,44
buffer_load_dwordx4 a[232:235], v67, s[8:11], s24 offen offset:0 sc1
Mvva 184,56,48
TR 52,14,24576
Mvva 184,60,52
buffer_load_dwordx4 a[236:239], v67, s[8:11], s24 offen offset:1024 sc1
Mvva 188,56,56
TR 54,14,28672
Mvva 188,60,60
WL 8
Mvva 192,32,32
TR 56,15,16384
Mvva 192,36,36
Mvva 196,32,40
TR 58,15,20480
Mvva 196,36,44
s_sub_u32 s24, s24, 55296
Mvva 200,32,48
TR 60,15,24576
Mvva 200,36,52
Mvva 204,32,56
TR 62,15,28672
Mvva 204,36,60
WL 8
s_waitcnt vmcnt(12)
s_barrier
Mvva 208,40,32
TR 32,8,32768
Mvva 208,44,36
v_lshlrev_b32 v94, 7, v1
Mvva 212,40,40
TR 34,8,36864
Mvva 212,44,44
Mvva 216,40,48
TR 36,8,40960
Mvva 216,44,52
s_lshl_b32 s36, s3, 13
Mvva 220,40,56
TR 38,8,45056
Mvva 220,44,60
WL 8
Mvva 224,48,32
TR 40,9,32768
Mvva 224,52,36
Mvva 228,48,40
TR 42,9,36864
Mvva 228,52,44
Mvva 232,48,48
TR 44,9,40960
Mvva 232,52,52
v_add_u32 v94, s36, v94
Mvva 236,48,56
TR 46,9,45056
Mvva 236,52,60
WL 8
Mvva 240,56,32
TR 48,10,32768
Mvva 240,60,36
Mvva 244,56,40
TR 50,10,36864
Mvva 244,60,44
Mvva 248,56,48
TR 52,10,40960
Mvva 248,60,52
v_add_u32 v94, B4_fin-M1_pc, v94
Mvva 252,56,56
TR 54,10,45056
Mvva 252,60,60
WL 8
Mvva 128,32,128
TR 56,11,32768
Mvva 128,36,132
Mvva 132,32,136
TR 58,11,36864
Mvva 132,36,140
v_min_u32 v94, M1_last-M1_pc, v94
Mvva 136,32,160
TR 60,11,40960
Mvva 136,36,164
Mvva 140,32,168
TR 62,11,45056
Mvva 140,36,172
WL 8
Mvva 144,40,128
TR 32,12,32768
Mvva 144,44,132
Mvva 148,40,136
TR 34,12,36864
Mvva 148,44,140
v_add_co_u32 v94, vcc, s100, v94
Mvva 152,40,160
TR 36,12,40960
Mvva 152,44,164
Mvva 156,40,168
TR 38,12,45056
Mvva 156,44,172
WL 8
Mvva 160,48,128
TR 40,13,32768
Mvva 160,52,132
Mvva 164,48,136
TR 42,13,36864
Mvva 164,52,140
v_mov_b32 v95, s101
Mvva 168,48,160
TR 44,13,40960
Mvva 168,52,164
Mvva 172,48,168
TR 46,13,45056
Mvva 172,52,172
WL 8
Mvva 176,56,128
TR 48,14,32768
Mvva 176,60,132
v_addc_co_u32 v95, vcc, 0, v95, vcc
Mvva 180,56,136
TR 50,14,36864
Mvva 180,60,140
Mvva 184,56,160
TR 52,14,40960
Mvva 184,60,164
Mvva 188,56,168
TR 54,14,45056
Mvva 188,60,172
WL 8
Mvva 192,32,128
TR 56,15,32768
Mvva 192,36,132
global_load_dword v89, v[94:95], off
Mvva 196,32,136
TR 58,15,36864
Mvva 196,36,140
Mvva 200,32,160
TR 60,15,40960
Mvva 200,36,164
Mvva 204,32,168
TR 62,15,45056
Mvva 204,36,172
WL 8
s_waitcnt vmcnt(1)
s_barrier
Mvva 208,40,128
TR 32,8,49152
Mvva 208,44,132
Mvva 212,40,136
TR 34,8,53248
Mvva 212,44,140
Mvva 216,40,160
TR 36,8,57344
Mvva 216,44,164
Mvva 220,40,168
TR 38,8,61440
Mvva 220,44,172
WL 8
Mvva 224,48,128
TR 40,9,49152
Mvva 224,52,132
Mvva 228,48,136
TR 42,9,53248
Mvva 228,52,140
Mvva 232,48,160
TR 44,9,57344
Mvva 232,52,164
Mvva 236,48,168
TR 46,9,61440
Mvva 236,52,172
WL 8
Mvva 240,56,128
TR 48,10,49152
Mvva 240,60,132
Mvva 244,56,136
TR 50,10,53248
Mvva 244,60,140
Mvva 248,56,160
TR 52,10,57344
Mvva 248,60,164
Mvva 252,56,168
TR 54,10,61440
Mvva 252,60,172
WL 8
Mvva 128,32,192
TR 56,11,49152
Mvva 128,36,196
Mvva 132,32,200
TR 58,11,53248
Mvva 132,36,204
Mvva 136,32,224
TR 60,11,57344
Mvva 136,36,228
Mvva 140,32,232
TR 62,11,61440
Mvva 140,36,236
WL 8
Mvva 144,40,192
TR 32,12,49152
Mvva 144,44,196
Mvva 148,40,200
TR 34,12,53248
Mvva 148,44,204
Mvva 152,40,224
TR 36,12,57344
Mvva 152,44,228
Mvva 156,40,232
TR 38,12,61440
Mvva 156,44,236
WL 8
Mvva 160,48,192
TR 40,13,49152
Mvva 160,52,196
Mvva 164,48,200
TR 42,13,53248
Mvva 164,52,204
Mvva 168,48,224
TR 44,13,57344
Mvva 168,52,228
Mvva 172,48,232
TR 46,13,61440
Mvva 172,52,236
WL 8
Mvva 176,56,192
TR 48,14,49152
Mvva 176,60,196
Mvva 180,56,200
TR 50,14,53248
Mvva 180,60,204
Mvva 184,56,224
TR 52,14,57344
Mvva 184,60,228
Mvva 188,56,232
TR 54,14,61440
Mvva 188,60,236
WL 8
Mvva 192,32,192
TR 56,15,49152
Mvva 192,36,196
Mvva 196,32,200
TR 58,15,53248
Mvva 196,36,204
Mvva 200,32,224
TR 60,15,57344
Mvva 200,36,228
Mvva 204,32,232
TR 62,15,61440
Mvva 204,36,236
WL 8
Mvva 208,40,192
Mvva 208,44,196
Mvva 212,40,200
Mvva 212,44,204
Mvva 216,40,224
Mvva 216,44,228
Mvva 220,40,232
Mvva 220,44,236
WL 4
Mvva 224,48,192
Mvva 224,52,196
Mvva 228,48,200
Mvva 228,52,204
Mvva 232,48,224
Mvva 232,52,228
Mvva 236,48,232
Mvva 236,52,236
WL 0
Mvva 240,56,192
Mvva 240,60,196
Mvva 244,56,200
Mvva 244,60,204
Mvva 248,56,224
Mvva 248,60,228
Mvva 252,56,232
Mvva 252,60,236
s_mov_b32 s16, s96
s_mov_b32 s17, s97
s_mov_b32 s18, 4194304
s_mov_b32 s19, 0x20000
B4_fin:
s_lshl_b32 s37, s40, 16
s_add_u32 s37, s37, s78
s_add_u32 s36, s40, 1
s_and_b32 s36, s36, 3
s_lshl_b32 s36, s36, 14
s_add_u32 s49, s37, s36
s_add_u32 s36, s40, 2
s_and_b32 s36, s36, 3
s_lshl_b32 s36, s36, 14
s_add_u32 s50, s37, s36
s_add_u32 s36, s40, 3
s_and_b32 s36, s36, 3
s_lshl_b32 s36, s36, 14
s_add_u32 s51, s37, s36
s_add_u32 s48, s47, 128
v_mov_b32 v2, 0
CV 24,132,133
CV 25,134,135
CV 26,148,149
CV 27,150,151
buffer_store_dwordx4 v[24:27], v88, s[88:91], s49 offen offset:0 sc1
CV 28,164,165
CV 29,166,167
CV 30,180,181
CV 31,182,183
buffer_store_dwordx4 v[28:31], v88, s[88:91], s49 offen offset:1024 sc1
CV 32,196,197
CV 33,198,199
CV 34,212,213
CV 35,214,215
buffer_store_dwordx4 v[32:35], v88, s[88:91], s49 offen offset:2048 sc1
CV 36,228,229
CV 37,230,231
CV 38,244,245
CV 39,246,247
buffer_store_dwordx4 v[36:39], v88, s[88:91], s49 offen offset:3072 sc1
CV 24,136,137
CV 25,138,139
CV 26,152,153
CV 27,154,155
buffer_store_dwordx4 v[24:27], v88, s[88:91], s50 offen offset:0 sc1
CV 28,168,169
CV 29,170,171
CV 30,184,185
CV 31,186,187
buffer_store_dwordx4 v[28:31], v88, s[88:91], s50 offen offset:1024 sc1
CV 32,200,201
CV 33,202,203
CV 34,216,217
CV 35,218,219
buffer_store_dwordx4 v[32:35], v88, s[88:91], s50 offen offset:2048 sc1
CV 36,232,233
CV 37,234,235
CV 38,248,249
CV 39,250,251
buffer_store_dwordx4 v[36:39], v88, s[88:91], s50 offen offset:3072 sc1
CV 24,140,141
CV 25,142,143
CV 26,156,157
CV 27,158,159
buffer_store_dwordx4 v[24:27], v88, s[88:91], s51 offen offset:0 sc1
CV 28,172,173
CV 29,174,175
CV 30,188,189
CV 31,190,191
buffer_store_dwordx4 v[28:31], v88, s[88:91], s51 offen offset:1024 sc1
CV 32,204,205
CV 33,206,207
CV 34,220,221
CV 35,222,223
buffer_store_dwordx4 v[32:35], v88, s[88:91], s51 offen offset:2048 sc1
CV 36,236,237
CV 37,238,239
CV 38,252,253
CV 39,254,255
buffer_store_dwordx4 v[36:39], v88, s[88:91], s51 offen offset:3072 sc1
s_lshl_b32 s37, s40, 14
s_add_u32 s37, s37, s78
s_xor_b32 s36, s40, 1
s_lshl_b32 s36, s36, 16
s_add_u32 s36, s36, s37
s_mov_b32 s52, s36
s_add_u32 s56, s37, 0
s_add_u32 s57, s37, 65536
v_and_b32 v2, 15, v1
v_lshrrev_b32 v3, 5, v1
v_bfe_u32 v4, v1, 4, 1
v_lshlrev_b32 v4, 3, v4
v_lshl_add_u32 v4, v2, 8, v4
v_add_u32 v4, s46, v4
v_add_u32 v5, 0, v3
v_xor_b32 v5, v5, v2
v_lshl_add_u32 v8, v5, 4, v4
ds_read_b64 v[104:105], v8
v_add_u32 v5, 2, v3
v_xor_b32 v5, v5, v2
v_lshl_add_u32 v9, v5, 4, v4
ds_read_b64 v[106:107], v9
v_add_u32 v5, 4, v3
v_xor_b32 v5, v5, v2
v_lshl_add_u32 v10, v5, 4, v4
ds_read_b64 v[108:109], v10
v_add_u32 v5, 6, v3
v_xor_b32 v5, v5, v2
v_lshl_add_u32 v11, v5, 4, v4
ds_read_b64 v[110:111], v11
v_add_u32 v5, 8, v3
v_xor_b32 v5, v5, v2
v_lshl_add_u32 v12, v5, 4, v4
ds_read_b64 v[112:113], v12
v_add_u32 v5, 10, v3
v_xor_b32 v5, v5, v2
v_lshl_add_u32 v13, v5, 4, v4
ds_read_b64 v[114:115], v13
v_add_u32 v5, 12, v3
v_xor_b32 v5, v5, v2
v_lshl_add_u32 v14, v5, 4, v4
ds_read_b64 v[116:117], v14
v_add_u32 v5, 14, v3
v_xor_b32 v5, v5, v2
v_lshl_add_u32 v15, v5, 4, v4
ds_read_b64 v[118:119], v15
v_lshlrev_b32 v136, 16, v72
v_and_b32 v137, 0xffff0000, v72
v_lshlrev_b32 v138, 16, v73
v_and_b32 v139, 0xffff0000, v73
v_lshlrev_b32 v152, 16, v74
v_and_b32 v153, 0xffff0000, v74
v_lshlrev_b32 v154, 16, v75
v_and_b32 v155, 0xffff0000, v75
v_lshlrev_b32 v168, 16, v76
v_and_b32 v169, 0xffff0000, v76
v_lshlrev_b32 v170, 16, v77
v_and_b32 v171, 0xffff0000, v77
v_lshlrev_b32 v184, 16, v78
v_and_b32 v185, 0xffff0000, v78
v_lshlrev_b32 v186, 16, v79
v_and_b32 v187, 0xffff0000, v79
v_lshlrev_b32 v200, 16, v80
v_and_b32 v201, 0xffff0000, v80
v_lshlrev_b32 v202, 16, v81
v_and_b32 v203, 0xffff0000, v81
v_lshlrev_b32 v216, 16, v82
v_and_b32 v217, 0xffff0000, v82
v_lshlrev_b32 v218, 16, v83
v_and_b32 v219, 0xffff0000, v83
v_lshlrev_b32 v232, 16, v84
v_and_b32 v233, 0xffff0000, v84
v_lshlrev_b32 v234, 16, v85
v_and_b32 v235, 0xffff0000, v85
v_lshlrev_b32 v248, 16, v86
v_and_b32 v249, 0xffff0000, v86
v_lshlrev_b32 v250, 16, v87
v_and_b32 v251, 0xffff0000, v87
WL 0
v_lshlrev_b32 v132, 16, v104
v_and_b32 v133, 0xffff0000, v104
v_lshlrev_b32 v134, 16, v105
v_and_b32 v135, 0xffff0000, v105
v_lshlrev_b32 v148, 16, v106
v_and_b32 v149, 0xffff0000, v106
v_lshlrev_b32 v150, 16, v107
v_and_b32 v151, 0xffff0000, v107
v_lshlrev_b32 v164, 16, v108
v_and_b32 v165, 0xffff0000, v108
v_lshlrev_b32 v166, 16, v109
v_and_b32 v167, 0xffff0000, v109
v_lshlrev_b32 v180, 16, v110
v_and_b32 v181, 0xffff0000, v110
v_lshlrev_b32 v182, 16, v111
v_and_b32 v183, 0xffff0000, v111
v_lshlrev_b32 v196, 16, v112
v_and_b32 v197, 0xffff0000, v112
v_lshlrev_b32 v198, 16, v113
v_and_b32 v199, 0xffff0000, v113
v_lshlrev_b32 v212, 16, v114
v_and_b32 v213, 0xffff0000, v114
v_lshlrev_b32 v214, 16, v115
v_and_b32 v215, 0xffff0000, v115
v_lshlrev_b32 v228, 16, v116
v_and_b32 v229, 0xffff0000, v116
v_lshlrev_b32 v230, 16, v117
v_and_b32 v231, 0xffff0000, v117
v_lshlrev_b32 v244, 16, v118
v_and_b32 v245, 0xffff0000, v118
v_lshlrev_b32 v246, 16, v119
v_and_b32 v247, 0xffff0000, v119
PA 136,136,128
PA 138,138,130
PA 152,152,144
PA 154,154,146
PA 168,168,160
PA 170,170,162
PA 184,184,176
PA 186,186,178
PA 200,200,192
PA 202,202,194
PA 216,216,208
PA 218,218,210
PA 232,232,224
PA 234,234,226
PA 248,248,240
PA 250,250,242
v_mov_b32 v2, 0
v_add_u32 v16, s46, v88
v_mov_b32 v4, 0xbfb8aa3b
v_mov_b32 v5, 0xbfb8aa3b
v_mov_b32 v6, 0x3f800000
v_mov_b32 v7, 0x3f800000
v_and_b32 v2, 1, v1
v_lshlrev_b32 v2, 7, v2
s_waitcnt vmcnt(0)
s_barrier
s_cmp_lg_u32 s3, 0
s_cbranch_scc1 B4_fsig
s_mov_b64 exec, 1
v_mov_b32 v3, 1
buffer_atomic_add v3, off, s[84:87], s47 sc1
s_mov_b64 exec, -1
B4_fsig:
B4_p1:
s_sleep 4
buffer_load_dword v89, v2, s[84:87], s47 offen sc1
s_waitcnt vmcnt(0)
v_cmp_eq_u32 vcc, 2, v89
s_nop 1
s_bitcmp1_b32 vcc_lo, 0
s_cbranch_scc0 B4_p1
B4_g1:
s_and_b32 s59, vcc_lo, 2
s_cmp_eq_u32 s59, 0
s_cbranch_scc1 B4_n2
buffer_load_dwordx4 v[24:27], v88, s[88:91], s56 offen offset:0 sc1
buffer_load_dwordx4 v[72:75], v88, s[88:91], s57 offen offset:0 sc1
buffer_load_dwordx4 v[28:31], v88, s[88:91], s56 offen offset:1024 sc1
buffer_load_dwordx4 v[76:79], v88, s[88:91], s57 offen offset:1024 sc1
buffer_load_dwordx4 v[32:35], v88, s[88:91], s56 offen offset:2048 sc1
buffer_load_dwordx4 v[80:83], v88, s[88:91], s57 offen offset:2048 sc1
buffer_load_dwordx4 v[36:39], v88, s[88:91], s56 offen offset:3072 sc1
buffer_load_dwordx4 v[84:87], v88, s[88:91], s57 offen offset:3072 sc1
B4_n2:
buffer_load_dwordx4 v[40:43], v88, s[88:91], s52 offen offset:0 sc1
buffer_load_dwordx4 v[48:51], v88, s[88:91], s52 offen offset:1024 sc1
buffer_load_dwordx4 v[56:59], v88, s[88:91], s52 offen offset:2048 sc1
buffer_load_dwordx4 v[64:67], v88, s[88:91], s52 offen offset:3072 sc1
s_waitcnt vmcnt(3)
v_lshlrev_b32 v96, 16, v40
v_and_b32 v97, 0xffff0000, v40
v_lshlrev_b32 v98, 16, v41
v_and_b32 v99, 0xffff0000, v41
v_lshlrev_b32 v100, 16, v42
v_and_b32 v101, 0xffff0000, v42
v_lshlrev_b32 v102, 16, v43
v_and_b32 v103, 0xffff0000, v43
PA 136,136,96
PA 138,138,98
PA 152,152,100
PA 154,154,102
PM 96,136,4
PM 98,138,4
PM 100,152,4
PM 102,154,4
EX 96
EX 97
EX 98
EX 99
EX 100
EX 101
EX 102
EX 103
PA 96,96,6
PA 98,98,6
PA 100,100,6
PA 102,102,6
RC 96
RC 97
RC 98
RC 99
RC 100
RC 101
RC 102
RC 103
PM 136,136,96
PM 138,138,98
PM 152,152,100
PM 154,154,102
s_waitcnt vmcnt(2)
v_lshlrev_b32 v96, 16, v48
v_and_b32 v97, 0xffff0000, v48
v_lshlrev_b32 v98, 16, v49
v_and_b32 v99, 0xffff0000, v49
v_lshlrev_b32 v100, 16, v50
v_and_b32 v101, 0xffff0000, v50
v_lshlrev_b32 v102, 16, v51
v_and_b32 v103, 0xffff0000, v51
PA 168,168,96
PA 170,170,98
PA 184,184,100
PA 186,186,102
PM 96,168,4
PM 98,170,4
PM 100,184,4
PM 102,186,4
EX 96
EX 97
EX 98
EX 99
EX 100
EX 101
EX 102
EX 103
PA 96,96,6
PA 98,98,6
PA 100,100,6
PA 102,102,6
RC 96
RC 97
RC 98
RC 99
RC 100
RC 101
RC 102
RC 103
PM 168,168,96
PM 170,170,98
PM 184,184,100
PM 186,186,102
s_waitcnt vmcnt(1)
v_lshlrev_b32 v96, 16, v56
v_and_b32 v97, 0xffff0000, v56
v_lshlrev_b32 v98, 16, v57
v_and_b32 v99, 0xffff0000, v57
v_lshlrev_b32 v100, 16, v58
v_and_b32 v101, 0xffff0000, v58
v_lshlrev_b32 v102, 16, v59
v_and_b32 v103, 0xffff0000, v59
PA 200,200,96
PA 202,202,98
PA 216,216,100
PA 218,218,102
PM 96,200,4
PM 98,202,4
PM 100,216,4
PM 102,218,4
EX 96
EX 97
EX 98
EX 99
EX 100
EX 101
EX 102
EX 103
PA 96,96,6
PA 98,98,6
PA 100,100,6
PA 102,102,6
RC 96
RC 97
RC 98
RC 99
RC 100
RC 101
RC 102
RC 103
PM 200,200,96
PM 202,202,98
PM 216,216,100
PM 218,218,102
s_waitcnt vmcnt(0)
v_lshlrev_b32 v96, 16, v64
v_and_b32 v97, 0xffff0000, v64
v_lshlrev_b32 v98, 16, v65
v_and_b32 v99, 0xffff0000, v65
v_lshlrev_b32 v100, 16, v66
v_and_b32 v101, 0xffff0000, v66
v_lshlrev_b32 v102, 16, v67
v_and_b32 v103, 0xffff0000, v67
PA 232,232,96
PA 234,234,98
PA 248,248,100
PA 250,250,102
PM 96,232,4
PM 98,234,4
PM 100,248,4
PM 102,250,4
EX 96
EX 97
EX 98
EX 99
EX 100
EX 101
EX 102
EX 103
PA 96,96,6
PA 98,98,6
PA 100,100,6
PA 102,102,6
RC 96
RC 97
RC 98
RC 99
RC 100
RC 101
RC 102
RC 103
PM 232,232,96
PM 234,234,98
PM 248,248,100
PM 250,250,102
s_cmp_lg_u32 s59, 0
s_cbranch_scc1 B4_h2
B4_p2:
buffer_load_dword v89, off, s[84:87], s48 sc1
s_waitcnt vmcnt(0)
v_cmp_eq_u32 vcc, 2, v89
s_nop 1
s_cbranch_vccnz B4_g2
s_sleep 4
s_branch B4_p2
B4_g2:
buffer_load_dwordx4 v[24:27], v88, s[88:91], s56 offen offset:0 sc1
buffer_load_dwordx4 v[72:75], v88, s[88:91], s57 offen offset:0 sc1
buffer_load_dwordx4 v[28:31], v88, s[88:91], s56 offen offset:1024 sc1
buffer_load_dwordx4 v[76:79], v88, s[88:91], s57 offen offset:1024 sc1
buffer_load_dwordx4 v[32:35], v88, s[88:91], s56 offen offset:2048 sc1
buffer_load_dwordx4 v[80:83], v88, s[88:91], s57 offen offset:2048 sc1
buffer_load_dwordx4 v[36:39], v88, s[88:91], s56 offen offset:3072 sc1
buffer_load_dwordx4 v[84:87], v88, s[88:91], s57 offen offset:3072 sc1
B4_h2:
s_waitcnt vmcnt(6)
v_lshlrev_b32 v128, 16, v24
v_and_b32 v129, 0xffff0000, v24
v_lshlrev_b32 v130, 16, v25
v_and_b32 v131, 0xffff0000, v25
v_lshlrev_b32 v144, 16, v26
v_and_b32 v145, 0xffff0000, v26
v_lshlrev_b32 v146, 16, v27
v_and_b32 v147, 0xffff0000, v27
v_lshlrev_b32 v96, 16, v72
v_and_b32 v97, 0xffff0000, v72
v_lshlrev_b32 v98, 16, v73
v_and_b32 v99, 0xffff0000, v73
v_lshlrev_b32 v100, 16, v74
v_and_b32 v101, 0xffff0000, v74
v_lshlrev_b32 v102, 16, v75
v_and_b32 v103, 0xffff0000, v75
PA 128,128,96
PA 130,130,98
PA 144,144,100
PA 146,146,102
PF 128,128,136,132
PF 130,130,138,134
PF 144,144,152,148
PF 146,146,154,150
CV 120,128,129
CV 121,130,131
CV 122,144,145
CV 123,146,147
ds_write_b64 v8, v[120:121]
ds_write_b64 v9, v[122:123]
s_waitcnt vmcnt(4)
v_lshlrev_b32 v160, 16, v28
v_and_b32 v161, 0xffff0000, v28
v_lshlrev_b32 v162, 16, v29
v_and_b32 v163, 0xffff0000, v29
v_lshlrev_b32 v176, 16, v30
v_and_b32 v177, 0xffff0000, v30
v_lshlrev_b32 v178, 16, v31
v_and_b32 v179, 0xffff0000, v31
v_lshlrev_b32 v96, 16, v76
v_and_b32 v97, 0xffff0000, v76
v_lshlrev_b32 v98, 16, v77
v_and_b32 v99, 0xffff0000, v77
v_lshlrev_b32 v100, 16, v78
v_and_b32 v101, 0xffff0000, v78
v_lshlrev_b32 v102, 16, v79
v_and_b32 v103, 0xffff0000, v79
PA 160,160,96
PA 162,162,98
PA 176,176,100
PA 178,178,102
PF 160,160,168,164
PF 162,162,170,166
PF 176,176,184,180
PF 178,178,186,182
CV 120,160,161
CV 121,162,163
CV 122,176,177
CV 123,178,179
ds_write_b64 v10, v[120:121]
ds_write_b64 v11, v[122:123]
s_waitcnt vmcnt(2)
v_lshlrev_b32 v192, 16, v32
v_and_b32 v193, 0xffff0000, v32
v_lshlrev_b32 v194, 16, v33
v_and_b32 v195, 0xffff0000, v33
v_lshlrev_b32 v208, 16, v34
v_and_b32 v209, 0xffff0000, v34
v_lshlrev_b32 v210, 16, v35
v_and_b32 v211, 0xffff0000, v35
v_lshlrev_b32 v96, 16, v80
v_and_b32 v97, 0xffff0000, v80
v_lshlrev_b32 v98, 16, v81
v_and_b32 v99, 0xffff0000, v81
v_lshlrev_b32 v100, 16, v82
v_and_b32 v101, 0xffff0000, v82
v_lshlrev_b32 v102, 16, v83
v_and_b32 v103, 0xffff0000, v83
PA 192,192,96
PA 194,194,98
PA 208,208,100
PA 210,210,102
PF 192,192,200,196
PF 194,194,202,198
PF 208,208,216,212
PF 210,210,218,214
CV 120,192,193
CV 121,194,195
CV 122,208,209
CV 123,210,211
ds_write_b64 v12, v[120:121]
ds_write_b64 v13, v[122:123]
s_waitcnt vmcnt(0)
v_lshlrev_b32 v224, 16, v36
v_and_b32 v225, 0xffff0000, v36
v_lshlrev_b32 v226, 16, v37
v_and_b32 v227, 0xffff0000, v37
v_lshlrev_b32 v240, 16, v38
v_and_b32 v241, 0xffff0000, v38
v_lshlrev_b32 v242, 16, v39
v_and_b32 v243, 0xffff0000, v39
v_lshlrev_b32 v96, 16, v84
v_and_b32 v97, 0xffff0000, v84
v_lshlrev_b32 v98, 16, v85
v_and_b32 v99, 0xffff0000, v85
v_lshlrev_b32 v100, 16, v86
v_and_b32 v101, 0xffff0000, v86
v_lshlrev_b32 v102, 16, v87
v_and_b32 v103, 0xffff0000, v87
PA 224,224,96
PA 226,226,98
PA 240,240,100
PA 242,242,102
PF 224,224,232,228
PF 226,226,234,230
PF 240,240,248,244
PF 242,242,250,246
CV 120,224,225
CV 121,226,227
CV 122,240,241
CV 123,242,243
ds_write_b64 v14, v[120:121]
ds_write_b64 v15, v[122:123]
WL 0
RQ 40,16,0
RQ 44,16,1024
RQ 48,16,2048
RQ 52,16,3072
WL 3
buffer_store_dwordx4 v[40:43], v90, s[16:19], s42 offen offset:0 sc1
WL 2
buffer_store_dwordx4 v[44:47], v91, s[16:19], s42 offen offset:1024 sc1
WL 1
buffer_store_dwordx4 v[48:51], v92, s[16:19], s42 offen offset:2048 sc1
WL 0
buffer_store_dwordx4 v[52:55], v93, s[16:19], s42 offen offset:3072 sc1
s_endpgm
B4_f0_w:
s_sleep 8
buffer_load_dword v5, off, s[84:87], s50 sc1
s_waitcnt vmcnt(0)
v_cmp_ne_u32 vcc, 8, v5
s_nop 1
s_cbranch_vccnz B4_f0_w
s_branch B4_f0_k
B4_f1_w:
s_sleep 8
buffer_load_dword v89, off, s[84:87], s51 sc1
s_waitcnt vmcnt(0)
v_cmp_ne_u32 vcc, 8, v89
s_nop 1
s_cbranch_vccnz B4_f1_w
s_branch B4_f1_k
M1_b:
s_load_dwordx2 s[6:7], s[0:1], 48
s_load_dwordx2 s[48:49], s[0:1], 56
s_load_dwordx2 s[52:53], s[0:1], 64
s_load_dwordx2 s[92:93], s[0:1], 32
s_load_dwordx2 s[94:95], s[0:1], 80
v_lshrrev_b32 v146, 3, v1
s_lshl_b32 s36, s2, 3
v_add_u32 v147, s36, v146
v_lshlrev_b32 v148, 11, v147
v_and_b32 v150, 7, v1
v_lshl_add_u32 v149, v150, 4, v148
s_lshl_b32 s36, s3, 9
s_lshl_b32 s37, s3, 4
s_add_u32 s37, s37, s2
WL 0
s_mov_b32 s84, s80
s_mov_b32 s85, s81
s_mov_b32 s86, 4194304
s_mov_b32 s87, 0x20000
s_add_u32 s44, s4, 21495808
s_addc_u32 s45, s5, 0
s_mov_b32 s46, 32768
s_mov_b32 s47, 0x20000
s_mov_b32 s88, s82
s_mov_b32 s89, s83
s_mov_b32 s90, 256
s_mov_b32 s91, 0x20000
s_cmp_lt_u32 s37, 16
s_cbranch_scc1 B1_l_z
LV 128,149,84,36,0
LV 132,149,84,36,128
LV 136,149,84,36,256
LV 140,149,84,36,384
buffer_load_ushort v144, v148, s[84:87], 0 offen
s_branch B1_l_zd
B1_l_z:
v_mov_b32 v152, 0
v_mov_b32 v153, 0
v_mov_b32 v154, 0
v_mov_b32 v155, 0
v_lshlrev_b32 v156, 4, v1
s_lshl_b32 s37, s2, 11
v_and_b32 v157, 1, v1
v_lshlrev_b32 v157, 7, v157
buffer_store_dwordx4 v[152:155], v156, s[44:47], s37 offen sc1
buffer_store_dwordx4 v[152:155], v156, s[44:47], s37 offen offset:1024 sc1
LV 128,149,84,36,0
LV 132,149,84,36,128
LV 136,149,84,36,256
LV 140,149,84,36,384
buffer_load_ushort v144, v148, s[84:87], 0 offen
buffer_load_dword v159, v157, s[88:91], 0 offen sc1
v_lshlrev_b32 v156, 6, v1
v_mov_b32 v157, 1
s_waitcnt vmcnt(6)
s_mov_b64 exec, 15
buffer_store_byte v157, v156, s[88:91], s2 offen sc1
s_mov_b64 exec, -1
B1_l_zd:
s_and_b32 s36, s35, 7
s_lshr_b32 s37, s35, 3
s_lshr_b32 s33, s36, 1
s_lshl_b32 s33, s33, 2
s_lshr_b32 s38, s37, 2
s_add_u32 s33, s33, s38
s_and_b32 s34, s36, 1
s_lshl_b32 s34, s34, 2
s_and_b32 s38, s37, 3
s_add_u32 s34, s34, s38
s_lshl_b32 s39, s33, 3
s_lshl_b32 s36, s3, 1
s_add_u32 s39, s39, s36
s_lshl_b32 s27, s3, 12
s_and_b32 s50, s35, 6
s_lshr_b32 s36, s35, 6
s_add_u32 s50, s50, s36
s_and_b32 s51, s35, 1
s_lshl_b32 s51, s51, 3
s_lshr_b32 s36, s35, 3
s_and_b32 s36, s36, 7
s_add_u32 s51, s51, s36
s_mov_b32 s8, s4
s_mov_b32 s9, s5
s_mov_b32 s10, 4194304
s_mov_b32 s11, 0x20000
s_mov_b32 s12, s6
s_mov_b32 s13, s7
s_mov_b32 s14, 2097152
s_mov_b32 s15, 0x20000
s_add_u32 s16, s4, 8388608
s_addc_u32 s17, s5, 0
s_mov_b32 s18, 4194304
s_mov_b32 s19, 0x20000
v_lshrrev_b32 v2, 4, v1
s_lshl_b32 s36, s3, 4
v_add_u32 v3, s36, v2
v_mul_u32_u24 v3, 2048, v3
v_and_b32 v4, 15, v1
v_add_u32 v5, 0, v2
v_lshlrev_b32 v5, 1, v5
v_xor_b32 v5, v5, v4
v_lshl_add_u32 v5, v5, 4, v3
v_add_u32 v80, 0, v5
v_add_u32 v5, 4, v2
v_lshlrev_b32 v5, 1, v5
v_xor_b32 v5, v5, v4
v_lshl_add_u32 v5, v5, 4, v3
v_add_u32 v81, 7168, v5
v_add_u32 v5, 0, v2
v_lshlrev_b32 v5, 1, v5
v_xor_b32 v5, v5, v4
v_lshl_add_u32 v5, v5, 4, v3
v_add_u32 v82, 14336, v5
v_add_u32 v5, 4, v2
v_lshlrev_b32 v5, 1, v5
v_xor_b32 v5, v5, v4
v_lshl_add_u32 v5, v5, 4, v3
v_add_u32 v83, 21504, v5
s_lshl_b32 s25, s34, 8
s_lshl_b32 s36, s3, 6
v_add_u32 v60, s36, v1
v_lshrrev_b32 v60, 1, v60
v_lshlrev_b32 v60, 7, v60
s_lshl_b32 s63, s35, 14
s_add_u32 m0, s27, 0
s_nop 0
DM 80,12,25,0
DM 81,12,25,1024
DM 82,12,25,2048
DM 83,12,25,3072
s_add_u32 s25, s25, 131072
s_add_u32 m0, s27, 16384
s_nop 0
DM 80,12,25,0
DM 81,12,25,1024
DM 82,12,25,2048
DM 83,12,25,3072
s_add_u32 s25, s25, 131072
buffer_load_dword v61, v60, s[12:15], s63 offen
s_mov_b32 s84, s4
s_mov_b32 s85, s5
s_mov_b32 s86, 4194304
s_mov_b32 s87, 0x20000
s_add_u32 s96, s4, 21364736
s_addc_u32 s97, s5, 0
s_mov_b32 s98, 65536
s_mov_b32 s99, 0x20000
s_lshl_b32 s36, s3, 12
s_add_u32 s36, s36, 0x21000
v_lshrrev_b32 v156, 2, v150
v_lshlrev_b32 v156, 9, v156
v_and_b32 v157, 1, v150
v_lshl_add_u32 v156, v157, 8, v156
v_bfe_u32 v157, v150, 1, 1
v_lshl_add_u32 v156, v157, 3, v156
v_lshl_add_u32 v156, v146, 4, v156
v_add_u32 v156, s36, v156
v_lshlrev_b32 v157, 4, v1
v_add_u32 v157, s36, v157
v_bfe_u32 v151, v1, 3, 2
v_lshlrev_b32 v151, 4, v151
v_and_b32 v196, 7, v1
s_and_b32 s36, s2, 1
s_lshl_b32 s36, s36, 3
v_add3_u32 v151, v151, s36, v196
v_lshlrev_b32 v151, 4, v151
v_lshrrev_b32 v196, 5, v1
v_lshl_add_u32 v151, v196, 10, v151
s_lshr_b32 s37, s2, 1
s_lshl_b32 s37, s37, 15
s_lshl_b32 s36, s3, 13
s_add_u32 s37, s37, s36
s_add_u32 s38, s37, 4096
v_lshlrev_b32 v147, 2, v1
v_mov_b32 v152, 0
v_mov_b32 v153, 0
v_mov_b32 v154, 0
v_mov_b32 v155, 0
s_and_b32 s36, s2, 3
s_lshl_b32 s36, s36, 6
v_mov_b32 v158, s36
s_waitcnt vmcnt(9)
v_lshlrev_b32 v144, 16, v144
v_mov_b32 v145, v144
v_lshlrev_b32 v160, 16, v128
v_and_b32 v161, 0xffff0000, v128
v_lshlrev_b32 v162, 16, v129
v_and_b32 v163, 0xffff0000, v129
v_lshlrev_b32 v164, 16, v130
v_and_b32 v165, 0xffff0000, v130
v_lshlrev_b32 v166, 16, v131
v_and_b32 v167, 0xffff0000, v131
v_lshlrev_b32 v168, 16, v132
v_and_b32 v169, 0xffff0000, v132
v_lshlrev_b32 v170, 16, v133
v_and_b32 v171, 0xffff0000, v133
v_lshlrev_b32 v172, 16, v134
v_and_b32 v173, 0xffff0000, v134
v_lshlrev_b32 v174, 16, v135
v_and_b32 v175, 0xffff0000, v135
v_lshlrev_b32 v176, 16, v136
v_and_b32 v177, 0xffff0000, v136
v_lshlrev_b32 v178, 16, v137
v_and_b32 v179, 0xffff0000, v137
v_lshlrev_b32 v180, 16, v138
v_and_b32 v181, 0xffff0000, v138
v_lshlrev_b32 v182, 16, v139
v_and_b32 v183, 0xffff0000, v139
v_lshlrev_b32 v184, 16, v140
v_and_b32 v185, 0xffff0000, v140
v_lshlrev_b32 v186, 16, v141
v_and_b32 v187, 0xffff0000, v141
v_lshlrev_b32 v188, 16, v142
v_and_b32 v189, 0xffff0000, v142
v_lshlrev_b32 v190, 16, v143
v_and_b32 v191, 0xffff0000, v143
v_pk_add_f32 v[160:161], v[160:161], v[144:145] neg_lo:[0,1] neg_hi:[0,1]
v_pk_add_f32 v[162:163], v[162:163], v[144:145] neg_lo:[0,1] neg_hi:[0,1]
v_pk_add_f32 v[164:165], v[164:165], v[144:145] neg_lo:[0,1] neg_hi:[0,1]
v_pk_add_f32 v[166:167], v[166:167], v[144:145] neg_lo:[0,1] neg_hi:[0,1]
v_pk_add_f32 v[168:169], v[168:169], v[144:145] neg_lo:[0,1] neg_hi:[0,1]
v_pk_add_f32 v[170:171], v[170:171], v[144:145] neg_lo:[0,1] neg_hi:[0,1]
v_pk_add_f32 v[172:173], v[172:173], v[144:145] neg_lo:[0,1] neg_hi:[0,1]
v_pk_add_f32 v[174:175], v[174:175], v[144:145] neg_lo:[0,1] neg_hi:[0,1]
v_pk_add_f32 v[176:177], v[176:177], v[144:145] neg_lo:[0,1] neg_hi:[0,1]
v_pk_add_f32 v[178:179], v[178:179], v[144:145] neg_lo:[0,1] neg_hi:[0,1]
v_pk_add_f32 v[180:181], v[180:181], v[144:145] neg_lo:[0,1] neg_hi:[0,1]
v_pk_add_f32 v[182:183], v[182:183], v[144:145] neg_lo:[0,1] neg_hi:[0,1]
v_pk_add_f32 v[184:185], v[184:185], v[144:145] neg_lo:[0,1] neg_hi:[0,1]
v_pk_add_f32 v[186:187], v[186:187], v[144:145] neg_lo:[0,1] neg_hi:[0,1]
v_pk_add_f32 v[188:189], v[188:189], v[144:145] neg_lo:[0,1] neg_hi:[0,1]
v_pk_add_f32 v[190:191], v[190:191], v[144:145] neg_lo:[0,1] neg_hi:[0,1]
PA 152,152,160
PF 154,160,160,154
PA 152,152,162
PF 154,162,162,154
PA 152,152,164
PF 154,164,164,154
PA 152,152,166
PF 154,166,166,154
PA 152,152,168
PF 154,168,168,154
PA 152,152,170
PF 154,170,170,154
PA 152,152,172
PF 154,172,172,154
PA 152,152,174
PF 154,174,174,154
PA 152,152,176
PF 154,176,176,154
PA 152,152,178
PF 154,178,178,154
PA 152,152,180
PF 154,180,180,154
PA 152,152,182
PF 154,182,182,154
PA 152,152,184
PF 154,184,184,154
PA 152,152,186
PF 154,186,186,154
PA 152,152,188
PF 154,188,188,154
PA 152,152,190
PF 154,190,190,154
v_add_f32 v152, v152, v153
v_add_f32 v153, v154, v155
s_nop 0
v_add_f32 v152, v152, v152 quad_perm:[1,0,3,2] row_mask:0xf bank_mask:0xf
v_add_f32 v153, v153, v153 quad_perm:[1,0,3,2] row_mask:0xf bank_mask:0xf
s_nop 0
v_add_f32 v152, v152, v152 quad_perm:[2,3,0,1] row_mask:0xf bank_mask:0xf
v_add_f32 v153, v153, v153 quad_perm:[2,3,0,1] row_mask:0xf bank_mask:0xf
s_nop 0
v_add_f32 v152, v152, v152 row_half_mirror row_mask:0xf bank_mask:0xf
v_add_f32 v153, v153, v153 row_half_mirror row_mask:0xf bank_mask:0xf
s_lshl_b32 s36, s3, 3
v_lshlrev_b32 v154, 5, v146
v_add_u32 v154, 0x20100, v154
v_add_u32 v155, s36, v154
ds_write_b64 v155, v[152:153]
WL 0
s_barrier
ds_read_b128 v[128:131], v154
RQ 132,154,16
WL 0
PA 128,128,130
PA 128,128,132
PA 128,128,134
v_mul_f32 v128, 0x3a800000, v128
v_mul_f32 v129, 0x3a800000, v129
v_fma_f32 v129, -v128, v128, v129
v_max_f32 v129, 0, v129
v_add_f32 v130, 0x3727c5ac, v129
v_rsq_f32 v130, v130
s_nop 0
v_mul_f32 v132, v130, v130
v_mul_f32 v132, v132, v129
v_add_f32 v132, 0x3727c5ac, v132
v_rsq_f32 v132, v132
v_mul_f32 v130, 0x3e0293ee, v130
v_mul_f32 v132, 0x40faf233, v132
v_mov_b32 v129, v128
v_mov_b32 v131, v130
v_pk_add_f32 v[160:161], v[160:161], v[128:129] neg_lo:[0,1] neg_hi:[0,1]
v_pk_add_f32 v[162:163], v[162:163], v[128:129] neg_lo:[0,1] neg_hi:[0,1]
v_pk_add_f32 v[164:165], v[164:165], v[128:129] neg_lo:[0,1] neg_hi:[0,1]
v_pk_add_f32 v[166:167], v[166:167], v[128:129] neg_lo:[0,1] neg_hi:[0,1]
PM 160,160,130
PM 162,162,130
PM 164,164,130
PM 166,166,130
CV 136,160,161
CV 137,162,163
CV 138,164,165
CV 139,166,167
ds_write_b64 v156, v[136:137] offset:0
ds_write_b64 v156, v[138:139] offset:128
v_pk_add_f32 v[168:169], v[168:169], v[128:129] neg_lo:[0,1] neg_hi:[0,1]
v_pk_add_f32 v[170:171], v[170:171], v[128:129] neg_lo:[0,1] neg_hi:[0,1]
v_pk_add_f32 v[172:173], v[172:173], v[128:129] neg_lo:[0,1] neg_hi:[0,1]
v_pk_add_f32 v[174:175], v[174:175], v[128:129] neg_lo:[0,1] neg_hi:[0,1]
PM 168,168,130
PM 170,170,130
PM 172,172,130
PM 174,174,130
CV 140,168,169
CV 141,170,171
CV 142,172,173
CV 143,174,175
ds_write_b64 v156, v[140:141] offset:1024
ds_write_b64 v156, v[142:143] offset:1152
v_pk_add_f32 v[176:177], v[176:177], v[128:129] neg_lo:[0,1] neg_hi:[0,1]
v_pk_add_f32 v[178:179], v[178:179], v[128:129] neg_lo:[0,1] neg_hi:[0,1]
v_pk_add_f32 v[180:181], v[180:181], v[128:129] neg_lo:[0,1] neg_hi:[0,1]
v_pk_add_f32 v[182:183], v[182:183], v[128:129] neg_lo:[0,1] neg_hi:[0,1]
PM 176,176,130
PM 178,178,130
PM 180,180,130
PM 182,182,130
CV 136,176,177
CV 137,178,179
CV 138,180,181
CV 139,182,183
ds_write_b64 v156, v[136:137] offset:2048
ds_write_b64 v156, v[138:139] offset:2176
v_pk_add_f32 v[184:185], v[184:185], v[128:129] neg_lo:[0,1] neg_hi:[0,1]
v_pk_add_f32 v[186:187], v[186:187], v[128:129] neg_lo:[0,1] neg_hi:[0,1]
v_pk_add_f32 v[188:189], v[188:189], v[128:129] neg_lo:[0,1] neg_hi:[0,1]
v_pk_add_f32 v[190:191], v[190:191], v[128:129] neg_lo:[0,1] neg_hi:[0,1]
PM 184,184,130
PM 186,186,130
PM 188,188,130
PM 190,190,130
CV 140,184,185
CV 141,186,187
CV 142,188,189
CV 143,190,191
ds_write_b64 v156, v[140:141] offset:3072
ds_write_b64 v156, v[142:143] offset:3200
WL 0
RQ 160,157,0
RQ 164,157,1024
RQ 168,157,2048
RQ 172,157,3072
WL 3
buffer_store_dwordx4 v[160:163], v151, s[84:87], s37 offen offset:0 sc1
WL 2
buffer_store_dwordx4 v[164:167], v151, s[84:87], s37 offen offset:2048 sc1
WL 1
buffer_store_dwordx4 v[168:171], v151, s[84:87], s38 offen offset:0 sc1
WL 0
buffer_store_dwordx4 v[172:175], v151, s[84:87], s38 offen offset:2048 sc1
s_lshl_b32 s36, s3, 24
s_lshl_b32 s37, s2, 8
s_add_u32 s36, s36, s37
buffer_store_dword v132, v147, s[96:99], s36 offen sc1
s_cmp_lg_u32 s3, 0
s_cbranch_scc1 LN_nz96
buffer_load_dwordx4 v[192:195], v158, s[88:91], 0 offen sc1
LN_nz96:
s_lshr_b32 s36, s34, 1
s_lshr_b32 s55, s36, 1
s_add_u32 s55, s55, 1
s_sub_u32 s38, 0, s55
s_bitcmp1_b32 s36, 0
s_cselect_b32 s55, s38, s55
s_mov_b32 s24, 0
v_and_b32 v2, 15, v1
v_add_u32 v3, s55, v2
v_ashrrev_i32 v4, 4, v3
v_lshlrev_b32 v5, 4, v1
v_and_b32 v3, 15, v3
v_and_b32 v6, 48, v1
v_add_u32 v3, v3, v6
v_lshlrev_b32 v92, 4, v3
v_add_u32 v93, 0x8000, v92
v_and_b32 v3, 7, v2
v_lshlrev_b32 v3, 5, v3
v_lshrrev_b32 v2, 3, v2
v_lshl_add_u32 v3, v2, 8, v3
v_cmp_ne_u32 s[58:59], 0, v4
v_min_i32 v6, 0, v4
v_lshlrev_b32 v6, 1, v6
v_sub_u32 v6, s39, v6
v_add_u32 v6, 0, v6
v_min_u32 v6, 0x1000, v6
v_lshl_add_u32 v84, v6, 15, v5
v_lshl_add_u32 v62, v6, 9, v3
v_max_i32 v6, 0, v4
v_lshlrev_b32 v6, 1, v6
v_sub_u32 v6, s39, v6
v_add_u32 v6, 1, v6
v_min_u32 v6, 0x1000, v6
v_lshl_add_u32 v85, v6, 15, v5
v_lshl_add_u32 v63, v6, 9, v3
s_cmp_eq_u32 s3, 0
s_cbranch_scc1 B1_ln_w0
s_waitcnt vmcnt(0)
s_barrier
s_branch B1_ln_b
B1_ln_w0:
s_mov_b32 s36, 0x01010101
s_waitcnt vmcnt(0)
s_barrier
B1_ln_zc:
v_and_b32 v192, v192, v193
v_and_b32 v194, v194, v195
v_and_b32 v192, v192, v194
v_cmp_ne_u32 vcc, s36, v192
s_nop 1
s_cbranch_vccz B1_ln_zo
buffer_load_dwordx4 v[192:195], v158, s[88:91], 0 offen sc1
s_waitcnt vmcnt(0)
s_branch B1_ln_zc
B1_ln_zo:
s_lshr_b32 s36, s2, 4
s_lshl_b32 s36, s36, 7
s_add_u32 s36, s36, 22528
v_mov_b32 v152, 0
v_mov_b32 v153, 1
s_mov_b64 exec, 1
buffer_atomic_add v153, v152, s[44:47], s36 offen sc1
s_mov_b64 exec, -1
s_cmp_gt_i32 s55, 0
s_cselect_b32 s36, -1, 1
s_add_i32 s36, s36, s33
s_max_i32 s36, s36, 0
s_min_i32 s36, s36, 15
s_lshl_b32 s36, s36, 7
s_lshl_b32 s37, s33, 7
v_mov_b32 v152, s36
v_writelane_b32 v152, s37, 0
s_mov_b32 s36, 22528
s_sleep 16
B1_ln_p:
s_sleep 8
buffer_load_dword v153, v152, s[44:47], s36 offen sc1
s_waitcnt vmcnt(0)
v_cmp_ne_u32 vcc, 16, v153
s_nop 1
s_cbranch_vccnz B1_ln_p
B1_ln_b:
s_barrier
buffer_load_dwordx4 a[0:3], v84, s[8:11], s24 offen offset:0 sc1
buffer_load_dwordx4 a[4:7], v84, s[8:11], s24 offen offset:1024 sc1
buffer_load_dwordx4 a[8:11], v85, s[8:11], s24 offen offset:0 sc1
buffer_load_dwordx4 a[12:15], v85, s[8:11], s24 offen offset:1024 sc1
s_add_u32 s24, s24, 2048
buffer_load_dwordx4 a[16:19], v84, s[8:11], s24 offen offset:0 sc1
buffer_load_dwordx4 a[20:23], v84, s[8:11], s24 offen offset:1024 sc1
buffer_load_dwordx4 a[24:27], v85, s[8:11], s24 offen offset:0 sc1
buffer_load_dwordx4 a[28:31], v85, s[8:11], s24 offen offset:1024 sc1
s_add_u32 s24, s24, 2048
v_lshrrev_b32 v2, 2, v1
v_and_b32 v3, 7, v2
v_lshlrev_b32 v2, 8, v2
v_and_b32 v4, 3, v1
v_lshl_add_u32 v2, v4, 3, v2
v_xor_b32 v4, 0, v3
v_lshl_add_u32 v64, v4, 5, v2
v_add_u32 v72, 0x10000, v64
v_xor_b32 v4, 1, v3
v_lshl_add_u32 v65, v4, 5, v2
v_add_u32 v73, 0x10000, v65
v_xor_b32 v4, 2, v3
v_lshl_add_u32 v66, v4, 5, v2
v_add_u32 v74, 0x10000, v66
v_xor_b32 v4, 3, v3
v_lshl_add_u32 v67, v4, 5, v2
v_add_u32 v75, 0x10000, v67
v_xor_b32 v4, 4, v3
v_lshl_add_u32 v68, v4, 5, v2
v_add_u32 v76, 0x10000, v68
v_xor_b32 v4, 5, v3
v_lshl_add_u32 v69, v4, 5, v2
v_add_u32 v77, 0x10000, v69
v_xor_b32 v4, 6, v3
v_lshl_add_u32 v70, v4, 5, v2
v_add_u32 v78, 0x10000, v70
v_xor_b32 v4, 7, v3
v_lshl_add_u32 v71, v4, 5, v2
v_add_u32 v79, 0x10000, v71
s_waitcnt vmcnt(4)
s_barrier
TR 96,64,0
TR 98,64,4096
TR 100,64,8192
TR 102,64,12288
TR 104,65,0
TR 106,65,4096
TR 108,65,8192
TR 110,65,12288
TR 112,66,0
TR 114,66,4096
TR 116,66,8192
TR 118,66,12288
TR 120,67,0
TR 122,67,4096
TR 124,67,8192
TR 126,67,12288
WL 12
Zvva 160,96,0
TR 128,68,0
s_add_u32 m0, s27, 32768
Mvva 160,100,4
TR 130,68,4096
DM 80,12,25,0
Zvva 164,96,8
TR 132,68,8192
DM 81,12,25,1024
Mvva 164,100,12
TR 134,68,12288
WL 12
Zvva 168,104,0
TR 136,69,0
DM 82,12,25,2048
Mvva 168,108,4
TR 138,69,4096
DM 83,12,25,3072
Zvva 172,104,8
TR 140,69,8192
s_add_u32 s25, s25, 131072
Mvva 172,108,12
TR 142,69,12288
WL 12
Zvva 176,112,0
TR 144,70,0
buffer_load_dwordx4 a[32:35], v84, s[8:11], s24 offen offset:0 sc1
Mvva 176,116,4
TR 146,70,4096
buffer_load_dwordx4 a[36:39], v84, s[8:11], s24 offen offset:1024 sc1
Zvva 180,112,8
TR 148,70,8192
buffer_load_dwordx4 a[40:43], v85, s[8:11], s24 offen offset:0 sc1
Mvva 180,116,12
TR 150,70,12288
WL 12
Zvva 184,120,0
TR 152,71,0
buffer_load_dwordx4 a[44:47], v85, s[8:11], s24 offen offset:1024 sc1
Mvva 184,124,4
TR 154,71,4096
s_add_u32 s24, s24, 2048
Zvva 188,120,8
TR 156,71,8192
Mvva 188,124,12
TR 158,71,12288
WL 12
s_waitcnt vmcnt(8)
s_barrier
Zvva 192,128,0
TR 96,64,16384
s_add_u32 m0, s27, 49152
Mvva 192,132,4
TR 98,64,20480
DM 80,12,25,0
Zvva 196,128,8
TR 100,64,24576
Mvva 196,132,12
TR 102,64,28672
WL 12
Zvva 200,136,0
TR 104,65,16384
DM 81,12,25,1024
Mvva 200,140,4
TR 106,65,20480
Zvva 204,136,8
TR 108,65,24576
DM 82,12,25,2048
Mvva 204,140,12
TR 110,65,28672
WL 12
Zvva 208,144,0
TR 112,66,16384
Mvva 208,148,4
TR 114,66,20480
DM 83,12,25,3072
Zvva 212,144,8
TR 116,66,24576
Mvva 212,148,12
TR 118,66,28672
WL 12
Zvva 216,152,0
TR 120,67,16384
s_add_u32 s25, s25, 131072
Mvva 216,156,4
TR 122,67,20480
Zvva 220,152,8
TR 124,67,24576
buffer_load_dwordx4 a[48:51], v84, s[8:11], s24 offen offset:0 sc1
Mvva 220,156,12
TR 126,67,28672
WL 12
Mvva 160,96,16
TR 128,68,16384
buffer_load_dwordx4 a[52:55], v84, s[8:11], s24 offen offset:1024 sc1
Mvva 160,100,20
TR 130,68,20480
Mvva 164,96,24
TR 132,68,24576
buffer_load_dwordx4 a[56:59], v85, s[8:11], s24 offen offset:0 sc1
Mvva 164,100,28
TR 134,68,28672
WL 12
Mvva 168,104,16
TR 136,69,16384
Mvva 168,108,20
TR 138,69,20480
buffer_load_dwordx4 a[60:63], v85, s[8:11], s24 offen offset:1024 sc1
Mvva 172,104,24
TR 140,69,24576
Mvva 172,108,28
TR 142,69,28672
WL 12
Mvva 176,112,16
TR 144,70,16384
s_add_u32 s24, s24, 2048
Mvva 176,116,20
TR 146,70,20480
Mvva 180,112,24
TR 148,70,24576
buffer_load_dword v94, v62, s[96:99], 0 offen sc1
Mvva 180,116,28
TR 150,70,28672
WL 12
Mvva 184,120,16
TR 152,71,16384
Mvva 184,124,20
TR 154,71,20480
buffer_load_dword v95, v63, s[96:99], 0 offen sc1
Mvva 188,120,24
TR 156,71,24576
Mvva 188,124,28
TR 158,71,28672
WL 12
s_waitcnt vmcnt(10)
s_barrier
Mvva 192,128,16
TR 96,64,32768
s_add_u32 m0, s27, 0
Mvva 192,132,20
TR 98,64,36864
Mvva 196,128,24
TR 100,64,40960
DM 80,12,25,0
Mvva 196,132,28
TR 102,64,45056
WL 12
Mvva 200,136,16
TR 104,65,32768
Mvva 200,140,20
TR 106,65,36864
DM 81,12,25,1024
Mvva 204,136,24
TR 108,65,40960
Mvva 204,140,28
TR 110,65,45056
WL 12
Mvva 208,144,16
TR 112,66,32768
DM 82,12,25,2048
Mvva 208,148,20
TR 114,66,36864
Mvva 212,144,24
TR 116,66,40960
DM 83,12,25,3072
Mvva 212,148,28
TR 118,66,45056
WL 12
Mvva 216,152,16
TR 120,67,32768
Mvva 216,156,20
TR 122,67,36864
s_add_u32 s25, s25, 131072
Mvva 220,152,24
TR 124,67,40960
Mvva 220,156,28
TR 126,67,45056
WL 12
Mvva 160,96,32
TR 128,68,32768
Mvva 160,100,36
TR 130,68,36864
buffer_load_dwordx4 a[0:3], v84, s[8:11], s24 offen offset:0 sc1
Mvva 164,96,40
TR 132,68,40960
Mvva 164,100,44
TR 134,68,45056
WL 12
Mvva 168,104,32
TR 136,69,32768
buffer_load_dwordx4 a[4:7], v84, s[8:11], s24 offen offset:1024 sc1
Mvva 168,108,36
TR 138,69,36864
Mvva 172,104,40
TR 140,69,40960
buffer_load_dwordx4 a[8:11], v85, s[8:11], s24 offen offset:0 sc1
Mvva 172,108,44
TR 142,69,45056
WL 12
Mvva 176,112,32
TR 144,70,32768
Mvva 176,116,36
TR 146,70,36864
buffer_load_dwordx4 a[12:15], v85, s[8:11], s24 offen offset:1024 sc1
Mvva 180,112,40
TR 148,70,40960
Mvva 180,116,44
TR 150,70,45056
WL 12
Mvva 184,120,32
TR 152,71,32768
s_add_u32 s24, s24, 2048
Mvva 184,124,36
TR 154,71,36864
Mvva 188,120,40
TR 156,71,40960
Mvva 188,124,44
TR 158,71,45056
WL 12
s_waitcnt vmcnt(10)
s_barrier
Mvva 192,128,32
TR 96,64,49152
s_add_u32 m0, s27, 16384
Mvva 192,132,36
TR 98,64,53248
Mvva 196,128,40
TR 100,64,57344
DM 80,12,25,0
Mvva 196,132,44
TR 102,64,61440
WL 12
Mvva 200,136,32
TR 104,65,49152
Mvva 200,140,36
TR 106,65,53248
DM 81,12,25,1024
Mvva 204,136,40
TR 108,65,57344
Mvva 204,140,44
TR 110,65,61440
WL 12
Mvva 208,144,32
TR 112,66,49152
DM 82,12,25,2048
Mvva 208,148,36
TR 114,66,53248
Mvva 212,144,40
TR 116,66,57344
DM 83,12,25,3072
Mvva 212,148,44
TR 118,66,61440
WL 12
Mvva 216,152,32
TR 120,67,49152
Mvva 216,156,36
TR 122,67,53248
s_add_u32 s25, s25, 131072
Mvva 220,152,40
TR 124,67,57344
Mvva 220,156,44
TR 126,67,61440
WL 12
Mvva 160,96,48
TR 128,68,49152
Mvva 160,100,52
TR 130,68,53248
buffer_load_dwordx4 a[16:19], v84, s[8:11], s24 offen offset:0 sc1
Mvva 164,96,56
TR 132,68,57344
Mvva 164,100,60
TR 134,68,61440
WL 12
Mvva 168,104,48
TR 136,69,49152
buffer_load_dwordx4 a[20:23], v84, s[8:11], s24 offen offset:1024 sc1
Mvva 168,108,52
TR 138,69,53248
Mvva 172,104,56
TR 140,69,57344
buffer_load_dwordx4 a[24:27], v85, s[8:11], s24 offen offset:0 sc1
Mvva 172,108,60
TR 142,69,61440
WL 12
Mvva 176,112,48
TR 144,70,49152
Mvva 176,116,52
TR 146,70,53248
buffer_load_dwordx4 a[28:31], v85, s[8:11], s24 offen offset:1024 sc1
Mvva 180,112,56
TR 148,70,57344
Mvva 180,116,60
TR 150,70,61440
WL 12
Mvva 184,120,48
TR 152,71,49152
s_add_u32 s24, s24, 2048
Mvva 184,124,52
TR 154,71,53248
Mvva 188,120,56
TR 156,71,57344
Mvva 188,124,60
TR 158,71,61440
WL 12
s_mov_b32 s32, 2
B1_loop:
s_waitcnt vmcnt(8)
s_barrier
Mvva 192,128,48
TR 96,64,0
s_add_u32 m0, s27, 32768
Mvva 192,132,52
TR 98,64,4096
Mvva 196,128,56
TR 100,64,8192
DM 80,12,25,0
Mvva 196,132,60
TR 102,64,12288
WL 12
Mvva 200,136,48
TR 104,65,0
Mvva 200,140,52
TR 106,65,4096
DM 81,12,25,1024
Mvva 204,136,56
TR 108,65,8192
Mvva 204,140,60
TR 110,65,12288
WL 12
Mvva 208,144,48
TR 112,66,0
DM 82,12,25,2048
Mvva 208,148,52
TR 114,66,4096
Mvva 212,144,56
TR 116,66,8192
DM 83,12,25,3072
Mvva 212,148,60
TR 118,66,12288
WL 12
Mvva 216,152,48
TR 120,67,0
Mvva 216,156,52
TR 122,67,4096
s_add_u32 s25, s25, 131072
Mvva 220,152,56
TR 124,67,8192
Mvva 220,156,60
TR 126,67,12288
WL 12
Mvva 160,96,0
TR 128,68,0
Mvva 160,100,4
TR 130,68,4096
buffer_load_dwordx4 a[32:35], v84, s[8:11], s24 offen offset:0 sc1
Mvva 164,96,8
TR 132,68,8192
Mvva 164,100,12
TR 134,68,12288
WL 12
Mvva 168,104,0
TR 136,69,0
buffer_load_dwordx4 a[36:39], v84, s[8:11], s24 offen offset:1024 sc1
Mvva 168,108,4
TR 138,69,4096
Mvva 172,104,8
TR 140,69,8192
buffer_load_dwordx4 a[40:43], v85, s[8:11], s24 offen offset:0 sc1
Mvva 172,108,12
TR 142,69,12288
WL 12
Mvva 176,112,0
TR 144,70,0
Mvva 176,116,4
TR 146,70,4096
buffer_load_dwordx4 a[44:47], v85, s[8:11], s24 offen offset:1024 sc1
Mvva 180,112,8
TR 148,70,8192
Mvva 180,116,12
TR 150,70,12288
WL 12
Mvva 184,120,0
TR 152,71,0
s_add_u32 s24, s24, 2048
Mvva 184,124,4
TR 154,71,4096
Mvva 188,120,8
TR 156,71,8192
Mvva 188,124,12
TR 158,71,12288
WL 12
s_waitcnt vmcnt(8)
s_barrier
Mvva 192,128,0
TR 96,64,16384
s_add_u32 m0, s27, 49152
Mvva 192,132,4
TR 98,64,20480
Mvva 196,128,8
TR 100,64,24576
DM 80,12,25,0
Mvva 196,132,12
TR 102,64,28672
WL 12
Mvva 200,136,0
TR 104,65,16384
Mvva 200,140,4
TR 106,65,20480
DM 81,12,25,1024
Mvva 204,136,8
TR 108,65,24576
Mvva 204,140,12
TR 110,65,28672
WL 12
Mvva 208,144,0
TR 112,66,16384
DM 82,12,25,2048
Mvva 208,148,4
TR 114,66,20480
Mvva 212,144,8
TR 116,66,24576
DM 83,12,25,3072
Mvva 212,148,12
TR 118,66,28672
WL 12
Mvva 216,152,0
TR 120,67,16384
Mvva 216,156,4
TR 122,67,20480
s_add_u32 s25, s25, 131072
Mvva 220,152,8
TR 124,67,24576
Mvva 220,156,12
TR 126,67,28672
WL 12
Mvva 160,96,16
TR 128,68,16384
Mvva 160,100,20
TR 130,68,20480
buffer_load_dwordx4 a[48:51], v84, s[8:11], s24 offen offset:0 sc1
Mvva 164,96,24
TR 132,68,24576
Mvva 164,100,28
TR 134,68,28672
WL 12
Mvva 168,104,16
TR 136,69,16384
buffer_load_dwordx4 a[52:55], v84, s[8:11], s24 offen offset:1024 sc1
Mvva 168,108,20
TR 138,69,20480
Mvva 172,104,24
TR 140,69,24576
buffer_load_dwordx4 a[56:59], v85, s[8:11], s24 offen offset:0 sc1
Mvva 172,108,28
TR 142,69,28672
WL 12
Mvva 176,112,16
TR 144,70,16384
Mvva 176,116,20
TR 146,70,20480
buffer_load_dwordx4 a[60:63], v85, s[8:11], s24 offen offset:1024 sc1
Mvva 180,112,24
TR 148,70,24576
Mvva 180,116,28
TR 150,70,28672
WL 12
Mvva 184,120,16
TR 152,71,16384
s_add_u32 s24, s24, 2048
Mvva 184,124,20
TR 154,71,20480
Mvva 188,120,24
TR 156,71,24576
Mvva 188,124,28
TR 158,71,28672
WL 12
s_waitcnt vmcnt(8)
s_barrier
Mvva 192,128,16
TR 96,64,32768
s_add_u32 m0, s27, 0
Mvva 192,132,20
TR 98,64,36864
Mvva 196,128,24
TR 100,64,40960
DM 80,12,25,0
Mvva 196,132,28
TR 102,64,45056
WL 12
Mvva 200,136,16
TR 104,65,32768
Mvva 200,140,20
TR 106,65,36864
DM 81,12,25,1024
Mvva 204,136,24
TR 108,65,40960
Mvva 204,140,28
TR 110,65,45056
WL 12
Mvva 208,144,16
TR 112,66,32768
DM 82,12,25,2048
Mvva 208,148,20
TR 114,66,36864
Mvva 212,144,24
TR 116,66,40960
DM 83,12,25,3072
Mvva 212,148,28
TR 118,66,45056
WL 12
Mvva 216,152,16
TR 120,67,32768
Mvva 216,156,20
TR 122,67,36864
s_add_u32 s25, s25, 131072
Mvva 220,152,24
TR 124,67,40960
Mvva 220,156,28
TR 126,67,45056
WL 12
Mvva 160,96,32
TR 128,68,32768
Mvva 160,100,36
TR 130,68,36864
buffer_load_dwordx4 a[0:3], v84, s[8:11], s24 offen offset:0 sc1
Mvva 164,96,40
TR 132,68,40960
Mvva 164,100,44
TR 134,68,45056
WL 12
Mvva 168,104,32
TR 136,69,32768
buffer_load_dwordx4 a[4:7], v84, s[8:11], s24 offen offset:1024 sc1
Mvva 168,108,36
TR 138,69,36864
Mvva 172,104,40
TR 140,69,40960
buffer_load_dwordx4 a[8:11], v85, s[8:11], s24 offen offset:0 sc1
Mvva 172,108,44
TR 142,69,45056
WL 12
Mvva 176,112,32
TR 144,70,32768
Mvva 176,116,36
TR 146,70,36864
buffer_load_dwordx4 a[12:15], v85, s[8:11], s24 offen offset:1024 sc1
Mvva 180,112,40
TR 148,70,40960
Mvva 180,116,44
TR 150,70,45056
WL 12
Mvva 184,120,32
TR 152,71,32768
s_add_u32 s24, s24, 2048
Mvva 184,124,36
TR 154,71,36864
Mvva 188,120,40
TR 156,71,40960
Mvva 188,124,44
TR 158,71,45056
WL 12
s_waitcnt vmcnt(8)
s_barrier
Mvva 192,128,32
TR 96,64,49152
s_add_u32 m0, s27, 16384
Mvva 192,132,36
TR 98,64,53248
Mvva 196,128,40
TR 100,64,57344
DM 80,12,25,0
Mvva 196,132,44
TR 102,64,61440
WL 12
Mvva 200,136,32
TR 104,65,49152
Mvva 200,140,36
TR 106,65,53248
DM 81,12,25,1024
Mvva 204,136,40
TR 108,65,57344
Mvva 204,140,44
TR 110,65,61440
WL 12
Mvva 208,144,32
TR 112,66,49152
DM 82,12,25,2048
Mvva 208,148,36
TR 114,66,53248
Mvva 212,144,40
TR 116,66,57344
DM 83,12,25,3072
Mvva 212,148,44
TR 118,66,61440
WL 12
Mvva 216,152,32
TR 120,67,49152
Mvva 216,156,36
TR 122,67,53248
s_add_u32 s25, s25, 131072
Mvva 220,152,40
TR 124,67,57344
Mvva 220,156,44
TR 126,67,61440
WL 12
Mvva 160,96,48
TR 128,68,49152
Mvva 160,100,52
TR 130,68,53248
buffer_load_dwordx4 a[16:19], v84, s[8:11], s24 offen offset:0 sc1
Mvva 164,96,56
TR 132,68,57344
Mvva 164,100,60
TR 134,68,61440
WL 12
Mvva 168,104,48
TR 136,69,49152
buffer_load_dwordx4 a[20:23], v84, s[8:11], s24 offen offset:1024 sc1
Mvva 168,108,52
TR 138,69,53248
Mvva 172,104,56
TR 140,69,57344
buffer_load_dwordx4 a[24:27], v85, s[8:11], s24 offen offset:0 sc1
Mvva 172,108,60
TR 142,69,61440
WL 12
Mvva 176,112,48
TR 144,70,49152
Mvva 176,116,52
TR 146,70,53248
buffer_load_dwordx4 a[28:31], v85, s[8:11], s24 offen offset:1024 sc1
Mvva 180,112,56
TR 148,70,57344
Mvva 180,116,60
TR 150,70,61440
WL 12
Mvva 184,120,48
TR 152,71,49152
s_add_u32 s24, s24, 2048
Mvva 184,124,52
TR 154,71,53248
Mvva 188,120,56
TR 156,71,57344
s_sub_u32 s32, s32, 1
Mvva 188,124,60
TR 158,71,61440
WL 12
s_cmp_lg_u32 s32, 0
s_cbranch_scc1 B1_loop
s_waitcnt vmcnt(8)
s_barrier
Mvva 192,128,48
TR 96,64,0
s_add_u32 m0, s27, 32768
Mvva 192,132,52
TR 98,64,4096
Mvva 196,128,56
TR 100,64,8192
DM 80,12,25,0
Mvva 196,132,60
TR 102,64,12288
WL 12
Mvva 200,136,48
TR 104,65,0
Mvva 200,140,52
TR 106,65,4096
DM 81,12,25,1024
Mvva 204,136,56
TR 108,65,8192
Mvva 204,140,60
TR 110,65,12288
WL 12
Mvva 208,144,48
TR 112,66,0
DM 82,12,25,2048
Mvva 208,148,52
TR 114,66,4096
Mvva 212,144,56
TR 116,66,8192
DM 83,12,25,3072
Mvva 212,148,60
TR 118,66,12288
WL 12
Mvva 216,152,48
TR 120,67,0
Mvva 216,156,52
TR 122,67,4096
s_add_u32 s25, s25, 131072
Mvva 220,152,56
TR 124,67,8192
Mvva 220,156,60
TR 126,67,12288
WL 12
Mvva 160,96,0
TR 128,68,0
Mvva 160,100,4
TR 130,68,4096
buffer_load_dwordx4 a[32:35], v84, s[8:11], s24 offen offset:0 sc1
Mvva 164,96,8
TR 132,68,8192
Mvva 164,100,12
TR 134,68,12288
WL 12
Mvva 168,104,0
TR 136,69,0
buffer_load_dwordx4 a[36:39], v84, s[8:11], s24 offen offset:1024 sc1
Mvva 168,108,4
TR 138,69,4096
Mvva 172,104,8
TR 140,69,8192
buffer_load_dwordx4 a[40:43], v85, s[8:11], s24 offen offset:0 sc1
Mvva 172,108,12
TR 142,69,12288
WL 12
Mvva 176,112,0
TR 144,70,0
Mvva 176,116,4
TR 146,70,4096
buffer_load_dwordx4 a[44:47], v85, s[8:11], s24 offen offset:1024 sc1
Mvva 180,112,8
TR 148,70,8192
Mvva 180,116,12
TR 150,70,12288
WL 12
Mvva 184,120,0
TR 152,71,0
s_add_u32 s24, s24, 2048
Mvva 184,124,4
TR 154,71,4096
Mvva 188,120,8
TR 156,71,8192
Mvva 188,124,12
TR 158,71,12288
WL 12
s_waitcnt vmcnt(8)
s_barrier
Mvva 192,128,0
TR 96,64,16384
s_add_u32 m0, s27, 49152
Mvva 192,132,4
TR 98,64,20480
Mvva 196,128,8
TR 100,64,24576
DM 80,12,25,0
Mvva 196,132,12
TR 102,64,28672
WL 12
Mvva 200,136,0
TR 104,65,16384
Mvva 200,140,4
TR 106,65,20480
DM 81,12,25,1024
Mvva 204,136,8
TR 108,65,24576
Mvva 204,140,12
TR 110,65,28672
WL 12
Mvva 208,144,0
TR 112,66,16384
DM 82,12,25,2048
Mvva 208,148,4
TR 114,66,20480
Mvva 212,144,8
TR 116,66,24576
DM 83,12,25,3072
Mvva 212,148,12
TR 118,66,28672
WL 12
Mvva 216,152,0
TR 120,67,16384
Mvva 216,156,4
TR 122,67,20480
s_add_u32 s25, s25, 131072
Mvva 220,152,8
TR 124,67,24576
Mvva 220,156,12
TR 126,67,28672
WL 12
Mvva 160,96,16
TR 128,68,16384
Mvva 160,100,20
TR 130,68,20480
buffer_load_dwordx4 a[48:51], v84, s[8:11], s24 offen offset:0 sc1
Mvva 164,96,24
TR 132,68,24576
Mvva 164,100,28
TR 134,68,28672
WL 12
Mvva 168,104,16
TR 136,69,16384
buffer_load_dwordx4 a[52:55], v84, s[8:11], s24 offen offset:1024 sc1
Mvva 168,108,20
TR 138,69,20480
Mvva 172,104,24
TR 140,69,24576
buffer_load_dwordx4 a[56:59], v85, s[8:11], s24 offen offset:0 sc1
Mvva 172,108,28
TR 142,69,28672
WL 12
Mvva 176,112,16
TR 144,70,16384
Mvva 176,116,20
TR 146,70,20480
buffer_load_dwordx4 a[60:63], v85, s[8:11], s24 offen offset:1024 sc1
Mvva 180,112,24
TR 148,70,24576
Mvva 180,116,28
TR 150,70,28672
WL 12
Mvva 184,120,16
TR 152,71,16384
s_add_u32 s24, s24, 2048
Mvva 184,124,20
TR 154,71,20480
Mvva 188,120,24
TR 156,71,24576
Mvva 188,124,28
TR 158,71,28672
WL 12
s_waitcnt vmcnt(8)
s_barrier
Mvva 192,128,16
TR 96,64,32768
Mvva 192,132,20
TR 98,64,36864
Mvva 196,128,24
TR 100,64,40960
Mvva 196,132,28
TR 102,64,45056
WL 12
Mvva 200,136,16
TR 104,65,32768
Mvva 200,140,20
TR 106,65,36864
Mvva 204,136,24
TR 108,65,40960
Mvva 204,140,28
TR 110,65,45056
WL 12
Mvva 208,144,16
TR 112,66,32768
Mvva 208,148,20
TR 114,66,36864
Mvva 212,144,24
TR 116,66,40960
Mvva 212,148,28
TR 118,66,45056
WL 12
Mvva 216,152,16
TR 120,67,32768
Mvva 216,156,20
TR 122,67,36864
Mvva 220,152,24
TR 124,67,40960
Mvva 220,156,28
TR 126,67,45056
WL 12
Mvva 160,96,32
TR 128,68,32768
Mvva 160,100,36
TR 130,68,36864
Mvva 164,96,40
TR 132,68,40960
Mvva 164,100,44
TR 134,68,45056
WL 12
Mvva 168,104,32
TR 136,69,32768
Mvva 168,108,36
TR 138,69,36864
Mvva 172,104,40
TR 140,69,40960
Mvva 172,108,44
TR 142,69,45056
WL 12
Mvva 176,112,32
TR 144,70,32768
Mvva 176,116,36
TR 146,70,36864
Mvva 180,112,40
TR 148,70,40960
Mvva 180,116,44
TR 150,70,45056
WL 12
Mvva 184,120,32
TR 152,71,32768
Mvva 184,124,36
TR 154,71,36864
Mvva 188,120,40
TR 156,71,40960
Mvva 188,124,44
TR 158,71,45056
WL 12
s_waitcnt vmcnt(0)
s_barrier
Mvva 192,128,32
TR 96,64,49152
Mvva 192,132,36
TR 98,64,53248
Mvva 196,128,40
TR 100,64,57344
Mvva 196,132,44
TR 102,64,61440
WL 12
Mvva 200,136,32
TR 104,65,49152
Mvva 200,140,36
TR 106,65,53248
Mvva 204,136,40
TR 108,65,57344
Mvva 204,140,44
TR 110,65,61440
WL 12
Mvva 208,144,32
TR 112,66,49152
Mvva 208,148,36
TR 114,66,53248
Mvva 212,144,40
TR 116,66,57344
Mvva 212,148,44
TR 118,66,61440
WL 12
Mvva 216,152,32
TR 120,67,49152
Mvva 216,156,36
TR 122,67,53248
Mvva 220,152,40
TR 124,67,57344
Mvva 220,156,44
TR 126,67,61440
WL 12
Mvva 160,96,48
TR 128,68,49152
Mvva 160,100,52
TR 130,68,53248
Mvva 164,96,56
TR 132,68,57344
Mvva 164,100,60
TR 134,68,61440
WL 12
Mvva 168,104,48
TR 136,69,49152
Mvva 168,108,52
TR 138,69,53248
Mvva 172,104,56
TR 140,69,57344
Mvva 172,108,60
TR 142,69,61440
WL 12
Mvva 176,112,48
TR 144,70,49152
Mvva 176,116,52
TR 146,70,53248
Mvva 180,112,56
TR 148,70,57344
Mvva 180,116,60
TR 150,70,61440
WL 12
Mvva 184,120,48
TR 152,71,49152
Mvva 184,124,52
TR 154,71,53248
Mvva 188,120,56
TR 156,71,57344
Mvva 188,124,60
TR 158,71,61440
WL 12
Mvva 192,128,48
Mvva 192,132,52
Mvva 196,128,56
Mvva 196,132,60
WL 8
Mvva 200,136,48
Mvva 200,140,52
Mvva 204,136,56
Mvva 204,140,60
WL 4
Mvva 208,144,48
Mvva 208,148,52
Mvva 212,144,56
Mvva 212,148,60
WL 0
Mvva 216,152,48
Mvva 216,156,52
Mvva 220,152,56
Mvva 220,156,60
B1_ep:
s_barrier
s_mov_b32 s12, s48
s_mov_b32 s13, s49
s_mov_b32 s14, 2097152
s_mov_b32 s15, 0x20000
s_lshl_b32 s25, s34, 8
s_lshl_b32 s43, s33, 7
s_add_u32 s62, s43, 28672
s_add_u32 s43, s43, 16384
s_mov_b32 s41, 16256
s_mov_b32 s42, 28544
s_add_u32 s36, s33, 1
s_lshl_b32 s36, s36, 7
v_mov_b32 v60, s36
s_lshl_b32 s40, s39, 15
s_lshl_b32 s36, s34, 12
s_add_u32 s40, s40, s36
v_rcp_f32 v6, v94
v_mul_f32 v2, 0xc0135761, v94
v_mul_f32 v4, v94, v94
v_mul_f32 v4, v4, v94
v_mul_f32 v4, 0xbdd2d3e8, v4
v_mov_b32 v3, v2
v_mov_b32 v5, v4
v_mov_b32 v7, v6
v_rcp_f32 v12, v95
v_mul_f32 v8, 0xc0135761, v95
v_mul_f32 v10, v95, v95
v_mul_f32 v10, v10, v95
v_mul_f32 v10, 0xbdd2d3e8, v10
v_mov_b32 v9, v8
v_mov_b32 v11, v10
v_mov_b32 v13, v12
PM 16,160,160
PM 18,162,162
PM 20,168,168
PM 22,170,170
PF 16,16,4,2
PF 18,18,4,2
PF 20,20,4,2
PF 22,22,4,2
PM 16,16,160
PM 18,18,162
PM 20,20,168
PM 22,22,170
EX 16
EX 17
PM 24,164,164
EX 18
EX 19
PM 26,166,166
EX 20
PM 28,172,172
PF 16,16,6,6
EX 21
PM 30,174,174
PF 18,18,6,6
EX 22
PF 24,24,10,8
EX 23
PF 26,26,10,8
RC 16
PF 20,20,6,6
PF 28,28,10,8
RC 17
PF 22,22,6,6
PF 30,30,10,8
RC 18
PM 24,24,164
RC 19
RC 20
PM 26,26,166
RC 21
RC 22
PM 28,28,172
RC 23
PM 30,30,174
EX 24
PM 160,160,16
EX 25
PM 162,162,18
EX 26
PM 168,168,20
EX 27
PM 170,170,22
EX 28
CV 40,160,161
PF 24,24,12,12
CV 41,162,163
EX 29
CV 42,168,169
PF 26,26,12,12
CV 43,170,171
EX 30
PM 32,176,176
EX 31
PM 34,178,178
RC 24
PM 36,184,184
PF 28,28,12,12
PM 38,186,186
RC 25
PF 32,32,4,2
PF 30,30,12,12
PF 34,34,4,2
RC 26
PF 36,36,4,2
RC 27
PF 38,38,4,2
RC 28
PM 32,32,176
RC 29
PM 34,34,178
RC 30
PM 36,36,184
RC 31
PM 38,38,186
EX 32
PM 164,164,24
EX 33
PM 166,166,26
PM 172,172,28
EX 34
PM 174,174,30
EX 35
CV 44,164,165
CV 45,166,167
EX 36
CV 46,172,173
PF 32,32,6,6
CV 47,174,175
v_cndmask_b32 v48, v40, v44, s[58:59]
EX 37
v_cndmask_b32 v49, v41, v45, s[58:59]
PF 34,34,6,6
v_cndmask_b32 v50, v42, v46, s[58:59]
v_cndmask_b32 v51, v43, v47, s[58:59]
EX 38
v_cndmask_b32 v44, v44, v40, s[58:59]
EX 39
v_cndmask_b32 v45, v45, v41, s[58:59]
v_cndmask_b32 v46, v46, v42, s[58:59]
RC 32
v_cndmask_b32 v47, v47, v43, s[58:59]
PF 36,36,6,6
buffer_store_dwordx4 v[48:51], v92, s[16:19], s40 offen offset:0 sc1
buffer_store_dwordx4 v[44:47], v93, s[16:19], s40 offen offset:0 sc1
RC 33
PM 16,180,180
PF 38,38,6,6
PM 18,182,182
PM 20,188,188
RC 34
PM 22,190,190
RC 35
PF 16,16,10,8
PF 18,18,10,8
RC 36
PF 20,20,10,8
RC 37
PF 22,22,10,8
PM 16,16,180
RC 38
PM 18,18,182
RC 39
PM 20,20,188
PM 22,22,190
EX 16
PM 176,176,32
EX 17
PM 178,178,34
EX 18
PM 184,184,36
EX 19
PM 186,186,38
EX 20
CV 40,176,177
PF 16,16,12,12
CV 41,178,179
EX 21
CV 42,184,185
PF 18,18,12,12
CV 43,186,187
EX 22
PM 24,192,192
EX 23
PM 26,194,194
RC 16
PM 28,200,200
PF 20,20,12,12
PM 30,202,202
RC 17
PF 24,24,4,2
PF 22,22,12,12
PF 26,26,4,2
RC 18
PF 28,28,4,2
RC 19
PF 30,30,4,2
RC 20
PM 24,24,192
RC 21
PM 26,26,194
RC 22
PM 28,28,200
RC 23
PM 30,30,202
EX 24
PM 180,180,16
EX 25
PM 182,182,18
PM 188,188,20
EX 26
PM 190,190,22
EX 27
CV 44,180,181
CV 45,182,183
EX 28
CV 46,188,189
PF 24,24,6,6
CV 47,190,191
v_cndmask_b32 v48, v40, v44, s[58:59]
EX 29
v_cndmask_b32 v49, v41, v45, s[58:59]
PF 26,26,6,6
v_cndmask_b32 v50, v42, v46, s[58:59]
v_cndmask_b32 v51, v43, v47, s[58:59]
EX 30
v_cndmask_b32 v44, v44, v40, s[58:59]
EX 31
v_cndmask_b32 v45, v45, v41, s[58:59]
v_cndmask_b32 v46, v46, v42, s[58:59]
RC 24
v_cndmask_b32 v47, v47, v43, s[58:59]
PF 28,28,6,6
buffer_store_dwordx4 v[48:51], v92, s[16:19], s40 offen offset:1024 sc1
buffer_store_dwordx4 v[44:47], v93, s[16:19], s40 offen offset:1024 sc1
RC 25
PM 32,196,196
PF 30,30,6,6
PM 34,198,198
PM 36,204,204
RC 26
PM 38,206,206
RC 27
PF 32,32,10,8
PF 34,34,10,8
RC 28
PF 36,36,10,8
RC 29
PF 38,38,10,8
PM 32,32,196
RC 30
PM 34,34,198
RC 31
PM 36,36,204
PM 38,38,206
EX 32
PM 192,192,24
EX 33
PM 194,194,26
EX 34
PM 200,200,28
EX 35
PM 202,202,30
EX 36
CV 40,192,193
PF 32,32,12,12
CV 41,194,195
EX 37
CV 42,200,201
PF 34,34,12,12
CV 43,202,203
EX 38
PM 16,208,208
EX 39
PM 18,210,210
RC 32
PM 20,216,216
PF 36,36,12,12
PM 22,218,218
RC 33
PF 16,16,4,2
PF 38,38,12,12
PF 18,18,4,2
RC 34
PF 20,20,4,2
RC 35
PF 22,22,4,2
RC 36
PM 16,16,208
RC 37
PM 18,18,210
RC 38
PM 20,20,216
RC 39
PM 22,22,218
EX 16
PM 196,196,32
EX 17
PM 198,198,34
PM 204,204,36
EX 18
PM 206,206,38
EX 19
CV 44,196,197
CV 45,198,199
EX 20
CV 46,204,205
PF 16,16,6,6
CV 47,206,207
v_cndmask_b32 v48, v40, v44, s[58:59]
EX 21
v_cndmask_b32 v49, v41, v45, s[58:59]
PF 18,18,6,6
v_cndmask_b32 v50, v42, v46, s[58:59]
v_cndmask_b32 v51, v43, v47, s[58:59]
EX 22
v_cndmask_b32 v44, v44, v40, s[58:59]
EX 23
v_cndmask_b32 v45, v45, v41, s[58:59]
v_cndmask_b32 v46, v46, v42, s[58:59]
RC 16
v_cndmask_b32 v47, v47, v43, s[58:59]
PF 20,20,6,6
buffer_store_dwordx4 v[48:51], v92, s[16:19], s40 offen offset:2048 sc1
buffer_store_dwordx4 v[44:47], v93, s[16:19], s40 offen offset:2048 sc1
s_waitcnt vmcnt(2)
s_barrier
s_cmp_lg_u32 s3, 0
s_cbranch_scc1 B1_sg0
s_mov_b64 exec, 1
v_mov_b32 v53, 1
buffer_atomic_add v53, off, s[44:47], s43 sc1
s_mov_b64 exec, -1
B1_sg0:
s_add_u32 m0, s27, 0
s_nop 0
DM 80,12,25,0
DM 81,12,25,1024
DM 82,12,25,2048
DM 83,12,25,3072
s_add_u32 s25, s25, 262144
s_add_u32 m0, s27, 16384
s_nop 0
DM 80,12,25,0
DM 81,12,25,1024
DM 82,12,25,2048
DM 83,12,25,3072
s_add_u32 s25, s25, 262144
s_add_u32 m0, s27, 32768
s_nop 0
DM 80,12,25,0
DM 81,12,25,1024
DM 82,12,25,2048
DM 83,12,25,3072
s_add_u32 s25, s25, 262144
s_cmp_lg_u32 s3, 0
s_cbranch_scc1 B2_o0
buffer_load_dword v61, v60, s[44:47], s41 offen sc1
B2_o0:
RC 17
PM 24,212,212
PF 22,22,6,6
PM 26,214,214
PM 28,220,220
RC 18
PM 30,222,222
RC 19
PF 24,24,10,8
PF 26,26,10,8
RC 20
PF 28,28,10,8
RC 21
PF 30,30,10,8
PM 24,24,212
RC 22
PM 26,26,214
RC 23
PM 28,28,220
PM 30,30,222
EX 24
EX 25
EX 26
PM 208,208,16
EX 27
EX 28
PM 210,210,18
PF 24,24,12,12
EX 29
PF 26,26,12,12
PM 216,216,20
EX 30
EX 31
PM 218,218,22
RC 24
PF 28,28,12,12
RC 25
CV 40,208,209
PF 30,30,12,12
RC 26
CV 41,210,211
RC 27
RC 28
RC 29
CV 42,216,217
RC 30
RC 31
CV 43,218,219
PM 212,212,24
PM 214,214,26
PM 220,220,28
PM 222,222,30
CV 44,212,213
CV 45,214,215
CV 46,220,221
CV 47,222,223
v_cndmask_b32 v48, v40, v44, s[58:59]
v_cndmask_b32 v49, v41, v45, s[58:59]
v_cndmask_b32 v50, v42, v46, s[58:59]
v_cndmask_b32 v51, v43, v47, s[58:59]
v_cndmask_b32 v44, v44, v40, s[58:59]
v_cndmask_b32 v45, v45, v41, s[58:59]
v_cndmask_b32 v46, v46, v42, s[58:59]
v_cndmask_b32 v47, v47, v43, s[58:59]
buffer_store_dwordx4 v[48:51], v92, s[16:19], s40 offen offset:3072 sc1
buffer_store_dwordx4 v[44:47], v93, s[16:19], s40 offen offset:3072 sc1
s_mul_i32 s24, s39, 32768
v_lshlrev_b32 v84, 4, v1
v_add_u32 v85, 32768, v84
s_add_u32 s8, s4, 8388608
s_addc_u32 s9, s5, 0
s_mov_b32 s10, 4194304
s_mov_b32 s11, 0x20000
s_waitcnt vmcnt(2)
s_cmp_lg_u32 s3, 0
s_cbranch_scc1 B2_h0_k
v_cmp_ne_u32 vcc, 8, v61
s_nop 1
s_cbranch_vccnz B2_h0_w
B2_h0_k:
s_barrier
buffer_load_dwordx4 a[0:3], v84, s[8:11], s24 offen offset:0 sc1
buffer_load_dwordx4 a[4:7], v84, s[8:11], s24 offen offset:1024 sc1
buffer_load_dwordx4 a[8:11], v85, s[8:11], s24 offen offset:0 sc1
buffer_load_dwordx4 a[12:15], v85, s[8:11], s24 offen offset:1024 sc1
s_add_u32 s24, s24, 4096
buffer_load_dwordx4 a[16:19], v84, s[8:11], s24 offen offset:0 sc1
buffer_load_dwordx4 a[20:23], v84, s[8:11], s24 offen offset:1024 sc1
buffer_load_dwordx4 a[24:27], v85, s[8:11], s24 offen offset:0 sc1
buffer_load_dwordx4 a[28:31], v85, s[8:11], s24 offen offset:1024 sc1
s_add_u32 s24, s24, 4096
s_add_u32 s16, s4, 12582912
s_addc_u32 s17, s5, 0
s_mov_b32 s18, 4194304
s_mov_b32 s19, 0x20000
s_add_u32 s28, s4, 20971520
s_addc_u32 s29, s5, 0
s_mov_b32 s30, 131072
s_mov_b32 s31, 0x20000
s_mov_b32 s20, s4
s_mov_b32 s21, s5
s_mov_b32 s22, 4194304
s_mov_b32 s23, 0x20000
B2_go:
s_lshl_b32 s40, s39, 15
s_lshl_b32 s36, s34, 12
s_add_u32 s40, s40, s36
v_lshlrev_b32 v92, 4, v1
v_add_u32 v93, 0x8000, v92
s_waitcnt vmcnt(4)
s_barrier
TR 96,64,0
TR 98,64,4096
TR 100,64,8192
TR 102,64,12288
TR 104,65,0
TR 106,65,4096
TR 108,65,8192
TR 110,65,12288
TR 112,66,0
TR 114,66,4096
TR 116,66,8192
TR 118,66,12288
TR 120,67,0
TR 122,67,4096
TR 124,67,8192
TR 126,67,12288
WL 12
Zvva 160,96,0
TR 128,68,0
s_add_u32 m0, s27, 49152
Mvva 160,100,4
TR 130,68,4096
DM 80,12,25,0
Zvva 164,96,8
TR 132,68,8192
DM 81,12,25,1024
Mvva 164,100,12
TR 134,68,12288
WL 12
Zvva 168,104,0
TR 136,69,0
DM 82,12,25,2048
Mvva 168,108,4
TR 138,69,4096
DM 83,12,25,3072
Zvva 172,104,8
TR 140,69,8192
s_add_u32 s25, s25, 262144
Mvva 172,108,12
TR 142,69,12288
WL 12
Zvva 176,112,0
TR 144,70,0
buffer_load_dwordx4 a[32:35], v84, s[8:11], s24 offen offset:0 sc1
Mvva 176,116,4
TR 146,70,4096
buffer_load_dwordx4 a[36:39], v84, s[8:11], s24 offen offset:1024 sc1
Zvva 180,112,8
TR 148,70,8192
buffer_load_dwordx4 a[40:43], v85, s[8:11], s24 offen offset:0 sc1
Mvva 180,116,12
TR 150,70,12288
WL 12
Zvva 184,120,0
TR 152,71,0
buffer_load_dwordx4 a[44:47], v85, s[8:11], s24 offen offset:1024 sc1
Mvva 184,124,4
TR 154,71,4096
s_add_u32 s24, s24, 4096
Zvva 188,120,8
TR 156,71,8192
Mvva 188,124,12
TR 158,71,12288
WL 12
s_waitcnt vmcnt(8)
s_barrier
s_cmp_lg_u32 s3, 0
s_cbranch_scc1 B1_sg1
s_mov_b64 exec, 1
v_mov_b32 v3, 1
buffer_atomic_add v3, off, s[44:47], s62 sc1
s_mov_b64 exec, -1
B1_sg1:
Zvva 192,128,0
TR 96,64,16384
s_add_u32 m0, s27, 65536
Mvva 192,132,4
TR 98,64,20480
Zvva 196,128,8
TR 100,64,24576
DM 80,12,25,0
Mvva 196,132,12
TR 102,64,28672
WL 12
Zvva 200,136,0
TR 104,65,16384
Mvva 200,140,4
TR 106,65,20480
DM 81,12,25,1024
Zvva 204,136,8
TR 108,65,24576
Mvva 204,140,12
TR 110,65,28672
WL 12
Zvva 208,144,0
TR 112,66,16384
DM 82,12,25,2048
Mvva 208,148,4
TR 114,66,20480
Zvva 212,144,8
TR 116,66,24576
DM 83,12,25,3072
Mvva 212,148,12
TR 118,66,28672
WL 12
Zvva 216,152,0
TR 120,67,16384
Mvva 216,156,4
TR 122,67,20480
s_add_u32 s25, s25, 262144
Zvva 220,152,8
TR 124,67,24576
Mvva 220,156,12
TR 126,67,28672
WL 12
Mvva 160,96,16
TR 128,68,16384
Mvva 160,100,20
TR 130,68,20480
buffer_load_dwordx4 a[48:51], v84, s[8:11], s24 offen offset:0 sc1
Mvva 164,96,24
TR 132,68,24576
Mvva 164,100,28
TR 134,68,28672
WL 12
Mvva 168,104,16
TR 136,69,16384
buffer_load_dwordx4 a[52:55], v84, s[8:11], s24 offen offset:1024 sc1
Mvva 168,108,20
TR 138,69,20480
Mvva 172,104,24
TR 140,69,24576
buffer_load_dwordx4 a[56:59], v85, s[8:11], s24 offen offset:0 sc1
Mvva 172,108,28
TR 142,69,28672
WL 12
Mvva 176,112,16
TR 144,70,16384
Mvva 176,116,20
TR 146,70,20480
buffer_load_dwordx4 a[60:63], v85, s[8:11], s24 offen offset:1024 sc1
Mvva 180,112,24
TR 148,70,24576
Mvva 180,116,28
TR 150,70,28672
WL 12
Mvva 184,120,16
TR 152,71,16384
s_add_u32 s24, s24, 4096
Mvva 184,124,20
TR 154,71,20480
Mvva 188,120,24
TR 156,71,24576
Mvva 188,124,28
TR 158,71,28672
WL 12
s_waitcnt vmcnt(8)
s_barrier
Mvva 192,128,16
TR 96,64,32768
s_add_u32 m0, s27, 81920
Mvva 192,132,20
TR 98,64,36864
Mvva 196,128,24
TR 100,64,40960
DM 80,12,25,0
Mvva 196,132,28
TR 102,64,45056
WL 12
Mvva 200,136,16
TR 104,65,32768
Mvva 200,140,20
TR 106,65,36864
DM 81,12,25,1024
Mvva 204,136,24
TR 108,65,40960
Mvva 204,140,28
TR 110,65,45056
WL 12
Mvva 208,144,16
TR 112,66,32768
DM 82,12,25,2048
Mvva 208,148,20
TR 114,66,36864
Mvva 212,144,24
TR 116,66,40960
DM 83,12,25,3072
Mvva 212,148,28
TR 118,66,45056
WL 12
Mvva 216,152,16
TR 120,67,32768
Mvva 216,156,20
TR 122,67,36864
s_add_u32 s25, s25, 262144
Mvva 220,152,24
TR 124,67,40960
Mvva 220,156,28
TR 126,67,45056
WL 12
Mvva 160,96,32
TR 128,68,32768
Mvva 160,100,36
TR 130,68,36864
buffer_load_dwordx4 a[64:67], v84, s[8:11], s24 offen offset:0 sc1
Mvva 164,96,40
TR 132,68,40960
Mvva 164,100,44
TR 134,68,45056
WL 12
Mvva 168,104,32
TR 136,69,32768
buffer_load_dwordx4 a[68:71], v84, s[8:11], s24 offen offset:1024 sc1
Mvva 168,108,36
TR 138,69,36864
Mvva 172,104,40
TR 140,69,40960
buffer_load_dwordx4 a[72:75], v85, s[8:11], s24 offen offset:0 sc1
Mvva 172,108,44
TR 142,69,45056
WL 12
Mvva 176,112,32
TR 144,70,32768
Mvva 176,116,36
TR 146,70,36864
buffer_load_dwordx4 a[76:79], v85, s[8:11], s24 offen offset:1024 sc1
Mvva 180,112,40
TR 148,70,40960
Mvva 180,116,44
TR 150,70,45056
WL 12
Mvva 184,120,32
TR 152,71,32768
s_add_u32 s24, s24, 4096
Mvva 184,124,36
TR 154,71,36864
Mvva 188,120,40
TR 156,71,40960
Mvva 188,124,44
TR 158,71,45056
WL 12
s_waitcnt vmcnt(8)
s_barrier
Mvva 192,128,32
TR 96,64,49152
s_add_u32 m0, s27, 98304
Mvva 192,132,36
TR 98,64,53248
Mvva 196,128,40
TR 100,64,57344
DM 80,12,25,0
Mvva 196,132,44
TR 102,64,61440
WL 12
Mvva 200,136,32
TR 104,65,49152
Mvva 200,140,36
TR 106,65,53248
DM 81,12,25,1024
Mvva 204,136,40
TR 108,65,57344
Mvva 204,140,44
TR 110,65,61440
WL 12
Mvva 208,144,32
TR 112,66,49152
DM 82,12,25,2048
Mvva 208,148,36
TR 114,66,53248
Mvva 212,144,40
TR 116,66,57344
DM 83,12,25,3072
Mvva 212,148,44
TR 118,66,61440
WL 12
Mvva 216,152,32
TR 120,67,49152
Mvva 216,156,36
TR 122,67,53248
s_add_u32 s25, s25, 262144
Mvva 220,152,40
TR 124,67,57344
Mvva 220,156,44
TR 126,67,61440
WL 12
Mvva 160,96,48
TR 128,68,49152
Mvva 160,100,52
TR 130,68,53248
buffer_load_dwordx4 a[80:83], v84, s[8:11], s24 offen offset:0 sc1
Mvva 164,96,56
TR 132,68,57344
Mvva 164,100,60
TR 134,68,61440
WL 12
Mvva 168,104,48
TR 136,69,49152
buffer_load_dwordx4 a[84:87], v84, s[8:11], s24 offen offset:1024 sc1
Mvva 168,108,52
TR 138,69,53248
Mvva 172,104,56
TR 140,69,57344
buffer_load_dwordx4 a[88:91], v85, s[8:11], s24 offen offset:0 sc1
Mvva 172,108,60
TR 142,69,61440
WL 12
Mvva 176,112,48
TR 144,70,49152
Mvva 176,116,52
TR 146,70,53248
buffer_load_dwordx4 a[92:95], v85, s[8:11], s24 offen offset:1024 sc1
Mvva 180,112,56
TR 148,70,57344
Mvva 180,116,60
TR 150,70,61440
WL 12
Mvva 184,120,48
TR 152,71,49152
s_add_u32 s24, s24, 4096
Mvva 184,124,52
TR 154,71,53248
Mvva 188,120,56
TR 156,71,57344
Mvva 188,124,60
TR 158,71,61440
WL 12
s_waitcnt vmcnt(8)
s_barrier
Mvva 192,128,48
TR 96,72,0
s_add_u32 m0, s27, 114688
Mvva 192,132,52
TR 98,72,4096
Mvva 196,128,56
TR 100,72,8192
DM 80,12,25,0
Mvva 196,132,60
TR 102,72,12288
WL 12
Mvva 200,136,48
TR 104,73,0
Mvva 200,140,52
TR 106,73,4096
DM 81,12,25,1024
Mvva 204,136,56
TR 108,73,8192
Mvva 204,140,60
TR 110,73,12288
WL 12
Mvva 208,144,48
TR 112,74,0
DM 82,12,25,2048
Mvva 208,148,52
TR 114,74,4096
Mvva 212,144,56
TR 116,74,8192
DM 83,12,25,3072
Mvva 212,148,60
TR 118,74,12288
WL 12
Mvva 216,152,48
TR 120,75,0
Mvva 216,156,52
TR 122,75,4096
s_sub_u32 s25, s25, 1703936
Mvva 220,152,56
TR 124,75,8192
Mvva 220,156,60
TR 126,75,12288
WL 12
Mvva 160,96,64
TR 128,76,0
Mvva 160,100,68
TR 130,76,4096
buffer_load_dwordx4 a[96:99], v84, s[8:11], s24 offen offset:0 sc1
Mvva 164,96,72
TR 132,76,8192
Mvva 164,100,76
TR 134,76,12288
WL 12
Mvva 168,104,64
TR 136,77,0
buffer_load_dwordx4 a[100:103], v84, s[8:11], s24 offen offset:1024 sc1
Mvva 168,108,68
TR 138,77,4096
Mvva 172,104,72
TR 140,77,8192
buffer_load_dwordx4 a[104:107], v85, s[8:11], s24 offen offset:0 sc1
Mvva 172,108,76
TR 142,77,12288
WL 12
Mvva 176,112,64
TR 144,78,0
Mvva 176,116,68
TR 146,78,4096
buffer_load_dwordx4 a[108:111], v85, s[8:11], s24 offen offset:1024 sc1
Mvva 180,112,72
TR 148,78,8192
Mvva 180,116,76
TR 150,78,12288
WL 12
Mvva 184,120,64
TR 152,79,0
s_add_u32 s24, s24, 4096
Mvva 184,124,68
TR 154,79,4096
Mvva 188,120,72
TR 156,79,8192
Mvva 188,124,76
TR 158,79,12288
WL 12
s_waitcnt vmcnt(8)
s_barrier
Mvva 192,128,64
TR 96,72,16384
s_add_u32 m0, s27, 0
Mvva 192,132,68
TR 98,72,20480
Mvva 196,128,72
TR 100,72,24576
DM 80,12,25,0
Mvva 196,132,76
TR 102,72,28672
WL 12
Mvva 200,136,64
TR 104,73,16384
Mvva 200,140,68
TR 106,73,20480
DM 81,12,25,1024
Mvva 204,136,72
TR 108,73,24576
Mvva 204,140,76
TR 110,73,28672
WL 12
Mvva 208,144,64
TR 112,74,16384
DM 82,12,25,2048
Mvva 208,148,68
TR 114,74,20480
Mvva 212,144,72
TR 116,74,24576
DM 83,12,25,3072
Mvva 212,148,76
TR 118,74,28672
WL 12
Mvva 216,152,64
TR 120,75,16384
Mvva 216,156,68
TR 122,75,20480
s_add_u32 s25, s25, 262144
Mvva 220,152,72
TR 124,75,24576
Mvva 220,156,76
TR 126,75,28672
WL 12
Mvva 160,96,80
TR 128,76,16384
buffer_load_dwordx4 a[112:115], v84, s[8:11], s24 offen offset:0 sc1
Mvva 160,100,84
TR 130,76,20480
Mvva 164,96,88
TR 132,76,24576
buffer_load_dwordx4 a[116:119], v84, s[8:11], s24 offen offset:1024 sc1
Mvva 164,100,92
TR 134,76,28672
WL 12
Mvva 168,104,80
TR 136,77,16384
Mvva 168,108,84
TR 138,77,20480
buffer_load_dwordx4 a[120:123], v85, s[8:11], s24 offen offset:0 sc1
Mvva 172,104,88
TR 140,77,24576
Mvva 172,108,92
TR 142,77,28672
WL 12
Mvva 176,112,80
TR 144,78,16384
buffer_load_dwordx4 a[124:127], v85, s[8:11], s24 offen offset:1024 sc1
Mvva 176,116,84
TR 146,78,20480
Mvva 180,112,88
TR 148,78,24576
s_sub_u32 s24, s24, 26624
Mvva 180,116,92
TR 150,78,28672
WL 12
Mvva 184,120,80
TR 152,79,16384
Mvva 184,124,84
TR 154,79,20480
buffer_load_dword v61, v60, s[44:47], s42 offen sc1
Mvva 188,120,88
TR 156,79,24576
Mvva 188,124,92
TR 158,79,28672
WL 12
s_waitcnt vmcnt(0)
s_barrier
v_cmp_ne_u32 vcc, 8, v61
s_nop 1
s_cbranch_vccnz B2_h1_w
B2_h1_k:
Mvva 192,128,80
TR 96,72,32768
s_add_u32 m0, s27, 16384
Mvva 192,132,84
TR 98,72,36864
Mvva 196,128,88
TR 100,72,40960
DM 80,12,25,0
Mvva 196,132,92
TR 102,72,45056
WL 12
Mvva 200,136,80
TR 104,73,32768
Mvva 200,140,84
TR 106,73,36864
DM 81,12,25,1024
Mvva 204,136,88
TR 108,73,40960
Mvva 204,140,92
TR 110,73,45056
WL 12
Mvva 208,144,80
TR 112,74,32768
DM 82,12,25,2048
Mvva 208,148,84
TR 114,74,36864
Mvva 212,144,88
TR 116,74,40960
DM 83,12,25,3072
Mvva 212,148,92
TR 118,74,45056
WL 12
Mvva 216,152,80
TR 120,75,32768
Mvva 216,156,84
TR 122,75,36864
s_add_u32 s25, s25, 262144
Mvva 220,152,88
TR 124,75,40960
Mvva 220,156,92
TR 126,75,45056
WL 12
Mvva 160,96,96
TR 128,76,32768
Mvva 160,100,100
TR 130,76,36864
buffer_load_dwordx4 a[0:3], v84, s[8:11], s24 offen offset:0 sc1
Mvva 164,96,104
TR 132,76,40960
Mvva 164,100,108
TR 134,76,45056
WL 12
Mvva 168,104,96
TR 136,77,32768
buffer_load_dwordx4 a[4:7], v84, s[8:11], s24 offen offset:1024 sc1
Mvva 168,108,100
TR 138,77,36864
Mvva 172,104,104
TR 140,77,40960
buffer_load_dwordx4 a[8:11], v85, s[8:11], s24 offen offset:0 sc1
Mvva 172,108,108
TR 142,77,45056
WL 12
Mvva 176,112,96
TR 144,78,32768
Mvva 176,116,100
TR 146,78,36864
buffer_load_dwordx4 a[12:15], v85, s[8:11], s24 offen offset:1024 sc1
Mvva 180,112,104
TR 148,78,40960
Mvva 180,116,108
TR 150,78,45056
WL 12
Mvva 184,120,96
TR 152,79,32768
s_add_u32 s24, s24, 4096
Mvva 184,124,100
TR 154,79,36864
Mvva 188,120,104
TR 156,79,40960
Mvva 188,124,108
TR 158,79,45056
WL 12
s_waitcnt vmcnt(8)
s_barrier
Mvva 192,128,96
TR 96,72,49152
s_add_u32 m0, s27, 32768
Mvva 192,132,100
TR 98,72,53248
Mvva 196,128,104
TR 100,72,57344
DM 80,12,25,0
Mvva 196,132,108
TR 102,72,61440
WL 12
Mvva 200,136,96
TR 104,73,49152
Mvva 200,140,100
TR 106,73,53248
DM 81,12,25,1024
Mvva 204,136,104
TR 108,73,57344
Mvva 204,140,108
TR 110,73,61440
WL 12
Mvva 208,144,96
TR 112,74,49152
DM 82,12,25,2048
Mvva 208,148,100
TR 114,74,53248
Mvva 212,144,104
TR 116,74,57344
DM 83,12,25,3072
Mvva 212,148,108
TR 118,74,61440
WL 12
Mvva 216,152,96
TR 120,75,49152
Mvva 216,156,100
TR 122,75,53248
s_add_u32 s25, s25, 262144
Mvva 220,152,104
TR 124,75,57344
Mvva 220,156,108
TR 126,75,61440
WL 12
Mvva 160,96,112
TR 128,76,49152
Mvva 160,100,116
TR 130,76,53248
buffer_load_dwordx4 a[16:19], v84, s[8:11], s24 offen offset:0 sc1
Mvva 164,96,120
TR 132,76,57344
Mvva 164,100,124
TR 134,76,61440
WL 12
Mvva 168,104,112
TR 136,77,49152
buffer_load_dwordx4 a[20:23], v84, s[8:11], s24 offen offset:1024 sc1
Mvva 168,108,116
TR 138,77,53248
Mvva 172,104,120
TR 140,77,57344
buffer_load_dwordx4 a[24:27], v85, s[8:11], s24 offen offset:0 sc1
Mvva 172,108,124
TR 142,77,61440
WL 12
Mvva 176,112,112
TR 144,78,49152
Mvva 176,116,116
TR 146,78,53248
buffer_load_dwordx4 a[28:31], v85, s[8:11], s24 offen offset:1024 sc1
Mvva 180,112,120
TR 148,78,57344
Mvva 180,116,124
TR 150,78,61440
WL 12
Mvva 184,120,112
TR 152,79,49152
s_add_u32 s24, s24, 4096
Mvva 184,124,116
TR 154,79,53248
Mvva 188,120,120
TR 156,79,57344
Mvva 188,124,124
TR 158,79,61440
WL 12
s_waitcnt vmcnt(8)
s_barrier
Mvva 192,128,112
TR 96,64,0
s_add_u32 m0, s27, 49152
Mvva 192,132,116
TR 98,64,4096
Mvva 196,128,120
TR 100,64,8192
DM 80,12,25,0
Mvva 196,132,124
TR 102,64,12288
WL 12
Mvva 200,136,112
TR 104,65,0
Mvva 200,140,116
TR 106,65,4096
DM 81,12,25,1024
Mvva 204,136,120
TR 108,65,8192
Mvva 204,140,124
TR 110,65,12288
WL 12
Mvva 208,144,112
TR 112,66,0
DM 82,12,25,2048
Mvva 208,148,116
TR 114,66,4096
Mvva 212,144,120
TR 116,66,8192
DM 83,12,25,3072
Mvva 212,148,124
TR 118,66,12288
WL 12
Mvva 216,152,112
TR 120,67,0
Mvva 216,156,116
TR 122,67,4096
s_add_u32 s25, s25, 262144
Mvva 220,152,120
TR 124,67,8192
Mvva 220,156,124
TR 126,67,12288
WL 12
Mvva 160,96,0
TR 128,68,0
Mvva 160,100,4
TR 130,68,4096
buffer_load_dwordx4 a[32:35], v84, s[8:11], s24 offen offset:0 sc1
Mvva 164,96,8
TR 132,68,8192
Mvva 164,100,12
TR 134,68,12288
WL 12
Mvva 168,104,0
TR 136,69,0
buffer_load_dwordx4 a[36:39], v84, s[8:11], s24 offen offset:1024 sc1
Mvva 168,108,4
TR 138,69,4096
Mvva 172,104,8
TR 140,69,8192
buffer_load_dwordx4 a[40:43], v85, s[8:11], s24 offen offset:0 sc1
Mvva 172,108,12
TR 142,69,12288
WL 12
Mvva 176,112,0
TR 144,70,0
Mvva 176,116,4
TR 146,70,4096
buffer_load_dwordx4 a[44:47], v85, s[8:11], s24 offen offset:1024 sc1
Mvva 180,112,8
TR 148,70,8192
Mvva 180,116,12
TR 150,70,12288
WL 12
Mvva 184,120,0
TR 152,71,0
s_add_u32 s24, s24, 4096
Mvva 184,124,4
TR 154,71,4096
Mvva 188,120,8
TR 156,71,8192
Mvva 188,124,12
TR 158,71,12288
WL 12
s_waitcnt vmcnt(8)
s_barrier
Mvva 192,128,0
TR 96,64,16384
s_add_u32 m0, s27, 65536
Mvva 192,132,4
TR 98,64,20480
Mvva 196,128,8
TR 100,64,24576
DM 80,12,25,0
Mvva 196,132,12
TR 102,64,28672
WL 12
Mvva 200,136,0
TR 104,65,16384
Mvva 200,140,4
TR 106,65,20480
DM 81,12,25,1024
Mvva 204,136,8
TR 108,65,24576
Mvva 204,140,12
TR 110,65,28672
WL 12
Mvva 208,144,0
TR 112,66,16384
DM 82,12,25,2048
Mvva 208,148,4
TR 114,66,20480
Mvva 212,144,8
TR 116,66,24576
DM 83,12,25,3072
Mvva 212,148,12
TR 118,66,28672
WL 12
Mvva 216,152,0
TR 120,67,16384
Mvva 216,156,4
TR 122,67,20480
s_add_u32 s25, s25, 262144
Mvva 220,152,8
TR 124,67,24576
Mvva 220,156,12
TR 126,67,28672
WL 12
Mvva 160,96,16
TR 128,68,16384
Mvva 160,100,20
TR 130,68,20480
buffer_load_dwordx4 a[48:51], v84, s[8:11], s24 offen offset:0 sc1
Mvva 164,96,24
TR 132,68,24576
Mvva 164,100,28
TR 134,68,28672
WL 12
Mvva 168,104,16
TR 136,69,16384
buffer_load_dwordx4 a[52:55], v84, s[8:11], s24 offen offset:1024 sc1
Mvva 168,108,20
TR 138,69,20480
Mvva 172,104,24
TR 140,69,24576
buffer_load_dwordx4 a[56:59], v85, s[8:11], s24 offen offset:0 sc1
Mvva 172,108,28
TR 142,69,28672
WL 12
Mvva 176,112,16
TR 144,70,16384
Mvva 176,116,20
TR 146,70,20480
buffer_load_dwordx4 a[60:63], v85, s[8:11], s24 offen offset:1024 sc1
Mvva 180,112,24
TR 148,70,24576
Mvva 180,116,28
TR 150,70,28672
WL 12
Mvva 184,120,16
TR 152,71,16384
s_add_u32 s24, s24, 4096
Mvva 184,124,20
TR 154,71,20480
Mvva 188,120,24
TR 156,71,24576
Mvva 188,124,28
TR 158,71,28672
WL 12
s_waitcnt vmcnt(8)
s_barrier
Mvva 192,128,16
TR 96,64,32768
s_add_u32 m0, s27, 81920
Mvva 192,132,20
TR 98,64,36864
Mvva 196,128,24
TR 100,64,40960
DM 80,12,25,0
Mvva 196,132,28
TR 102,64,45056
WL 12
Mvva 200,136,16
TR 104,65,32768
Mvva 200,140,20
TR 106,65,36864
DM 81,12,25,1024
Mvva 204,136,24
TR 108,65,40960
Mvva 204,140,28
TR 110,65,45056
WL 12
Mvva 208,144,16
TR 112,66,32768
DM 82,12,25,2048
Mvva 208,148,20
TR 114,66,36864
Mvva 212,144,24
TR 116,66,40960
DM 83,12,25,3072
Mvva 212,148,28
TR 118,66,45056
WL 12
Mvva 216,152,16
TR 120,67,32768
Mvva 216,156,20
TR 122,67,36864
s_add_u32 s25, s25, 262144
Mvva 220,152,24
TR 124,67,40960
Mvva 220,156,28
TR 126,67,45056
WL 12
Mvva 160,96,32
TR 128,68,32768
Mvva 160,100,36
TR 130,68,36864
buffer_load_dwordx4 a[64:67], v84, s[8:11], s24 offen offset:0 sc1
Mvva 164,96,40
TR 132,68,40960
Mvva 164,100,44
TR 134,68,45056
WL 12
Mvva 168,104,32
TR 136,69,32768
buffer_load_dwordx4 a[68:71], v84, s[8:11], s24 offen offset:1024 sc1
Mvva 168,108,36
TR 138,69,36864
Mvva 172,104,40
TR 140,69,40960
buffer_load_dwordx4 a[72:75], v85, s[8:11], s24 offen offset:0 sc1
Mvva 172,108,44
TR 142,69,45056
WL 12
Mvva 176,112,32
TR 144,70,32768
Mvva 176,116,36
TR 146,70,36864
buffer_load_dwordx4 a[76:79], v85, s[8:11], s24 offen offset:1024 sc1
Mvva 180,112,40
TR 148,70,40960
Mvva 180,116,44
TR 150,70,45056
WL 12
Mvva 184,120,32
TR 152,71,32768
s_add_u32 s24, s24, 4096
Mvva 184,124,36
TR 154,71,36864
Mvva 188,120,40
TR 156,71,40960
Mvva 188,124,44
TR 158,71,45056
WL 12
s_waitcnt vmcnt(8)
s_barrier
Mvva 192,128,32
TR 96,64,49152
s_add_u32 m0, s27, 98304
Mvva 192,132,36
TR 98,64,53248
Mvva 196,128,40
TR 100,64,57344
DM 80,12,25,0
Mvva 196,132,44
TR 102,64,61440
WL 12
Mvva 200,136,32
TR 104,65,49152
Mvva 200,140,36
TR 106,65,53248
DM 81,12,25,1024
Mvva 204,136,40
TR 108,65,57344
Mvva 204,140,44
TR 110,65,61440
WL 12
Mvva 208,144,32
TR 112,66,49152
DM 82,12,25,2048
Mvva 208,148,36
TR 114,66,53248
Mvva 212,144,40
TR 116,66,57344
DM 83,12,25,3072
Mvva 212,148,44
TR 118,66,61440
WL 12
Mvva 216,152,32
TR 120,67,49152
Mvva 216,156,36
TR 122,67,53248
s_add_u32 s25, s25, 262144
Mvva 220,152,40
TR 124,67,57344
Mvva 220,156,44
TR 126,67,61440
WL 12
Mvva 160,96,48
TR 128,68,49152
Mvva 160,100,52
TR 130,68,53248
buffer_load_dwordx4 a[80:83], v84, s[8:11], s24 offen offset:0 sc1
Mvva 164,96,56
TR 132,68,57344
Mvva 164,100,60
TR 134,68,61440
WL 12
Mvva 168,104,48
TR 136,69,49152
buffer_load_dwordx4 a[84:87], v84, s[8:11], s24 offen offset:1024 sc1
Mvva 168,108,52
TR 138,69,53248
Mvva 172,104,56
TR 140,69,57344
buffer_load_dwordx4 a[88:91], v85, s[8:11], s24 offen offset:0 sc1
Mvva 172,108,60
TR 142,69,61440
WL 12
Mvva 176,112,48
TR 144,70,49152
Mvva 176,116,52
TR 146,70,53248
buffer_load_dwordx4 a[92:95], v85, s[8:11], s24 offen offset:1024 sc1
Mvva 180,112,56
TR 148,70,57344
Mvva 180,116,60
TR 150,70,61440
WL 12
Mvva 184,120,48
TR 152,71,49152
s_add_u32 s24, s24, 4096
Mvva 184,124,52
TR 154,71,53248
Mvva 188,120,56
TR 156,71,57344
Mvva 188,124,60
TR 158,71,61440
WL 12
s_waitcnt vmcnt(8)
s_barrier
Mvva 192,128,48
TR 96,72,0
s_add_u32 m0, s27, 114688
Mvva 192,132,52
TR 98,72,4096
Mvva 196,128,56
TR 100,72,8192
DM 80,12,25,0
Mvva 196,132,60
TR 102,72,12288
WL 12
Mvva 200,136,48
TR 104,73,0
Mvva 200,140,52
TR 106,73,4096
DM 81,12,25,1024
Mvva 204,136,56
TR 108,73,8192
Mvva 204,140,60
TR 110,73,12288
WL 12
Mvva 208,144,48
TR 112,74,0
DM 82,12,25,2048
Mvva 208,148,52
TR 114,74,4096
Mvva 212,144,56
TR 116,74,8192
DM 83,12,25,3072
Mvva 212,148,60
TR 118,74,12288
WL 12
Mvva 216,152,48
TR 120,75,0
Mvva 216,156,52
TR 122,75,4096
s_add_u32 s25, s25, 262144
Mvva 220,152,56
TR 124,75,8192
Mvva 220,156,60
TR 126,75,12288
WL 12
Mvva 160,96,64
TR 128,76,0
Mvva 160,100,68
TR 130,76,4096
buffer_load_dwordx4 a[96:99], v84, s[8:11], s24 offen offset:0 sc1
Mvva 164,96,72
TR 132,76,8192
Mvva 164,100,76
TR 134,76,12288
WL 12
Mvva 168,104,64
TR 136,77,0
buffer_load_dwordx4 a[100:103], v84, s[8:11], s24 offen offset:1024 sc1
Mvva 168,108,68
TR 138,77,4096
Mvva 172,104,72
TR 140,77,8192
buffer_load_dwordx4 a[104:107], v85, s[8:11], s24 offen offset:0 sc1
Mvva 172,108,76
TR 142,77,12288
WL 12
Mvva 176,112,64
TR 144,78,0
Mvva 176,116,68
TR 146,78,4096
buffer_load_dwordx4 a[108:111], v85, s[8:11], s24 offen offset:1024 sc1
Mvva 180,112,72
TR 148,78,8192
Mvva 180,116,76
TR 150,78,12288
WL 12
Mvva 184,120,64
TR 152,79,0
s_add_u32 s24, s24, 4096
Mvva 184,124,68
TR 154,79,4096
Mvva 188,120,72
TR 156,79,8192
Mvva 188,124,76
TR 158,79,12288
WL 12
s_waitcnt vmcnt(8)
s_barrier
Mvva 192,128,64
TR 96,72,16384
buffer_load_dwordx4 a[112:115], v84, s[8:11], s24 offen offset:0 sc1
Mvva 192,132,68
TR 98,72,20480
buffer_load_dwordx4 a[116:119], v84, s[8:11], s24 offen offset:1024 sc1
Mvva 196,128,72
TR 100,72,24576
Mvva 196,132,76
TR 102,72,28672
WL 12
Mvva 200,136,64
TR 104,73,16384
buffer_load_dwordx4 a[120:123], v85, s[8:11], s24 offen offset:0 sc1
Mvva 200,140,68
TR 106,73,20480
Mvva 204,136,72
TR 108,73,24576
buffer_load_dwordx4 a[124:127], v85, s[8:11], s24 offen offset:1024 sc1
Mvva 204,140,76
TR 110,73,28672
WL 12
Mvva 208,144,64
TR 112,74,16384
Mvva 208,148,68
TR 114,74,20480
s_add_u32 s24, s24, 4096
Mvva 212,144,72
TR 116,74,24576
Mvva 212,148,76
TR 118,74,28672
WL 12
Mvva 216,152,64
TR 120,75,16384
buffer_load_dwordx4 v[8:11], v92, s[20:23], s40 offen offset:0 sc1
Mvva 216,156,68
TR 122,75,20480
Mvva 220,152,72
TR 124,75,24576
buffer_load_dwordx4 v[12:15], v93, s[20:23], s40 offen offset:0 sc1
Mvva 220,156,76
TR 126,75,28672
WL 12
Mvva 160,96,80
TR 128,76,16384
buffer_load_dwordx4 v[16:19], v92, s[20:23], s40 offen offset:1024 sc1
Mvva 160,100,84
TR 130,76,20480
Mvva 164,96,88
TR 132,76,24576
buffer_load_dwordx4 v[20:23], v93, s[20:23], s40 offen offset:1024 sc1
Mvva 164,100,92
TR 134,76,28672
WL 12
Mvva 168,104,80
TR 136,77,16384
Mvva 168,108,84
TR 138,77,20480
buffer_load_dwordx4 v[24:27], v92, s[20:23], s40 offen offset:2048 sc1
Mvva 172,104,88
TR 140,77,24576
Mvva 172,108,92
TR 142,77,28672
WL 12
Mvva 176,112,80
TR 144,78,16384
buffer_load_dwordx4 v[28:31], v93, s[20:23], s40 offen offset:2048 sc1
Mvva 176,116,84
TR 146,78,20480
Mvva 180,112,88
TR 148,78,24576
buffer_load_dwordx4 v[32:35], v92, s[20:23], s40 offen offset:3072 sc1
Mvva 180,116,92
TR 150,78,28672
WL 12
Mvva 184,120,80
TR 152,79,16384
Mvva 184,124,84
TR 154,79,20480
buffer_load_dwordx4 v[36:39], v93, s[20:23], s40 offen offset:3072 sc1
Mvva 188,120,88
TR 156,79,24576
Mvva 188,124,92
TR 158,79,28672
WL 12
s_waitcnt vmcnt(12)
s_barrier
Mvva 192,128,80
TR 96,72,32768
Mvva 192,132,84
TR 98,72,36864
Mvva 196,128,88
TR 100,72,40960
Mvva 196,132,92
TR 102,72,45056
WL 12
Mvva 200,136,80
TR 104,73,32768
Mvva 200,140,84
TR 106,73,36864
Mvva 204,136,88
TR 108,73,40960
Mvva 204,140,92
TR 110,73,45056
WL 12
Mvva 208,144,80
TR 112,74,32768
Mvva 208,148,84
TR 114,74,36864
Mvva 212,144,88
TR 116,74,40960
Mvva 212,148,92
TR 118,74,45056
WL 12
Mvva 216,152,80
TR 120,75,32768
Mvva 216,156,84
TR 122,75,36864
Mvva 220,152,88
TR 124,75,40960
Mvva 220,156,92
TR 126,75,45056
WL 12
Mvva 160,96,96
TR 128,76,32768
Mvva 160,100,100
TR 130,76,36864
Mvva 164,96,104
TR 132,76,40960
Mvva 164,100,108
TR 134,76,45056
WL 12
Mvva 168,104,96
TR 136,77,32768
Mvva 168,108,100
TR 138,77,36864
Mvva 172,104,104
TR 140,77,40960
Mvva 172,108,108
TR 142,77,45056
WL 12
Mvva 176,112,96
TR 144,78,32768
Mvva 176,116,100
TR 146,78,36864
Mvva 180,112,104
TR 148,78,40960
Mvva 180,116,108
TR 150,78,45056
WL 12
Mvva 184,120,96
TR 152,79,32768
Mvva 184,124,100
TR 154,79,36864
Mvva 188,120,104
TR 156,79,40960
Mvva 188,124,108
TR 158,79,45056
WL 12
s_waitcnt vmcnt(8)
s_barrier
Mvva 192,128,96
TR 96,72,49152
Mvva 192,132,100
TR 98,72,53248
Mvva 196,128,104
TR 100,72,57344
Mvva 196,132,108
TR 102,72,61440
WL 12
Mvva 200,136,96
TR 104,73,49152
Mvva 200,140,100
TR 106,73,53248
Mvva 204,136,104
TR 108,73,57344
Mvva 204,140,108
TR 110,73,61440
WL 12
Mvva 208,144,96
TR 112,74,49152
Mvva 208,148,100
TR 114,74,53248
Mvva 212,144,104
TR 116,74,57344
Mvva 212,148,108
TR 118,74,61440
WL 12
Mvva 216,152,96
TR 120,75,49152
Mvva 216,156,100
TR 122,75,53248
Mvva 220,152,104
TR 124,75,57344
Mvva 220,156,108
TR 126,75,61440
WL 12
Mvva 160,96,112
TR 128,76,49152
Mvva 160,100,116
TR 130,76,53248
Mvva 164,96,120
TR 132,76,57344
Mvva 164,100,124
TR 134,76,61440
WL 12
Mvva 168,104,112
TR 136,77,49152
Mvva 168,108,116
TR 138,77,53248
Mvva 172,104,120
TR 140,77,57344
Mvva 172,108,124
TR 142,77,61440
WL 12
Mvva 176,112,112
TR 144,78,49152
Mvva 176,116,116
TR 146,78,53248
Mvva 180,112,120
TR 148,78,57344
Mvva 180,116,124
TR 150,78,61440
WL 12
Mvva 184,120,112
TR 152,79,49152
Mvva 184,124,116
TR 154,79,53248
Mvva 188,120,120
TR 156,79,57344
Mvva 188,124,124
TR 158,79,61440
WL 12
Mvva 192,128,112
Mvva 192,132,116
Mvva 196,128,120
Mvva 196,132,124
WL 8
Mvva 200,136,112
Mvva 200,140,116
Mvva 204,136,120
Mvva 204,140,124
WL 4
Mvva 208,144,112
Mvva 208,148,116
Mvva 212,144,120
Mvva 212,148,124
WL 0
Mvva 216,152,112
Mvva 216,156,116
Mvva 220,152,120
Mvva 220,156,124
s_barrier
s_mov_b32 s12, s52
s_mov_b32 s13, s53
s_mov_b32 s14, 7340032
s_mov_b32 s15, 0x20000
v_lshrrev_b32 v248, 4, v1
s_lshl_b32 s36, s3, 4
v_add_u32 v249, s36, v248
v_mul_u32_u24 v249, 7168, v249
v_and_b32 v250, 15, v1
v_add_u32 v251, 0, v248
v_lshlrev_b32 v251, 1, v251
v_xor_b32 v251, v251, v250
v_cmp_gt_u32 vcc, 12, v251
v_lshl_add_u32 v251, v251, 4, v249
v_add_u32 v240, 0, v251
v_mov_b32 v244, 0x40000000
v_cndmask_b32 v244, v244, v240, vcc
v_add_u32 v251, 4, v248
v_lshlrev_b32 v251, 1, v251
v_xor_b32 v251, v251, v250
v_cmp_gt_u32 vcc, 12, v251
v_lshl_add_u32 v251, v251, 4, v249
v_add_u32 v241, 27648, v251
v_mov_b32 v245, 0x40000000
v_cndmask_b32 v245, v245, v241, vcc
v_add_u32 v251, 0, v248
v_lshlrev_b32 v251, 1, v251
v_xor_b32 v251, v251, v250
v_cmp_gt_u32 vcc, 12, v251
v_lshl_add_u32 v251, v251, 4, v249
v_add_u32 v242, 55296, v251
v_mov_b32 v246, 0x40000000
v_cndmask_b32 v246, v246, v242, vcc
v_add_u32 v251, 4, v248
v_lshlrev_b32 v251, 1, v251
v_xor_b32 v251, v251, v250
v_cmp_gt_u32 vcc, 12, v251
v_lshl_add_u32 v251, v251, 4, v249
v_add_u32 v243, 82944, v251
v_mov_b32 v247, 0x40000000
v_cndmask_b32 v247, v247, v243, vcc
s_mul_i32 s25, s51, 448
s_lshl_b32 s27, s3, 12
s_add_u32 s26, s25, 256
v_cmp_le_u32 vcc, 28, v1
s_lshl_b32 s43, s50, 2
s_nop 0
v_cndmask_b32 v2, 0, 1, vcc
v_mul_u32_u24 v3, 28, v2
v_sub_u32 v3, v1, v3
v_lshlrev_b32 v4, 4, v3
v_mul_u32_u24 v5, 7168, v2
v_add_u32 v4, v4, v5
v_cmp_le_u32 vcc, 56, v1
v_mov_b32 v5, 0x40000000
s_add_u32 s43, s43, s3
v_cndmask_b32 v4, v4, v5, vcc
s_mul_i32 s43, s43, 229376
s_mul_i32 s37, s51, 448
s_add_u32 s43, s43, s37
s_waitcnt vmcnt(0)
v_mov_b32 v6, 0x40faf233
v_mov_b32 v7, 0x40faf233
s_nop 5
v_lshlrev_b32 v40, 16, v8
v_and_b32 v41, 0xffff0000, v8
v_lshlrev_b32 v42, 16, v9
v_and_b32 v43, 0xffff0000, v9
v_lshlrev_b32 v44, 16, v10
v_and_b32 v45, 0xffff0000, v10
v_lshlrev_b32 v46, 16, v11
v_and_b32 v47, 0xffff0000, v11
PF 160,40,6,160
PF 162,42,6,162
PF 168,44,6,168
PF 170,46,6,170
CV 48,160,161
CV 49,162,163
CV 50,168,169
CV 51,170,171
buffer_store_dwordx4 v[48:51], v92, s[16:19], s40 offen offset:0 sc1
v_lshlrev_b32 v40, 16, v16
v_and_b32 v41, 0xffff0000, v16
v_lshlrev_b32 v42, 16, v17
v_and_b32 v43, 0xffff0000, v17
v_lshlrev_b32 v44, 16, v18
v_and_b32 v45, 0xffff0000, v18
v_lshlrev_b32 v46, 16, v19
v_and_b32 v47, 0xffff0000, v19
PF 176,40,6,176
PF 178,42,6,178
PF 184,44,6,184
PF 186,46,6,186
CV 52,176,177
CV 53,178,179
CV 54,184,185
CV 55,186,187
buffer_store_dwordx4 v[52:55], v92, s[16:19], s40 offen offset:1024 sc1
v_lshlrev_b32 v40, 16, v24
v_and_b32 v41, 0xffff0000, v24
v_lshlrev_b32 v42, 16, v25
v_and_b32 v43, 0xffff0000, v25
v_lshlrev_b32 v44, 16, v26
v_and_b32 v45, 0xffff0000, v26
v_lshlrev_b32 v46, 16, v27
v_and_b32 v47, 0xffff0000, v27
PF 192,40,6,192
PF 194,42,6,194
PF 200,44,6,200
PF 202,46,6,202
CV 48,192,193
CV 49,194,195
CV 50,200,201
CV 51,202,203
buffer_store_dwordx4 v[48:51], v92, s[16:19], s40 offen offset:2048 sc1
v_lshlrev_b32 v40, 16, v32
v_and_b32 v41, 0xffff0000, v32
v_lshlrev_b32 v42, 16, v33
v_and_b32 v43, 0xffff0000, v33
v_lshlrev_b32 v44, 16, v34
v_and_b32 v45, 0xffff0000, v34
v_lshlrev_b32 v46, 16, v35
v_and_b32 v47, 0xffff0000, v35
PF 208,40,6,208
PF 210,42,6,210
PF 216,44,6,216
PF 218,46,6,218
CV 52,208,209
CV 53,210,211
CV 54,216,217
CV 55,218,219
buffer_store_dwordx4 v[52:55], v92, s[16:19], s40 offen offset:3072 sc1
v_lshlrev_b32 v40, 16, v12
v_and_b32 v41, 0xffff0000, v12
v_lshlrev_b32 v42, 16, v13
v_and_b32 v43, 0xffff0000, v13
v_lshlrev_b32 v44, 16, v14
v_and_b32 v45, 0xffff0000, v14
v_lshlrev_b32 v46, 16, v15
v_and_b32 v47, 0xffff0000, v15
PF 164,40,6,164
PF 166,42,6,166
PF 172,44,6,172
PF 174,46,6,174
CV 48,164,165
CV 49,166,167
CV 50,172,173
CV 51,174,175
buffer_store_dwordx4 v[48:51], v93, s[16:19], s40 offen offset:0 sc1
v_lshlrev_b32 v40, 16, v20
v_and_b32 v41, 0xffff0000, v20
v_lshlrev_b32 v42, 16, v21
v_and_b32 v43, 0xffff0000, v21
v_lshlrev_b32 v44, 16, v22
v_and_b32 v45, 0xffff0000, v22
v_lshlrev_b32 v46, 16, v23
v_and_b32 v47, 0xffff0000, v23
PF 180,40,6,180
PF 182,42,6,182
PF 188,44,6,188
PF 190,46,6,190
CV 52,180,181
CV 53,182,183
CV 54,188,189
CV 55,190,191
buffer_store_dwordx4 v[52:55], v93, s[16:19], s40 offen offset:1024 sc1
v_lshlrev_b32 v40, 16, v28
v_and_b32 v41, 0xffff0000, v28
v_lshlrev_b32 v42, 16, v29
v_and_b32 v43, 0xffff0000, v29
v_lshlrev_b32 v44, 16, v30
v_and_b32 v45, 0xffff0000, v30
v_lshlrev_b32 v46, 16, v31
v_and_b32 v47, 0xffff0000, v31
PF 196,40,6,196
PF 198,42,6,198
PF 204,44,6,204
PF 206,46,6,206
CV 48,196,197
CV 49,198,199
CV 50,204,205
CV 51,206,207
buffer_store_dwordx4 v[48:51], v93, s[16:19], s40 offen offset:2048 sc1
v_lshlrev_b32 v40, 16, v36
v_and_b32 v41, 0xffff0000, v36
v_lshlrev_b32 v42, 16, v37
v_and_b32 v43, 0xffff0000, v37
v_lshlrev_b32 v44, 16, v38
v_and_b32 v45, 0xffff0000, v38
v_lshlrev_b32 v46, 16, v39
v_and_b32 v47, 0xffff0000, v39
PF 212,40,6,212
PF 214,42,6,214
PF 220,44,6,220
PF 222,46,6,222
CV 52,212,213
CV 53,214,215
CV 54,220,221
CV 55,222,223
buffer_store_dwordx4 v[52:55], v93, s[16:19], s40 offen offset:3072 sc1
s_lshl_b32 s41, s33, 7
s_add_u32 s41, s41, 18432
s_waitcnt vmcnt(0)
s_barrier
s_cmp_lg_u32 s3, 0
s_cbranch_scc1 B2_sig
s_mov_b64 exec, 1
v_mov_b32 v3, 1
buffer_atomic_add v3, off, s[44:47], s41 sc1
s_mov_b64 exec, -1
B2_sig:
PA 56,160,162
PA 58,168,170
PA 56,56,176
s_add_u32 m0, s27, 0
PA 58,58,178
PA 56,56,184
DM 240,12,25,0
PA 58,58,186
PA 56,56,192
DM 241,12,25,1024
PA 58,58,194
PA 56,56,200
DM 242,12,25,2048
PA 58,58,202
PA 56,56,208
PA 58,58,210
DM 243,12,25,3072
PA 56,56,216
PA 58,58,218
s_add_u32 s25, s25, 458752
PA 56,56,58
v_add_f32 v56, v56, v57
s_add_u32 m0, s27, 65536
v_mov_b32 v58, v56
s_nop 1
v_permlane16_swap_b32 v58, v56
DM 244,12,26,0
v_add_f32 v56, v56, v58
v_mov_b32 v58, v56
s_nop 1
v_permlane32_swap_b32 v58, v56
DM 245,12,26,1024
v_add_f32 v56, v56, v58
v_mul_f32 v56, 0x3c000000, v56
DM 246,12,26,2048
v_mov_b32 v57, v56
v_pk_add_f32 v[160:161], v[160:161], v[56:57] neg_lo:[0,1] neg_hi:[0,1]
DM 247,12,26,3072
v_pk_add_f32 v[162:163], v[162:163], v[56:57] neg_lo:[0,1] neg_hi:[0,1]
v_pk_add_f32 v[168:169], v[168:169], v[56:57] neg_lo:[0,1] neg_hi:[0,1]
s_add_u32 s26, s26, 458752
v_pk_add_f32 v[170:171], v[170:171], v[56:57] neg_lo:[0,1] neg_hi:[0,1]
v_pk_add_f32 v[176:177], v[176:177], v[56:57] neg_lo:[0,1] neg_hi:[0,1]
v_pk_add_f32 v[178:179], v[178:179], v[56:57] neg_lo:[0,1] neg_hi:[0,1]
s_add_u32 m0, s27, 16384
v_pk_add_f32 v[184:185], v[184:185], v[56:57] neg_lo:[0,1] neg_hi:[0,1]
v_pk_add_f32 v[186:187], v[186:187], v[56:57] neg_lo:[0,1] neg_hi:[0,1]
DM 240,12,25,0
v_pk_add_f32 v[192:193], v[192:193], v[56:57] neg_lo:[0,1] neg_hi:[0,1]
v_pk_add_f32 v[194:195], v[194:195], v[56:57] neg_lo:[0,1] neg_hi:[0,1]
DM 241,12,25,1024
v_pk_add_f32 v[200:201], v[200:201], v[56:57] neg_lo:[0,1] neg_hi:[0,1]
v_pk_add_f32 v[202:203], v[202:203], v[56:57] neg_lo:[0,1] neg_hi:[0,1]
DM 242,12,25,2048
v_pk_add_f32 v[208:209], v[208:209], v[56:57] neg_lo:[0,1] neg_hi:[0,1]
v_pk_add_f32 v[210:211], v[210:211], v[56:57] neg_lo:[0,1] neg_hi:[0,1]
v_pk_add_f32 v[216:217], v[216:217], v[56:57] neg_lo:[0,1] neg_hi:[0,1]
DM 243,12,25,3072
v_pk_add_f32 v[218:219], v[218:219], v[56:57] neg_lo:[0,1] neg_hi:[0,1]
PM 58,160,160
s_add_u32 s25, s25, 458752
PM 60,162,162
PF 58,168,168,58
s_add_u32 m0, s27, 81920
PF 60,170,170,60
PF 58,176,176,58
DM 244,12,26,0
PF 60,178,178,60
PF 58,184,184,58
PF 60,186,186,60
DM 245,12,26,1024
PF 58,192,192,58
PF 60,194,194,60
DM 246,12,26,2048
PF 58,200,200,58
PF 60,202,202,60
DM 247,12,26,3072
PF 58,208,208,58
PF 60,210,210,60
s_add_u32 s26, s26, 458752
PF 58,216,216,58
PF 60,218,218,60
PA 58,58,60
buffer_load_dwordx4 v[96:99], v4, s[12:15], s43 offen
v_add_f32 v57, v58, v59
v_mov_b32 v58, v57
s_add_u32 s43, s43, 14336
s_nop 0
v_permlane16_swap_b32 v58, v57
v_add_f32 v57, v57, v58
buffer_load_dwordx4 v[100:103], v4, s[12:15], s43 offen
v_mov_b32 v58, v57
s_nop 1
v_permlane32_swap_b32 v58, v57
s_add_u32 s43, s43, 14336
v_add_f32 v57, v57, v58
v_and_b32 v58, 15, v1
v_lshlrev_b32 v58, 3, v58
buffer_load_dwordx4 v[104:107], v4, s[12:15], s43 offen
s_lshl_b32 s38, s39, 10
s_lshl_b32 s37, s34, 7
s_add_u32 s43, s43, 14336
s_add_u32 s38, s38, s37
buffer_store_dwordx2 v[56:57], v58, s[28:31], s38 offen offset:0 sc1
buffer_load_dwordx4 v[108:111], v4, s[12:15], s43 offen
PA 56,164,166
PA 58,172,174
s_add_u32 s43, s43, 14336
PA 56,56,180
PA 58,58,182
PA 56,56,188
buffer_load_dwordx4 v[112:115], v4, s[12:15], s43 offen
PA 58,58,190
PA 56,56,196
s_add_u32 s43, s43, 14336
PA 58,58,198
PA 56,56,204
buffer_load_dwordx4 v[116:119], v4, s[12:15], s43 offen
PA 58,58,206
PA 56,56,212
s_add_u32 s43, s43, 14336
PA 58,58,214
PA 56,56,220
PA 58,58,222
buffer_load_dwordx4 v[120:123], v4, s[12:15], s43 offen
PA 56,56,58
v_add_f32 v56, v56, v57
s_add_u32 s43, s43, 14336
v_mov_b32 v58, v56
s_nop 1
v_permlane16_swap_b32 v58, v56
buffer_load_dwordx4 v[124:127], v4, s[12:15], s43 offen
v_add_f32 v56, v56, v58
v_mov_b32 v58, v56
s_add_u32 s43, s43, 14336
s_nop 0
v_permlane32_swap_b32 v58, v56
v_add_f32 v56, v56, v58
v_mul_f32 v56, 0x3c000000, v56
buffer_load_dwordx4 v[128:131], v4, s[12:15], s43 offen
v_mov_b32 v57, v56
v_pk_add_f32 v[164:165], v[164:165], v[56:57] neg_lo:[0,1] neg_hi:[0,1]
s_add_u32 s43, s43, 14336
v_pk_add_f32 v[166:167], v[166:167], v[56:57] neg_lo:[0,1] neg_hi:[0,1]
v_pk_add_f32 v[172:173], v[172:173], v[56:57] neg_lo:[0,1] neg_hi:[0,1]
buffer_load_dwordx4 v[132:135], v4, s[12:15], s43 offen
v_pk_add_f32 v[174:175], v[174:175], v[56:57] neg_lo:[0,1] neg_hi:[0,1]
v_pk_add_f32 v[180:181], v[180:181], v[56:57] neg_lo:[0,1] neg_hi:[0,1]
s_add_u32 s43, s43, 14336
v_pk_add_f32 v[182:183], v[182:183], v[56:57] neg_lo:[0,1] neg_hi:[0,1]
v_pk_add_f32 v[188:189], v[188:189], v[56:57] neg_lo:[0,1] neg_hi:[0,1]
v_pk_add_f32 v[190:191], v[190:191], v[56:57] neg_lo:[0,1] neg_hi:[0,1]
buffer_load_dwordx4 v[136:139], v4, s[12:15], s43 offen
v_pk_add_f32 v[196:197], v[196:197], v[56:57] neg_lo:[0,1] neg_hi:[0,1]
v_pk_add_f32 v[198:199], v[198:199], v[56:57] neg_lo:[0,1] neg_hi:[0,1]
s_add_u32 s43, s43, 14336
v_pk_add_f32 v[204:205], v[204:205], v[56:57] neg_lo:[0,1] neg_hi:[0,1]
v_pk_add_f32 v[206:207], v[206:207], v[56:57] neg_lo:[0,1] neg_hi:[0,1]
buffer_load_dwordx4 v[140:143], v4, s[12:15], s43 offen
v_pk_add_f32 v[212:213], v[212:213], v[56:57] neg_lo:[0,1] neg_hi:[0,1]
v_pk_add_f32 v[214:215], v[214:215], v[56:57] neg_lo:[0,1] neg_hi:[0,1]
s_add_u32 s43, s43, 14336
v_pk_add_f32 v[220:221], v[220:221], v[56:57] neg_lo:[0,1] neg_hi:[0,1]
v_pk_add_f32 v[222:223], v[222:223], v[56:57] neg_lo:[0,1] neg_hi:[0,1]
PM 58,164,164
buffer_load_dwordx4 v[144:147], v4, s[12:15], s43 offen
PM 60,166,166
PF 58,172,172,58
s_add_u32 s43, s43, 14336
PF 60,174,174,60
PF 58,180,180,58
buffer_load_dwordx4 v[148:151], v4, s[12:15], s43 offen
PF 60,182,182,60
PF 58,188,188,58
s_add_u32 s43, s43, 14336
PF 60,190,190,60
PF 58,196,196,58
PF 60,198,198,60
buffer_load_dwordx4 v[152:155], v4, s[12:15], s43 offen
PF 58,204,204,58
PF 60,206,206,60
s_add_u32 s43, s43, 14336
PF 58,212,212,58
PF 60,214,214,60
buffer_load_dwordx4 v[156:159], v4, s[12:15], s43 offen
PF 58,220,220,58
PF 60,222,222,60
s_add_u32 s43, s43, 14336
PA 58,58,60
v_add_f32 v57, v58, v59
v_mov_b32 v58, v57
s_nop 1
v_permlane16_swap_b32 v58, v57
v_add_f32 v57, v57, v58
v_mov_b32 v58, v57
s_nop 1
v_permlane32_swap_b32 v58, v57
v_add_f32 v57, v57, v58
v_and_b32 v58, 15, v1
v_lshlrev_b32 v58, 3, v58
s_lshl_b32 s38, s39, 10
s_lshl_b32 s37, s34, 7
s_add_u32 s38, s38, s37
buffer_store_dwordx2 v[56:57], v58, s[28:31], s38 offen offset:1024 sc1
s_add_u32 s43, s41, 64
s_mov_b32 s33, s50
s_mov_b32 s34, s51
v_and_b32 v62, 1, v1
v_lshlrev_b32 v62, 7, v62
s_lshl_b32 s42, s33, 8
s_add_u32 s42, s42, 18432
s_cmp_lg_u32 s3, 0
s_cbranch_scc1 B3_o0
buffer_load_dword v63, v62, s[44:47], s42 offen sc1
B3_o0:
v_mov_b32 v32, 0
v_mov_b32 v33, 0
v_mov_b32 v34, 0
v_mov_b32 v35, 0
v_mov_b32 v36, 0
v_mov_b32 v37, 0
v_mov_b32 v38, 0
v_mov_b32 v39, 0
s_waitcnt vmcnt(12)
v_lshlrev_b32 v40, 16, v96
v_and_b32 v41, 0xffff0000, v96
v_lshlrev_b32 v42, 16, v97
v_and_b32 v43, 0xffff0000, v97
v_lshlrev_b32 v44, 16, v98
v_and_b32 v45, 0xffff0000, v98
v_lshlrev_b32 v46, 16, v99
v_and_b32 v47, 0xffff0000, v99
PA 32,32,40
PA 34,34,42
PA 36,36,44
PA 38,38,46
v_lshlrev_b32 v48, 16, v100
v_and_b32 v49, 0xffff0000, v100
v_lshlrev_b32 v50, 16, v101
v_and_b32 v51, 0xffff0000, v101
v_lshlrev_b32 v52, 16, v102
v_and_b32 v53, 0xffff0000, v102
v_lshlrev_b32 v54, 16, v103
v_and_b32 v55, 0xffff0000, v103
PA 32,32,48
PA 34,34,50
PA 36,36,52
PA 38,38,54
v_lshlrev_b32 v40, 16, v104
v_and_b32 v41, 0xffff0000, v104
v_lshlrev_b32 v42, 16, v105
v_and_b32 v43, 0xffff0000, v105
v_lshlrev_b32 v44, 16, v106
v_and_b32 v45, 0xffff0000, v106
v_lshlrev_b32 v46, 16, v107
v_and_b32 v47, 0xffff0000, v107
PA 32,32,40
PA 34,34,42
PA 36,36,44
PA 38,38,46
v_lshlrev_b32 v48, 16, v108
v_and_b32 v49, 0xffff0000, v108
v_lshlrev_b32 v50, 16, v109
v_and_b32 v51, 0xffff0000, v109
v_lshlrev_b32 v52, 16, v110
v_and_b32 v53, 0xffff0000, v110
v_lshlrev_b32 v54, 16, v111
v_and_b32 v55, 0xffff0000, v111
PA 32,32,48
PA 34,34,50
PA 36,36,52
PA 38,38,54
s_waitcnt vmcnt(8)
v_lshlrev_b32 v40, 16, v112
v_and_b32 v41, 0xffff0000, v112
v_lshlrev_b32 v42, 16, v113
v_and_b32 v43, 0xffff0000, v113
v_lshlrev_b32 v44, 16, v114
v_and_b32 v45, 0xffff0000, v114
v_lshlrev_b32 v46, 16, v115
v_and_b32 v47, 0xffff0000, v115
PA 32,32,40
PA 34,34,42
PA 36,36,44
PA 38,38,46
v_lshlrev_b32 v48, 16, v116
v_and_b32 v49, 0xffff0000, v116
v_lshlrev_b32 v50, 16, v117
v_and_b32 v51, 0xffff0000, v117
v_lshlrev_b32 v52, 16, v118
v_and_b32 v53, 0xffff0000, v118
v_lshlrev_b32 v54, 16, v119
v_and_b32 v55, 0xffff0000, v119
PA 32,32,48
PA 34,34,50
PA 36,36,52
PA 38,38,54
v_lshlrev_b32 v40, 16, v120
v_and_b32 v41, 0xffff0000, v120
v_lshlrev_b32 v42, 16, v121
v_and_b32 v43, 0xffff0000, v121
v_lshlrev_b32 v44, 16, v122
v_and_b32 v45, 0xffff0000, v122
v_lshlrev_b32 v46, 16, v123
v_and_b32 v47, 0xffff0000, v123
PA 32,32,40
PA 34,34,42
PA 36,36,44
PA 38,38,46
v_lshlrev_b32 v48, 16, v124
v_and_b32 v49, 0xffff0000, v124
v_lshlrev_b32 v50, 16, v125
v_and_b32 v51, 0xffff0000, v125
v_lshlrev_b32 v52, 16, v126
v_and_b32 v53, 0xffff0000, v126
v_lshlrev_b32 v54, 16, v127
v_and_b32 v55, 0xffff0000, v127
PA 32,32,48
PA 34,34,50
PA 36,36,52
PA 38,38,54
s_waitcnt vmcnt(4)
v_lshlrev_b32 v40, 16, v128
v_and_b32 v41, 0xffff0000, v128
v_lshlrev_b32 v42, 16, v129
v_and_b32 v43, 0xffff0000, v129
v_lshlrev_b32 v44, 16, v130
v_and_b32 v45, 0xffff0000, v130
v_lshlrev_b32 v46, 16, v131
v_and_b32 v47, 0xffff0000, v131
PA 32,32,40
PA 34,34,42
PA 36,36,44
PA 38,38,46
v_lshlrev_b32 v48, 16, v132
v_and_b32 v49, 0xffff0000, v132
v_lshlrev_b32 v50, 16, v133
v_and_b32 v51, 0xffff0000, v133
v_lshlrev_b32 v52, 16, v134
v_and_b32 v53, 0xffff0000, v134
v_lshlrev_b32 v54, 16, v135
v_and_b32 v55, 0xffff0000, v135
PA 32,32,48
PA 34,34,50
PA 36,36,52
PA 38,38,54
v_lshlrev_b32 v40, 16, v136
v_and_b32 v41, 0xffff0000, v136
v_lshlrev_b32 v42, 16, v137
v_and_b32 v43, 0xffff0000, v137
v_lshlrev_b32 v44, 16, v138
v_and_b32 v45, 0xffff0000, v138
v_lshlrev_b32 v46, 16, v139
v_and_b32 v47, 0xffff0000, v139
PA 32,32,40
PA 34,34,42
PA 36,36,44
PA 38,38,46
v_lshlrev_b32 v48, 16, v140
v_and_b32 v49, 0xffff0000, v140
v_lshlrev_b32 v50, 16, v141
v_and_b32 v51, 0xffff0000, v141
v_lshlrev_b32 v52, 16, v142
v_and_b32 v53, 0xffff0000, v142
v_lshlrev_b32 v54, 16, v143
v_and_b32 v55, 0xffff0000, v143
PA 32,32,48
PA 34,34,50
PA 36,36,52
PA 38,38,54
s_waitcnt vmcnt(0)
v_lshlrev_b32 v40, 16, v144
v_and_b32 v41, 0xffff0000, v144
v_lshlrev_b32 v42, 16, v145
v_and_b32 v43, 0xffff0000, v145
v_lshlrev_b32 v44, 16, v146
v_and_b32 v45, 0xffff0000, v146
v_lshlrev_b32 v46, 16, v147
v_and_b32 v47, 0xffff0000, v147
PA 32,32,40
PA 34,34,42
PA 36,36,44
PA 38,38,46
v_lshlrev_b32 v48, 16, v148
v_and_b32 v49, 0xffff0000, v148
v_lshlrev_b32 v50, 16, v149
v_and_b32 v51, 0xffff0000, v149
v_lshlrev_b32 v52, 16, v150
v_and_b32 v53, 0xffff0000, v150
v_lshlrev_b32 v54, 16, v151
v_and_b32 v55, 0xffff0000, v151
PA 32,32,48
PA 34,34,50
PA 36,36,52
PA 38,38,54
v_lshlrev_b32 v40, 16, v152
v_and_b32 v41, 0xffff0000, v152
v_lshlrev_b32 v42, 16, v153
v_and_b32 v43, 0xffff0000, v153
v_lshlrev_b32 v44, 16, v154
v_and_b32 v45, 0xffff0000, v154
v_lshlrev_b32 v46, 16, v155
v_and_b32 v47, 0xffff0000, v155
PA 32,32,40
PA 34,34,42
PA 36,36,44
PA 38,38,46
v_lshlrev_b32 v48, 16, v156
v_and_b32 v49, 0xffff0000, v156
v_lshlrev_b32 v50, 16, v157
v_and_b32 v51, 0xffff0000, v157
v_lshlrev_b32 v52, 16, v158
v_and_b32 v53, 0xffff0000, v158
v_lshlrev_b32 v54, 16, v159
v_and_b32 v55, 0xffff0000, v159
PA 32,32,48
PA 34,34,50
PA 36,36,52
PA 38,38,54
s_lshl_b32 s36, s3, 6
v_add_u32 v120, s36, v1
v_lshlrev_b32 v5, 5, v120
v_add_u32 v5, 0x20000, v5
ds_write_b128 v5, v[32:35]
ds_write_b128 v5, v[36:39] offset:16
v_lshlrev_b32 v121, 2, v120
v_add_u32 v5, 0x20000, v121
s_lshl_b32 s39, s33, 4
s_lshl_b32 s36, s3, 2
s_add_u32 s39, s39, s36
s_lshl_b32 s24, s39, 15
v_lshlrev_b32 v28, 4, v1
v_add_u32 v29, 32768, v28
v_add_u32 v30, 65536, v28
v_add_u32 v31, 98304, v28
v_mov_b32 v24, v240
v_mov_b32 v25, v241
v_mov_b32 v26, v242
v_mov_b32 v27, v243
v_mov_b32 v116, v244
v_mov_b32 v117, v245
v_mov_b32 v118, v246
v_mov_b32 v119, v247
s_add_u32 s8, s4, 12582912
s_addc_u32 s9, s5, 0
s_mov_b32 s10, 4194304
s_mov_b32 s11, 0x20000
s_add_u32 s16, s4, 25165824
s_addc_u32 s17, s5, 0
s_mov_b32 s18, 14680064
s_mov_b32 s19, 0x20000
s_add_u32 s20, s4, 20971520
s_addc_u32 s21, s5, 0
s_mov_b32 s22, 131072
s_mov_b32 s23, 0x20000
s_add_u32 s28, s4, 21233664
s_addc_u32 s29, s5, 0
s_mov_b32 s30, 114688
s_mov_b32 s31, 0x20000
s_waitcnt vmcnt(0) lgkmcnt(0)
s_cmp_lg_u32 s3, 0
s_cbranch_scc1 B3_x_k
v_cmp_ne_u32 vcc, 8, v63
s_nop 1
s_cbranch_vccnz B3_x_w
B3_x_k:
s_barrier
buffer_load_dwordx4 a[0:3], v28, s[8:11], s24 offen offset:0 sc1
buffer_load_dwordx4 a[4:7], v28, s[8:11], s24 offen offset:1024 sc1
buffer_load_dwordx4 a[8:11], v29, s[8:11], s24 offen offset:0 sc1
buffer_load_dwordx4 a[12:15], v29, s[8:11], s24 offen offset:1024 sc1
buffer_load_dwordx4 a[16:19], v30, s[8:11], s24 offen offset:0 sc1
buffer_load_dwordx4 a[20:23], v30, s[8:11], s24 offen offset:1024 sc1
buffer_load_dwordx4 a[24:27], v31, s[8:11], s24 offen offset:0 sc1
buffer_load_dwordx4 a[28:31], v31, s[8:11], s24 offen offset:1024 sc1
s_add_u32 s24, s24, 2048
buffer_load_dwordx4 a[32:35], v28, s[8:11], s24 offen offset:0 sc1
buffer_load_dwordx4 a[36:39], v28, s[8:11], s24 offen offset:1024 sc1
buffer_load_dwordx4 a[40:43], v29, s[8:11], s24 offen offset:0 sc1
buffer_load_dwordx4 a[44:47], v29, s[8:11], s24 offen offset:1024 sc1
buffer_load_dwordx4 a[48:51], v30, s[8:11], s24 offen offset:0 sc1
buffer_load_dwordx4 a[52:55], v30, s[8:11], s24 offen offset:1024 sc1
buffer_load_dwordx4 a[56:59], v31, s[8:11], s24 offen offset:0 sc1
buffer_load_dwordx4 a[60:63], v31, s[8:11], s24 offen offset:1024 sc1
s_add_u32 s24, s24, 2048
ds_read_b32 v32, v5 offset:0
ds_read_b32 v33, v5 offset:896
ds_read_b32 v34, v5 offset:2048
ds_read_b32 v35, v5 offset:2944
ds_read_b32 v36, v5 offset:4096
ds_read_b32 v37, v5 offset:4992
ds_read_b32 v38, v5 offset:6144
ds_read_b32 v39, v5 offset:7040
s_mul_i32 s36, s33, 14336
s_mul_i32 s41, s34, 896
s_add_u32 s36, s36, s41
v_cmp_gt_u32 vcc, 0xe0, v120
v_mov_b32 v6, 0x40000000
WL 0
v_cndmask_b32 v121, v6, v121, vcc
v_add_f32 v32, v32, v33
v_add_f32 v32, v32, v34
v_add_f32 v32, v32, v35
v_add_f32 v32, v32, v36
v_add_f32 v32, v32, v37
v_add_f32 v32, v32, v38
v_add_f32 v32, v32, v39
buffer_store_dword v32, v121, s[28:31], s36 offen sc1
B3_go:
v_and_b32 v2, 15, v1
v_lshrrev_b32 v3, 4, v1
v_lshlrev_b32 v2, 3, v2
v_lshl_add_u32 v112, v3, 8, v2
s_lshl_b32 s40, s39, 10
s_lshl_b32 s42, s34, 7
s_add_u32 s42, s42, 20480
v_and_b32 v113, 1, v1
v_lshlrev_b32 v113, 7, v113
s_lshl_b32 s36, s33, 8
s_add_u32 s36, s36, 18496
v_add_u32 v113, s36, v113
v_writelane_b32 v113, s42, 0
v_lshrrev_b32 v2, 2, v1
v_and_b32 v3, 7, v2
v_lshlrev_b32 v2, 8, v2
v_and_b32 v4, 3, v1
v_lshl_add_u32 v2, v4, 3, v2
v_xor_b32 v4, 0, v3
v_lshl_add_u32 v8, v4, 5, v2
v_add_u32 v16, 0x10000, v8
v_xor_b32 v4, 1, v3
v_lshl_add_u32 v9, v4, 5, v2
v_add_u32 v17, 0x10000, v9
v_xor_b32 v4, 2, v3
v_lshl_add_u32 v10, v4, 5, v2
v_add_u32 v18, 0x10000, v10
v_xor_b32 v4, 3, v3
v_lshl_add_u32 v11, v4, 5, v2
v_add_u32 v19, 0x10000, v11
v_xor_b32 v4, 4, v3
v_lshl_add_u32 v12, v4, 5, v2
v_add_u32 v20, 0x10000, v12
v_xor_b32 v4, 5, v3
v_lshl_add_u32 v13, v4, 5, v2
v_add_u32 v21, 0x10000, v13
v_xor_b32 v4, 6, v3
v_lshl_add_u32 v14, v4, 5, v2
v_add_u32 v22, 0x10000, v14
v_xor_b32 v4, 7, v3
v_lshl_add_u32 v15, v4, 5, v2
v_add_u32 v23, 0x10000, v15
s_waitcnt vmcnt(9)
s_barrier
TR 32,8,0
TR 34,8,4096
TR 36,8,8192
TR 38,8,12288
TR 40,9,0
TR 42,9,4096
TR 44,9,8192
TR 46,9,12288
TR 48,10,0
TR 50,10,4096
TR 52,10,8192
TR 54,10,12288
WL 8
Zvva 128,32,0
TR 56,11,0
Mvva 128,36,4
s_add_u32 m0, s27, 32768
Zvva 132,32,8
TR 58,11,4096
Mvva 132,36,12
DM 24,12,25,0
Zvva 136,32,16
TR 60,11,8192
Mvva 136,36,20
Zvva 140,32,24
TR 62,11,12288
Mvva 140,36,28
WL 8
Zvva 144,40,0
TR 32,12,0
Mvva 144,44,4
DM 25,12,25,1024
Zvva 148,40,8
TR 34,12,4096
Mvva 148,44,12
DM 26,12,25,2048
Zvva 152,40,16
TR 36,12,8192
Mvva 152,44,20
Zvva 156,40,24
TR 38,12,12288
Mvva 156,44,28
WL 8
Zvva 160,48,0
TR 40,13,0
Mvva 160,52,4
DM 27,12,25,3072
Zvva 164,48,8
TR 42,13,4096
Mvva 164,52,12
s_add_u32 s25, s25, 458752
Zvva 168,48,16
TR 44,13,8192
Mvva 168,52,20
Zvva 172,48,24
TR 46,13,12288
Mvva 172,52,28
WL 8
Zvva 176,56,0
TR 48,14,0
Mvva 176,60,4
s_add_u32 m0, s27, 98304
Zvva 180,56,8
TR 50,14,4096
Mvva 180,60,12
Zvva 184,56,16
TR 52,14,8192
Mvva 184,60,20
DM 116,12,26,0
Zvva 188,56,24
TR 54,14,12288
Mvva 188,60,28
WL 8
Zvva 192,32,0
TR 56,15,0
Mvva 192,36,4
DM 117,12,26,1024
Zvva 196,32,8
TR 58,15,4096
Mvva 196,36,12
Zvva 200,32,16
TR 60,15,8192
Mvva 200,36,20
DM 118,12,26,2048
Zvva 204,32,24
TR 62,15,12288
Mvva 204,36,28
WL 8
Zvva 208,40,0
TR 32,16,0
Mvva 208,44,4
DM 119,12,26,3072
Zvva 212,40,8
TR 34,16,4096
Mvva 212,44,12
Zvva 216,40,16
TR 36,16,8192
Mvva 216,44,20
s_add_u32 s26, s26, 458752
Zvva 220,40,24
TR 38,16,12288
Mvva 220,44,28
WL 8
Zava 128,48,0
TR 40,17,0
Mava 128,52,4
buffer_load_dwordx4 a[64:67], v28, s[8:11], s24 offen offset:0 sc1
Zava 132,48,8
TR 42,17,4096
Mava 132,52,12
Zava 136,48,16
TR 44,17,8192
Mava 136,52,20
buffer_load_dwordx4 a[68:71], v28, s[8:11], s24 offen offset:1024 sc1
Zava 140,48,24
TR 46,17,12288
Mava 140,52,28
WL 8
Zava 144,56,0
TR 48,18,0
Mava 144,60,4
Zava 148,56,8
TR 50,18,4096
Mava 148,60,12
buffer_load_dwordx4 a[72:75], v29, s[8:11], s24 offen offset:0 sc1
Zava 152,56,16
TR 52,18,8192
Mava 152,60,20
buffer_load_dwordx4 a[76:79], v29, s[8:11], s24 offen offset:1024 sc1
Zava 156,56,24
TR 54,18,12288
Mava 156,60,28
WL 8
Zava 160,32,0
TR 56,19,0
Mava 160,36,4
Zava 164,32,8
TR 58,19,4096
Mava 164,36,12
buffer_load_dwordx4 a[80:83], v30, s[8:11], s24 offen offset:0 sc1
Zava 168,32,16
TR 60,19,8192
Mava 168,36,20
buffer_load_dwordx4 a[84:87], v30, s[8:11], s24 offen offset:1024 sc1
Zava 172,32,24
TR 62,19,12288
Mava 172,36,28
WL 8
Zava 176,40,0
TR 32,20,0
Mava 176,44,4
Zava 180,40,8
TR 34,20,4096
Mava 180,44,12
buffer_load_dwordx4 a[88:91], v31, s[8:11], s24 offen offset:0 sc1
Zava 184,40,16
TR 36,20,8192
Mava 184,44,20
buffer_load_dwordx4 a[92:95], v31, s[8:11], s24 offen offset:1024 sc1
Zava 188,40,24
TR 38,20,12288
Mava 188,44,28
WL 8
Zava 192,48,0
TR 40,21,0
Mava 192,52,4
Zava 196,48,8
TR 42,21,4096
Mava 196,52,12
s_add_u32 s24, s24, 2048
Zava 200,48,16
TR 44,21,8192
Mava 200,52,20
Zava 204,48,24
TR 46,21,12288
Mava 204,52,28
WL 8
s_waitcnt vmcnt(16)
s_barrier
s_cmp_lg_u32 s3, 0
s_cbranch_scc1 B3_cssig
s_mov_b64 exec, 1
v_mov_b32 v3, 1
buffer_atomic_add v3, off, s[44:47], s42 sc1
s_mov_b64 exec, -1
B3_cssig:
s_cmp_lg_u32 s3, 0
s_cbranch_scc1 B3_stsig
s_mov_b64 exec, 1
v_mov_b32 v3, 1
buffer_atomic_add v3, off, s[44:47], s43 sc1
s_mov_b64 exec, -1
B3_stsig:
Zava 208,56,0
TR 48,8,16384
Mava 208,60,4
s_add_u32 m0, s27, 49152
Zava 212,56,8
TR 50,8,20480
Mava 212,60,12
Zava 216,56,16
TR 52,8,24576
Mava 216,60,20
DM 24,12,25,0
Zava 220,56,24
TR 54,8,28672
Mava 220,60,28
WL 8
Zava 224,32,0
TR 56,9,16384
Mava 224,36,4
Zava 228,32,8
TR 58,9,20480
Mava 228,36,12
DM 25,12,25,1024
Zava 232,32,16
TR 60,9,24576
Mava 232,36,20
Zava 236,32,24
TR 62,9,28672
Mava 236,36,28
WL 8
Zava 240,40,0
TR 32,10,16384
Mava 240,44,4
DM 26,12,25,2048
Zava 244,40,8
TR 34,10,20480
Mava 244,44,12
Zava 248,40,16
TR 36,10,24576
Mava 248,44,20
DM 27,12,25,3072
Zava 252,40,24
TR 38,10,28672
Mava 252,44,28
WL 8
Mvva 128,48,32
TR 40,11,16384
Mvva 128,52,36
Mvva 132,48,40
TR 42,11,20480
Mvva 132,52,44
s_add_u32 s25, s25, 458752
Mvva 136,48,48
TR 44,11,24576
Mvva 136,52,52
Mvva 140,48,56
TR 46,11,28672
Mvva 140,52,60
WL 8
Mvva 144,56,32
TR 48,12,16384
Mvva 144,60,36
s_add_u32 m0, s27, 114688
Mvva 148,56,40
TR 50,12,20480
Mvva 148,60,44
Mvva 152,56,48
TR 52,12,24576
Mvva 152,60,52
DM 116,12,26,0
Mvva 156,56,56
TR 54,12,28672
Mvva 156,60,60
WL 8
Mvva 160,32,32
TR 56,13,16384
Mvva 160,36,36
Mvva 164,32,40
TR 58,13,20480
Mvva 164,36,44
DM 117,12,26,1024
Mvva 168,32,48
TR 60,13,24576
Mvva 168,36,52
Mvva 172,32,56
TR 62,13,28672
Mvva 172,36,60
WL 8
Mvva 176,40,32
TR 32,14,16384
Mvva 176,44,36
DM 118,12,26,2048
Mvva 180,40,40
TR 34,14,20480
Mvva 180,44,44
Mvva 184,40,48
TR 36,14,24576
Mvva 184,44,52
DM 119,12,26,3072
Mvva 188,40,56
TR 38,14,28672
Mvva 188,44,60
WL 8
Mvva 192,48,32
TR 40,15,16384
Mvva 192,52,36
Mvva 196,48,40
TR 42,15,20480
Mvva 196,52,44
s_add_u32 s26, s26, 458752
Mvva 200,48,48
TR 44,15,24576
Mvva 200,52,52
Mvva 204,48,56
TR 46,15,28672
Mvva 204,52,60
WL 8
Mvva 208,56,32
TR 48,16,16384
Mvva 208,60,36
buffer_load_dwordx4 a[96:99], v28, s[8:11], s24 offen offset:0 sc1
Mvva 212,56,40
TR 50,16,20480
Mvva 212,60,44
Mvva 216,56,48
TR 52,16,24576
Mvva 216,60,52
buffer_load_dwordx4 a[100:103], v28, s[8:11], s24 offen offset:1024 sc1
Mvva 220,56,56
TR 54,16,28672
Mvva 220,60,60
WL 8
Mava 128,32,32
TR 56,17,16384
Mava 128,36,36
Mava 132,32,40
TR 58,17,20480
Mava 132,36,44
buffer_load_dwordx4 a[104:107], v29, s[8:11], s24 offen offset:0 sc1
Mava 136,32,48
TR 60,17,24576
Mava 136,36,52
Mava 140,32,56
TR 62,17,28672
Mava 140,36,60
WL 8
Mava 144,40,32
TR 32,18,16384
Mava 144,44,36
buffer_load_dwordx4 a[108:111], v29, s[8:11], s24 offen offset:1024 sc1
Mava 148,40,40
TR 34,18,20480
Mava 148,44,44
Mava 152,40,48
TR 36,18,24576
Mava 152,44,52
buffer_load_dwordx4 a[112:115], v30, s[8:11], s24 offen offset:0 sc1
Mava 156,40,56
TR 38,18,28672
Mava 156,44,60
WL 8
Mava 160,48,32
TR 40,19,16384
Mava 160,52,36
Mava 164,48,40
TR 42,19,20480
Mava 164,52,44
buffer_load_dwordx4 a[116:119], v30, s[8:11], s24 offen offset:1024 sc1
Mava 168,48,48
TR 44,19,24576
Mava 168,52,52
Mava 172,48,56
TR 46,19,28672
Mava 172,52,60
WL 8
Mava 176,56,32
TR 48,20,16384
Mava 176,60,36
buffer_load_dwordx4 a[120:123], v31, s[8:11], s24 offen offset:0 sc1
Mava 180,56,40
TR 50,20,20480
Mava 180,60,44
Mava 184,56,48
TR 52,20,24576
Mava 184,60,52
buffer_load_dwordx4 a[124:127], v31, s[8:11], s24 offen offset:1024 sc1
Mava 188,56,56
TR 54,20,28672
Mava 188,60,60
WL 8
Mava 192,32,32
TR 56,21,16384
Mava 192,36,36
Mava 196,32,40
TR 58,21,20480
Mava 196,36,44
s_add_u32 s24, s24, 2048
Mava 200,32,48
TR 60,21,24576
Mava 200,36,52
Mava 204,32,56
TR 62,21,28672
Mava 204,36,60
WL 8
s_mov_b32 s32, 2
B3_loop:
s_waitcnt vmcnt(16)
s_barrier
Mava 208,40,32
TR 32,8,32768
Mava 208,44,36
s_add_u32 m0, s27, 0
Mava 212,40,40
TR 34,8,36864
Mava 212,44,44
Mava 216,40,48
TR 36,8,40960
Mava 216,44,52
DM 24,12,25,0
Mava 220,40,56
TR 38,8,45056
Mava 220,44,60
WL 8
Mava 224,48,32
TR 40,9,32768
Mava 224,52,36
Mava 228,48,40
TR 42,9,36864
Mava 228,52,44
DM 25,12,25,1024
Mava 232,48,48
TR 44,9,40960
Mava 232,52,52
Mava 236,48,56
TR 46,9,45056
Mava 236,52,60
WL 8
Mava 240,56,32
TR 48,10,32768
Mava 240,60,36
DM 26,12,25,2048
Mava 244,56,40
TR 50,10,36864
Mava 244,60,44
Mava 248,56,48
TR 52,10,40960
Mava 248,60,52
DM 27,12,25,3072
Mava 252,56,56
TR 54,10,45056
Mava 252,60,60
WL 8
Mvva 128,32,64
TR 56,11,32768
Mvva 128,36,68
Mvva 132,32,72
TR 58,11,36864
Mvva 132,36,76
s_add_u32 s25, s25, 458752
Mvva 136,32,80
TR 60,11,40960
Mvva 136,36,84
Mvva 140,32,88
TR 62,11,45056
Mvva 140,36,92
WL 8
Mvva 144,40,64
TR 32,12,32768
Mvva 144,44,68
s_add_u32 m0, s27, 65536
Mvva 148,40,72
TR 34,12,36864
Mvva 148,44,76
Mvva 152,40,80
TR 36,12,40960
Mvva 152,44,84
DM 116,12,26,0
Mvva 156,40,88
TR 38,12,45056
Mvva 156,44,92
WL 8
Mvva 160,48,64
TR 40,13,32768
Mvva 160,52,68
Mvva 164,48,72
TR 42,13,36864
Mvva 164,52,76
DM 117,12,26,1024
Mvva 168,48,80
TR 44,13,40960
Mvva 168,52,84
Mvva 172,48,88
TR 46,13,45056
Mvva 172,52,92
WL 8
Mvva 176,56,64
TR 48,14,32768
Mvva 176,60,68
DM 118,12,26,2048
Mvva 180,56,72
TR 50,14,36864
Mvva 180,60,76
Mvva 184,56,80
TR 52,14,40960
Mvva 184,60,84
DM 119,12,26,3072
Mvva 188,56,88
TR 54,14,45056
Mvva 188,60,92
WL 8
Mvva 192,32,64
TR 56,15,32768
Mvva 192,36,68
Mvva 196,32,72
TR 58,15,36864
Mvva 196,36,76
s_add_u32 s26, s26, 458752
Mvva 200,32,80
TR 60,15,40960
Mvva 200,36,84
Mvva 204,32,88
TR 62,15,45056
Mvva 204,36,92
WL 8
Mvva 208,40,64
TR 32,16,32768
Mvva 208,44,68
buffer_load_dwordx4 a[0:3], v28, s[8:11], s24 offen offset:0 sc1
Mvva 212,40,72
TR 34,16,36864
Mvva 212,44,76
Mvva 216,40,80
TR 36,16,40960
Mvva 216,44,84
buffer_load_dwordx4 a[4:7], v28, s[8:11], s24 offen offset:1024 sc1
Mvva 220,40,88
TR 38,16,45056
Mvva 220,44,92
WL 8
Mava 128,48,64
TR 40,17,32768
Mava 128,52,68
Mava 132,48,72
TR 42,17,36864
Mava 132,52,76
buffer_load_dwordx4 a[8:11], v29, s[8:11], s24 offen offset:0 sc1
Mava 136,48,80
TR 44,17,40960
Mava 136,52,84
Mava 140,48,88
TR 46,17,45056
Mava 140,52,92
WL 8
Mava 144,56,64
TR 48,18,32768
Mava 144,60,68
buffer_load_dwordx4 a[12:15], v29, s[8:11], s24 offen offset:1024 sc1
Mava 148,56,72
TR 50,18,36864
Mava 148,60,76
Mava 152,56,80
TR 52,18,40960
Mava 152,60,84
buffer_load_dwordx4 a[16:19], v30, s[8:11], s24 offen offset:0 sc1
Mava 156,56,88
TR 54,18,45056
Mava 156,60,92
WL 8
Mava 160,32,64
TR 56,19,32768
Mava 160,36,68
Mava 164,32,72
TR 58,19,36864
Mava 164,36,76
buffer_load_dwordx4 a[20:23], v30, s[8:11], s24 offen offset:1024 sc1
Mava 168,32,80
TR 60,19,40960
Mava 168,36,84
Mava 172,32,88
TR 62,19,45056
Mava 172,36,92
WL 8
Mava 176,40,64
TR 32,20,32768
Mava 176,44,68
buffer_load_dwordx4 a[24:27], v31, s[8:11], s24 offen offset:0 sc1
Mava 180,40,72
TR 34,20,36864
Mava 180,44,76
Mava 184,40,80
TR 36,20,40960
Mava 184,44,84
buffer_load_dwordx4 a[28:31], v31, s[8:11], s24 offen offset:1024 sc1
Mava 188,40,88
TR 38,20,45056
Mava 188,44,92
WL 8
Mava 192,48,64
TR 40,21,32768
Mava 192,52,68
Mava 196,48,72
TR 42,21,36864
Mava 196,52,76
s_add_u32 s24, s24, 2048
Mava 200,48,80
TR 44,21,40960
Mava 200,52,84
Mava 204,48,88
TR 46,21,45056
Mava 204,52,92
WL 8
s_waitcnt vmcnt(16)
s_barrier
Mava 208,56,64
TR 48,8,49152
Mava 208,60,68
s_add_u32 m0, s27, 16384
Mava 212,56,72
TR 50,8,53248
Mava 212,60,76
Mava 216,56,80
TR 52,8,57344
Mava 216,60,84
DM 24,12,25,0
Mava 220,56,88
TR 54,8,61440
Mava 220,60,92
WL 8
Mava 224,32,64
TR 56,9,49152
Mava 224,36,68
Mava 228,32,72
TR 58,9,53248
Mava 228,36,76
DM 25,12,25,1024
Mava 232,32,80
TR 60,9,57344
Mava 232,36,84
Mava 236,32,88
TR 62,9,61440
Mava 236,36,92
WL 8
Mava 240,40,64
TR 32,10,49152
Mava 240,44,68
DM 26,12,25,2048
Mava 244,40,72
TR 34,10,53248
Mava 244,44,76
Mava 248,40,80
TR 36,10,57344
Mava 248,44,84
DM 27,12,25,3072
Mava 252,40,88
TR 38,10,61440
Mava 252,44,92
WL 8
Mvva 128,48,96
TR 40,11,49152
Mvva 128,52,100
Mvva 132,48,104
TR 42,11,53248
Mvva 132,52,108
s_add_u32 s25, s25, 458752
Mvva 136,48,112
TR 44,11,57344
Mvva 136,52,116
Mvva 140,48,120
TR 46,11,61440
Mvva 140,52,124
WL 8
Mvva 144,56,96
TR 48,12,49152
Mvva 144,60,100
s_add_u32 m0, s27, 81920
Mvva 148,56,104
TR 50,12,53248
Mvva 148,60,108
Mvva 152,56,112
TR 52,12,57344
Mvva 152,60,116
DM 116,12,26,0
Mvva 156,56,120
TR 54,12,61440
Mvva 156,60,124
WL 8
Mvva 160,32,96
TR 56,13,49152
Mvva 160,36,100
Mvva 164,32,104
TR 58,13,53248
Mvva 164,36,108
DM 117,12,26,1024
Mvva 168,32,112
TR 60,13,57344
Mvva 168,36,116
Mvva 172,32,120
TR 62,13,61440
Mvva 172,36,124
WL 8
Mvva 176,40,96
TR 32,14,49152
Mvva 176,44,100
DM 118,12,26,2048
Mvva 180,40,104
TR 34,14,53248
Mvva 180,44,108
Mvva 184,40,112
TR 36,14,57344
Mvva 184,44,116
DM 119,12,26,3072
Mvva 188,40,120
TR 38,14,61440
Mvva 188,44,124
WL 8
Mvva 192,48,96
TR 40,15,49152
Mvva 192,52,100
Mvva 196,48,104
TR 42,15,53248
Mvva 196,52,108
s_add_u32 s26, s26, 458752
Mvva 200,48,112
TR 44,15,57344
Mvva 200,52,116
Mvva 204,48,120
TR 46,15,61440
Mvva 204,52,124
WL 8
Mvva 208,56,96
TR 48,16,49152
Mvva 208,60,100
buffer_load_dwordx4 a[32:35], v28, s[8:11], s24 offen offset:0 sc1
Mvva 212,56,104
TR 50,16,53248
Mvva 212,60,108
Mvva 216,56,112
TR 52,16,57344
Mvva 216,60,116
buffer_load_dwordx4 a[36:39], v28, s[8:11], s24 offen offset:1024 sc1
Mvva 220,56,120
TR 54,16,61440
Mvva 220,60,124
WL 8
Mava 128,32,96
TR 56,17,49152
Mava 128,36,100
Mava 132,32,104
TR 58,17,53248
Mava 132,36,108
buffer_load_dwordx4 a[40:43], v29, s[8:11], s24 offen offset:0 sc1
Mava 136,32,112
TR 60,17,57344
Mava 136,36,116
Mava 140,32,120
TR 62,17,61440
Mava 140,36,124
WL 8
Mava 144,40,96
TR 32,18,49152
Mava 144,44,100
buffer_load_dwordx4 a[44:47], v29, s[8:11], s24 offen offset:1024 sc1
Mava 148,40,104
TR 34,18,53248
Mava 148,44,108
Mava 152,40,112
TR 36,18,57344
Mava 152,44,116
buffer_load_dwordx4 a[48:51], v30, s[8:11], s24 offen offset:0 sc1
Mava 156,40,120
TR 38,18,61440
Mava 156,44,124
WL 8
Mava 160,48,96
TR 40,19,49152
Mava 160,52,100
Mava 164,48,104
TR 42,19,53248
Mava 164,52,108
buffer_load_dwordx4 a[52:55], v30, s[8:11], s24 offen offset:1024 sc1
Mava 168,48,112
TR 44,19,57344
Mava 168,52,116
Mava 172,48,120
TR 46,19,61440
Mava 172,52,124
WL 8
Mava 176,56,96
TR 48,20,49152
Mava 176,60,100
buffer_load_dwordx4 a[56:59], v31, s[8:11], s24 offen offset:0 sc1
Mava 180,56,104
TR 50,20,53248
Mava 180,60,108
Mava 184,56,112
TR 52,20,57344
Mava 184,60,116
buffer_load_dwordx4 a[60:63], v31, s[8:11], s24 offen offset:1024 sc1
Mava 188,56,120
TR 54,20,61440
Mava 188,60,124
WL 8
Mava 192,32,96
TR 56,21,49152
Mava 192,36,100
Mava 196,32,104
TR 58,21,53248
Mava 196,36,108
s_add_u32 s24, s24, 2048
Mava 200,32,112
TR 60,21,57344
Mava 200,36,116
Mava 204,32,120
TR 62,21,61440
Mava 204,36,124
WL 8
s_waitcnt vmcnt(16)
s_barrier
Mava 208,40,96
TR 32,8,0
Mava 208,44,100
s_add_u32 m0, s27, 32768
Mava 212,40,104
TR 34,8,4096
Mava 212,44,108
Mava 216,40,112
TR 36,8,8192
Mava 216,44,116
DM 24,12,25,0
Mava 220,40,120
TR 38,8,12288
Mava 220,44,124
WL 8
Mava 224,48,96
TR 40,9,0
Mava 224,52,100
Mava 228,48,104
TR 42,9,4096
Mava 228,52,108
DM 25,12,25,1024
Mava 232,48,112
TR 44,9,8192
Mava 232,52,116
Mava 236,48,120
TR 46,9,12288
Mava 236,52,124
WL 8
Mava 240,56,96
TR 48,10,0
Mava 240,60,100
DM 26,12,25,2048
Mava 244,56,104
TR 50,10,4096
Mava 244,60,108
Mava 248,56,112
TR 52,10,8192
Mava 248,60,116
DM 27,12,25,3072
Mava 252,56,120
TR 54,10,12288
Mava 252,60,124
WL 8
Mvva 128,32,0
TR 56,11,0
Mvva 128,36,4
Mvva 132,32,8
TR 58,11,4096
Mvva 132,36,12
s_add_u32 s25, s25, 458752
Mvva 136,32,16
TR 60,11,8192
Mvva 136,36,20
Mvva 140,32,24
TR 62,11,12288
Mvva 140,36,28
WL 8
Mvva 144,40,0
TR 32,12,0
Mvva 144,44,4
s_add_u32 m0, s27, 98304
Mvva 148,40,8
TR 34,12,4096
Mvva 148,44,12
Mvva 152,40,16
TR 36,12,8192
Mvva 152,44,20
DM 116,12,26,0
Mvva 156,40,24
TR 38,12,12288
Mvva 156,44,28
WL 8
Mvva 160,48,0
TR 40,13,0
Mvva 160,52,4
Mvva 164,48,8
TR 42,13,4096
Mvva 164,52,12
DM 117,12,26,1024
Mvva 168,48,16
TR 44,13,8192
Mvva 168,52,20
Mvva 172,48,24
TR 46,13,12288
Mvva 172,52,28
WL 8
Mvva 176,56,0
TR 48,14,0
Mvva 176,60,4
DM 118,12,26,2048
Mvva 180,56,8
TR 50,14,4096
Mvva 180,60,12
Mvva 184,56,16
TR 52,14,8192
Mvva 184,60,20
DM 119,12,26,3072
Mvva 188,56,24
TR 54,14,12288
Mvva 188,60,28
WL 8
Mvva 192,32,0
TR 56,15,0
Mvva 192,36,4
Mvva 196,32,8
TR 58,15,4096
Mvva 196,36,12
s_add_u32 s26, s26, 458752
Mvva 200,32,16
TR 60,15,8192
Mvva 200,36,20
Mvva 204,32,24
TR 62,15,12288
Mvva 204,36,28
WL 8
Mvva 208,40,0
TR 32,16,0
Mvva 208,44,4
buffer_load_dwordx4 a[64:67], v28, s[8:11], s24 offen offset:0 sc1
Mvva 212,40,8
TR 34,16,4096
Mvva 212,44,12
Mvva 216,40,16
TR 36,16,8192
Mvva 216,44,20
buffer_load_dwordx4 a[68:71], v28, s[8:11], s24 offen offset:1024 sc1
Mvva 220,40,24
TR 38,16,12288
Mvva 220,44,28
WL 8
Mava 128,48,0
TR 40,17,0
Mava 128,52,4
Mava 132,48,8
TR 42,17,4096
Mava 132,52,12
buffer_load_dwordx4 a[72:75], v29, s[8:11], s24 offen offset:0 sc1
Mava 136,48,16
TR 44,17,8192
Mava 136,52,20
Mava 140,48,24
TR 46,17,12288
Mava 140,52,28
WL 8
Mava 144,56,0
TR 48,18,0
Mava 144,60,4
buffer_load_dwordx4 a[76:79], v29, s[8:11], s24 offen offset:1024 sc1
Mava 148,56,8
TR 50,18,4096
Mava 148,60,12
Mava 152,56,16
TR 52,18,8192
Mava 152,60,20
buffer_load_dwordx4 a[80:83], v30, s[8:11], s24 offen offset:0 sc1
Mava 156,56,24
TR 54,18,12288
Mava 156,60,28
WL 8
Mava 160,32,0
TR 56,19,0
Mava 160,36,4
Mava 164,32,8
TR 58,19,4096
Mava 164,36,12
buffer_load_dwordx4 a[84:87], v30, s[8:11], s24 offen offset:1024 sc1
Mava 168,32,16
TR 60,19,8192
Mava 168,36,20
Mava 172,32,24
TR 62,19,12288
Mava 172,36,28
WL 8
Mava 176,40,0
TR 32,20,0
Mava 176,44,4
buffer_load_dwordx4 a[88:91], v31, s[8:11], s24 offen offset:0 sc1
Mava 180,40,8
TR 34,20,4096
Mava 180,44,12
Mava 184,40,16
TR 36,20,8192
Mava 184,44,20
buffer_load_dwordx4 a[92:95], v31, s[8:11], s24 offen offset:1024 sc1
Mava 188,40,24
TR 38,20,12288
Mava 188,44,28
WL 8
Mava 192,48,0
TR 40,21,0
Mava 192,52,4
Mava 196,48,8
TR 42,21,4096
Mava 196,52,12
s_add_u32 s24, s24, 2048
Mava 200,48,16
TR 44,21,8192
Mava 200,52,20
Mava 204,48,24
TR 46,21,12288
Mava 204,52,28
WL 8
s_waitcnt vmcnt(16)
s_barrier
Mava 208,56,0
TR 48,8,16384
Mava 208,60,4
s_add_u32 m0, s27, 49152
Mava 212,56,8
TR 50,8,20480
Mava 212,60,12
Mava 216,56,16
TR 52,8,24576
Mava 216,60,20
DM 24,12,25,0
Mava 220,56,24
TR 54,8,28672
Mava 220,60,28
WL 8
Mava 224,32,0
TR 56,9,16384
Mava 224,36,4
Mava 228,32,8
TR 58,9,20480
Mava 228,36,12
DM 25,12,25,1024
Mava 232,32,16
TR 60,9,24576
Mava 232,36,20
Mava 236,32,24
TR 62,9,28672
Mava 236,36,28
WL 8
Mava 240,40,0
TR 32,10,16384
Mava 240,44,4
DM 26,12,25,2048
Mava 244,40,8
TR 34,10,20480
Mava 244,44,12
Mava 248,40,16
TR 36,10,24576
Mava 248,44,20
DM 27,12,25,3072
Mava 252,40,24
TR 38,10,28672
Mava 252,44,28
WL 8
Mvva 128,48,32
TR 40,11,16384
Mvva 128,52,36
Mvva 132,48,40
TR 42,11,20480
Mvva 132,52,44
s_add_u32 s25, s25, 458752
Mvva 136,48,48
TR 44,11,24576
Mvva 136,52,52
Mvva 140,48,56
TR 46,11,28672
Mvva 140,52,60
WL 8
Mvva 144,56,32
TR 48,12,16384
Mvva 144,60,36
s_add_u32 m0, s27, 114688
Mvva 148,56,40
TR 50,12,20480
Mvva 148,60,44
Mvva 152,56,48
TR 52,12,24576
Mvva 152,60,52
DM 116,12,26,0
Mvva 156,56,56
TR 54,12,28672
Mvva 156,60,60
WL 8
Mvva 160,32,32
TR 56,13,16384
Mvva 160,36,36
Mvva 164,32,40
TR 58,13,20480
Mvva 164,36,44
DM 117,12,26,1024
Mvva 168,32,48
TR 60,13,24576
Mvva 168,36,52
Mvva 172,32,56
TR 62,13,28672
Mvva 172,36,60
WL 8
Mvva 176,40,32
TR 32,14,16384
Mvva 176,44,36
DM 118,12,26,2048
Mvva 180,40,40
TR 34,14,20480
Mvva 180,44,44
Mvva 184,40,48
TR 36,14,24576
Mvva 184,44,52
DM 119,12,26,3072
Mvva 188,40,56
TR 38,14,28672
Mvva 188,44,60
WL 8
Mvva 192,48,32
TR 40,15,16384
Mvva 192,52,36
Mvva 196,48,40
TR 42,15,20480
Mvva 196,52,44
s_add_u32 s26, s26, 458752
Mvva 200,48,48
TR 44,15,24576
Mvva 200,52,52
Mvva 204,48,56
TR 46,15,28672
Mvva 204,52,60
WL 8
Mvva 208,56,32
TR 48,16,16384
Mvva 208,60,36
buffer_load_dwordx4 a[96:99], v28, s[8:11], s24 offen offset:0 sc1
Mvva 212,56,40
TR 50,16,20480
Mvva 212,60,44
Mvva 216,56,48
TR 52,16,24576
Mvva 216,60,52
buffer_load_dwordx4 a[100:103], v28, s[8:11], s24 offen offset:1024 sc1
Mvva 220,56,56
TR 54,16,28672
Mvva 220,60,60
WL 8
Mava 128,32,32
TR 56,17,16384
Mava 128,36,36
Mava 132,32,40
TR 58,17,20480
Mava 132,36,44
buffer_load_dwordx4 a[104:107], v29, s[8:11], s24 offen offset:0 sc1
Mava 136,32,48
TR 60,17,24576
Mava 136,36,52
Mava 140,32,56
TR 62,17,28672
Mava 140,36,60
WL 8
Mava 144,40,32
TR 32,18,16384
Mava 144,44,36
buffer_load_dwordx4 a[108:111], v29, s[8:11], s24 offen offset:1024 sc1
Mava 148,40,40
TR 34,18,20480
Mava 148,44,44
Mava 152,40,48
TR 36,18,24576
Mava 152,44,52
buffer_load_dwordx4 a[112:115], v30, s[8:11], s24 offen offset:0 sc1
Mava 156,40,56
TR 38,18,28672
Mava 156,44,60
WL 8
Mava 160,48,32
TR 40,19,16384
Mava 160,52,36
Mava 164,48,40
TR 42,19,20480
Mava 164,52,44
buffer_load_dwordx4 a[116:119], v30, s[8:11], s24 offen offset:1024 sc1
Mava 168,48,48
TR 44,19,24576
Mava 168,52,52
Mava 172,48,56
TR 46,19,28672
Mava 172,52,60
WL 8
Mava 176,56,32
TR 48,20,16384
Mava 176,60,36
buffer_load_dwordx4 a[120:123], v31, s[8:11], s24 offen offset:0 sc1
Mava 180,56,40
TR 50,20,20480
Mava 180,60,44
Mava 184,56,48
TR 52,20,24576
Mava 184,60,52
buffer_load_dwordx4 a[124:127], v31, s[8:11], s24 offen offset:1024 sc1
Mava 188,56,56
TR 54,20,28672
Mava 188,60,60
WL 8
Mava 192,32,32
TR 56,21,16384
Mava 192,36,36
Mava 196,32,40
TR 58,21,20480
Mava 196,36,44
s_add_u32 s24, s24, 2048
Mava 200,32,48
TR 60,21,24576
Mava 200,36,52
Mava 204,32,56
TR 62,21,28672
s_sub_u32 s32, s32, 1
Mava 204,36,60
WL 8
s_cmp_lg_u32 s32, 0
s_cbranch_scc1 B3_loop
s_waitcnt vmcnt(16)
s_barrier
Mava 208,40,32
TR 32,8,32768
Mava 208,44,36
s_add_u32 m0, s27, 0
Mava 212,40,40
TR 34,8,36864
Mava 212,44,44
Mava 216,40,48
TR 36,8,40960
Mava 216,44,52
DM 24,12,25,0
Mava 220,40,56
TR 38,8,45056
Mava 220,44,60
WL 8
Mava 224,48,32
TR 40,9,32768
Mava 224,52,36
Mava 228,48,40
TR 42,9,36864
Mava 228,52,44
DM 25,12,25,1024
Mava 232,48,48
TR 44,9,40960
Mava 232,52,52
Mava 236,48,56
TR 46,9,45056
Mava 236,52,60
WL 8
Mava 240,56,32
TR 48,10,32768
Mava 240,60,36
DM 26,12,25,2048
Mava 244,56,40
TR 50,10,36864
Mava 244,60,44
Mava 248,56,48
TR 52,10,40960
Mava 248,60,52
DM 27,12,25,3072
Mava 252,56,56
TR 54,10,45056
Mava 252,60,60
WL 8
Mvva 128,32,64
TR 56,11,32768
Mvva 128,36,68
Mvva 132,32,72
TR 58,11,36864
Mvva 132,36,76
s_add_u32 s25, s25, 458752
Mvva 136,32,80
TR 60,11,40960
Mvva 136,36,84
Mvva 140,32,88
TR 62,11,45056
Mvva 140,36,92
WL 8
Mvva 144,40,64
TR 32,12,32768
Mvva 144,44,68
s_add_u32 m0, s27, 65536
Mvva 148,40,72
TR 34,12,36864
Mvva 148,44,76
Mvva 152,40,80
TR 36,12,40960
Mvva 152,44,84
DM 116,12,26,0
Mvva 156,40,88
TR 38,12,45056
Mvva 156,44,92
WL 8
Mvva 160,48,64
TR 40,13,32768
Mvva 160,52,68
Mvva 164,48,72
TR 42,13,36864
Mvva 164,52,76
DM 117,12,26,1024
Mvva 168,48,80
TR 44,13,40960
Mvva 168,52,84
Mvva 172,48,88
TR 46,13,45056
Mvva 172,52,92
WL 8
Mvva 176,56,64
TR 48,14,32768
Mvva 176,60,68
DM 118,12,26,2048
Mvva 180,56,72
TR 50,14,36864
Mvva 180,60,76
Mvva 184,56,80
TR 52,14,40960
Mvva 184,60,84
DM 119,12,26,3072
Mvva 188,56,88
TR 54,14,45056
Mvva 188,60,92
WL 8
Mvva 192,32,64
TR 56,15,32768
Mvva 192,36,68
Mvva 196,32,72
TR 58,15,36864
Mvva 196,36,76
s_add_u32 s26, s26, 458752
Mvva 200,32,80
TR 60,15,40960
Mvva 200,36,84
Mvva 204,32,88
TR 62,15,45056
Mvva 204,36,92
WL 8
Mvva 208,40,64
TR 32,16,32768
Mvva 208,44,68
buffer_load_dwordx4 a[0:3], v28, s[8:11], s24 offen offset:0 sc1
Mvva 212,40,72
TR 34,16,36864
Mvva 212,44,76
Mvva 216,40,80
TR 36,16,40960
Mvva 216,44,84
buffer_load_dwordx4 a[4:7], v28, s[8:11], s24 offen offset:1024 sc1
Mvva 220,40,88
TR 38,16,45056
Mvva 220,44,92
WL 8
Mava 128,48,64
TR 40,17,32768
Mava 128,52,68
Mava 132,48,72
TR 42,17,36864
Mava 132,52,76
buffer_load_dwordx4 a[8:11], v29, s[8:11], s24 offen offset:0 sc1
Mava 136,48,80
TR 44,17,40960
Mava 136,52,84
Mava 140,48,88
TR 46,17,45056
Mava 140,52,92
WL 8
Mava 144,56,64
TR 48,18,32768
Mava 144,60,68
buffer_load_dwordx4 a[12:15], v29, s[8:11], s24 offen offset:1024 sc1
Mava 148,56,72
TR 50,18,36864
Mava 148,60,76
Mava 152,56,80
TR 52,18,40960
Mava 152,60,84
buffer_load_dwordx4 a[16:19], v30, s[8:11], s24 offen offset:0 sc1
Mava 156,56,88
TR 54,18,45056
Mava 156,60,92
WL 8
Mava 160,32,64
TR 56,19,32768
Mava 160,36,68
Mava 164,32,72
TR 58,19,36864
Mava 164,36,76
buffer_load_dwordx4 a[20:23], v30, s[8:11], s24 offen offset:1024 sc1
Mava 168,32,80
TR 60,19,40960
Mava 168,36,84
Mava 172,32,88
TR 62,19,45056
Mava 172,36,92
WL 8
Mava 176,40,64
TR 32,20,32768
Mava 176,44,68
buffer_load_dwordx4 a[24:27], v31, s[8:11], s24 offen offset:0 sc1
Mava 180,40,72
TR 34,20,36864
Mava 180,44,76
Mava 184,40,80
TR 36,20,40960
Mava 184,44,84
buffer_load_dwordx4 a[28:31], v31, s[8:11], s24 offen offset:1024 sc1
Mava 188,40,88
TR 38,20,45056
Mava 188,44,92
WL 8
Mava 192,48,64
TR 40,21,32768
Mava 192,52,68
Mava 196,48,72
TR 42,21,36864
Mava 196,52,76
s_add_u32 s24, s24, 2048
Mava 200,48,80
TR 44,21,40960
Mava 200,52,84
Mava 204,48,88
TR 46,21,45056
Mava 204,52,92
WL 8
s_waitcnt vmcnt(16)
s_barrier
Mava 208,56,64
TR 48,8,49152
Mava 208,60,68
s_add_u32 m0, s27, 16384
Mava 212,56,72
TR 50,8,53248
Mava 212,60,76
Mava 216,56,80
TR 52,8,57344
Mava 216,60,84
DM 24,12,25,0
Mava 220,56,88
TR 54,8,61440
Mava 220,60,92
WL 8
Mava 224,32,64
TR 56,9,49152
Mava 224,36,68
Mava 228,32,72
TR 58,9,53248
Mava 228,36,76
DM 25,12,25,1024
Mava 232,32,80
TR 60,9,57344
Mava 232,36,84
Mava 236,32,88
TR 62,9,61440
Mava 236,36,92
WL 8
Mava 240,40,64
TR 32,10,49152
Mava 240,44,68
DM 26,12,25,2048
Mava 244,40,72
TR 34,10,53248
Mava 244,44,76
Mava 248,40,80
TR 36,10,57344
Mava 248,44,84
DM 27,12,25,3072
Mava 252,40,88
TR 38,10,61440
Mava 252,44,92
WL 8
Mvva 128,48,96
TR 40,11,49152
Mvva 128,52,100
Mvva 132,48,104
TR 42,11,53248
Mvva 132,52,108
s_add_u32 s25, s25, 458752
Mvva 136,48,112
TR 44,11,57344
Mvva 136,52,116
Mvva 140,48,120
TR 46,11,61440
Mvva 140,52,124
WL 8
Mvva 144,56,96
TR 48,12,49152
Mvva 144,60,100
s_add_u32 m0, s27, 81920
Mvva 148,56,104
TR 50,12,53248
Mvva 148,60,108
Mvva 152,56,112
TR 52,12,57344
Mvva 152,60,116
DM 116,12,26,0
Mvva 156,56,120
TR 54,12,61440
Mvva 156,60,124
WL 8
Mvva 160,32,96
TR 56,13,49152
Mvva 160,36,100
Mvva 164,32,104
TR 58,13,53248
Mvva 164,36,108
DM 117,12,26,1024
Mvva 168,32,112
TR 60,13,57344
Mvva 168,36,116
Mvva 172,32,120
TR 62,13,61440
Mvva 172,36,124
WL 8
Mvva 176,40,96
TR 32,14,49152
Mvva 176,44,100
DM 118,12,26,2048
Mvva 180,40,104
TR 34,14,53248
Mvva 180,44,108
Mvva 184,40,112
TR 36,14,57344
Mvva 184,44,116
DM 119,12,26,3072
Mvva 188,40,120
TR 38,14,61440
Mvva 188,44,124
WL 8
Mvva 192,48,96
TR 40,15,49152
Mvva 192,52,100
Mvva 196,48,104
TR 42,15,53248
Mvva 196,52,108
s_add_u32 s26, s26, 458752
Mvva 200,48,112
TR 44,15,57344
Mvva 200,52,116
Mvva 204,48,120
TR 46,15,61440
Mvva 204,52,124
WL 8
Mvva 208,56,96
TR 48,16,49152
Mvva 208,60,100
buffer_load_dwordx4 a[32:35], v28, s[8:11], s24 offen offset:0 sc1
Mvva 212,56,104
TR 50,16,53248
Mvva 212,60,108
Mvva 216,56,112
TR 52,16,57344
Mvva 216,60,116
buffer_load_dwordx4 a[36:39], v28, s[8:11], s24 offen offset:1024 sc1
Mvva 220,56,120
TR 54,16,61440
Mvva 220,60,124
WL 8
Mava 128,32,96
TR 56,17,49152
Mava 128,36,100
Mava 132,32,104
TR 58,17,53248
Mava 132,36,108
buffer_load_dwordx4 a[40:43], v29, s[8:11], s24 offen offset:0 sc1
Mava 136,32,112
TR 60,17,57344
Mava 136,36,116
Mava 140,32,120
TR 62,17,61440
Mava 140,36,124
WL 8
Mava 144,40,96
TR 32,18,49152
Mava 144,44,100
buffer_load_dwordx4 a[44:47], v29, s[8:11], s24 offen offset:1024 sc1
Mava 148,40,104
TR 34,18,53248
Mava 148,44,108
Mava 152,40,112
TR 36,18,57344
Mava 152,44,116
buffer_load_dwordx4 a[48:51], v30, s[8:11], s24 offen offset:0 sc1
Mava 156,40,120
TR 38,18,61440
Mava 156,44,124
WL 8
Mava 160,48,96
TR 40,19,49152
Mava 160,52,100
Mava 164,48,104
TR 42,19,53248
Mava 164,52,108
buffer_load_dwordx4 a[52:55], v30, s[8:11], s24 offen offset:1024 sc1
Mava 168,48,112
TR 44,19,57344
Mava 168,52,116
Mava 172,48,120
TR 46,19,61440
Mava 172,52,124
WL 8
Mava 176,56,96
TR 48,20,49152
Mava 176,60,100
buffer_load_dwordx4 a[56:59], v31, s[8:11], s24 offen offset:0 sc1
Mava 180,56,104
TR 50,20,53248
Mava 180,60,108
Mava 184,56,112
TR 52,20,57344
Mava 184,60,116
buffer_load_dwordx4 a[60:63], v31, s[8:11], s24 offen offset:1024 sc1
Mava 188,56,120
TR 54,20,61440
Mava 188,60,124
WL 8
Mava 192,32,96
TR 56,21,49152
Mava 192,36,100
Mava 196,32,104
TR 58,21,53248
Mava 196,36,108
s_add_u32 s24, s24, 2048
Mava 200,32,112
TR 60,21,57344
Mava 200,36,116
Mava 204,32,120
TR 62,21,61440
Mava 204,36,124
WL 8
s_waitcnt vmcnt(16)
s_barrier
Mava 208,40,96
TR 32,8,0
Mava 208,44,100
s_add_u32 m0, s27, 32768
Mava 212,40,104
TR 34,8,4096
Mava 212,44,108
Mava 216,40,112
TR 36,8,8192
Mava 216,44,116
DM 24,12,25,0
Mava 220,40,120
TR 38,8,12288
Mava 220,44,124
WL 8
Mava 224,48,96
TR 40,9,0
Mava 224,52,100
Mava 228,48,104
TR 42,9,4096
Mava 228,52,108
DM 25,12,25,1024
Mava 232,48,112
TR 44,9,8192
Mava 232,52,116
Mava 236,48,120
TR 46,9,12288
Mava 236,52,124
WL 8
Mava 240,56,96
TR 48,10,0
Mava 240,60,100
DM 26,12,25,2048
Mava 244,56,104
TR 50,10,4096
Mava 244,60,108
Mava 248,56,112
TR 52,10,8192
Mava 248,60,116
DM 27,12,25,3072
Mava 252,56,120
TR 54,10,12288
Mava 252,60,124
WL 8
Mvva 128,32,0
TR 56,11,0
Mvva 128,36,4
Mvva 132,32,8
TR 58,11,4096
Mvva 132,36,12
s_add_u32 s25, s25, 458752
Mvva 136,32,16
TR 60,11,8192
Mvva 136,36,20
Mvva 140,32,24
TR 62,11,12288
Mvva 140,36,28
WL 8
Mvva 144,40,0
TR 32,12,0
Mvva 144,44,4
s_add_u32 m0, s27, 98304
Mvva 148,40,8
TR 34,12,4096
Mvva 148,44,12
Mvva 152,40,16
TR 36,12,8192
Mvva 152,44,20
DM 116,12,26,0
Mvva 156,40,24
TR 38,12,12288
Mvva 156,44,28
WL 8
Mvva 160,48,0
TR 40,13,0
Mvva 160,52,4
Mvva 164,48,8
TR 42,13,4096
Mvva 164,52,12
DM 117,12,26,1024
Mvva 168,48,16
TR 44,13,8192
Mvva 168,52,20
Mvva 172,48,24
TR 46,13,12288
Mvva 172,52,28
WL 8
Mvva 176,56,0
TR 48,14,0
Mvva 176,60,4
DM 118,12,26,2048
Mvva 180,56,8
TR 50,14,4096
Mvva 180,60,12
Mvva 184,56,16
TR 52,14,8192
Mvva 184,60,20
DM 119,12,26,3072
Mvva 188,56,24
TR 54,14,12288
Mvva 188,60,28
WL 8
Mvva 192,32,0
TR 56,15,0
Mvva 192,36,4
Mvva 196,32,8
TR 58,15,4096
Mvva 196,36,12
s_add_u32 s26, s26, 458752
Mvva 200,32,16
TR 60,15,8192
Mvva 200,36,20
Mvva 204,32,24
TR 62,15,12288
Mvva 204,36,28
WL 8
Mvva 208,40,0
TR 32,16,0
Mvva 208,44,4
buffer_load_dwordx4 a[64:67], v28, s[8:11], s24 offen offset:0 sc1
Mvva 212,40,8
TR 34,16,4096
Mvva 212,44,12
Mvva 216,40,16
TR 36,16,8192
Mvva 216,44,20
buffer_load_dwordx4 a[68:71], v28, s[8:11], s24 offen offset:1024 sc1
Mvva 220,40,24
TR 38,16,12288
Mvva 220,44,28
WL 8
Mava 128,48,0
TR 40,17,0
Mava 128,52,4
Mava 132,48,8
TR 42,17,4096
Mava 132,52,12
buffer_load_dwordx4 a[72:75], v29, s[8:11], s24 offen offset:0 sc1
Mava 136,48,16
TR 44,17,8192
Mava 136,52,20
Mava 140,48,24
TR 46,17,12288
Mava 140,52,28
WL 8
Mava 144,56,0
TR 48,18,0
Mava 144,60,4
buffer_load_dwordx4 a[76:79], v29, s[8:11], s24 offen offset:1024 sc1
Mava 148,56,8
TR 50,18,4096
Mava 148,60,12
Mava 152,56,16
TR 52,18,8192
Mava 152,60,20
buffer_load_dwordx4 a[80:83], v30, s[8:11], s24 offen offset:0 sc1
Mava 156,56,24
TR 54,18,12288
Mava 156,60,28
WL 8
Mava 160,32,0
TR 56,19,0
Mava 160,36,4
Mava 164,32,8
TR 58,19,4096
Mava 164,36,12
buffer_load_dwordx4 a[84:87], v30, s[8:11], s24 offen offset:1024 sc1
Mava 168,32,16
TR 60,19,8192
Mava 168,36,20
Mava 172,32,24
TR 62,19,12288
Mava 172,36,28
WL 8
Mava 176,40,0
TR 32,20,0
Mava 176,44,4
buffer_load_dwordx4 a[88:91], v31, s[8:11], s24 offen offset:0 sc1
Mava 180,40,8
TR 34,20,4096
Mava 180,44,12
Mava 184,40,16
TR 36,20,8192
Mava 184,44,20
buffer_load_dwordx4 a[92:95], v31, s[8:11], s24 offen offset:1024 sc1
Mava 188,40,24
TR 38,20,12288
Mava 188,44,28
WL 8
Mava 192,48,0
TR 40,21,0
Mava 192,52,4
Mava 196,48,8
TR 42,21,4096
Mava 196,52,12
s_add_u32 s24, s24, 2048
Mava 200,48,16
TR 44,21,8192
Mava 200,52,20
Mava 204,48,24
TR 46,21,12288
Mava 204,52,28
WL 8
s_waitcnt vmcnt(16)
s_barrier
Mava 208,56,0
TR 48,8,16384
Mava 208,60,4
s_add_u32 m0, s27, 49152
Mava 212,56,8
TR 50,8,20480
Mava 212,60,12
DM 24,12,25,0
Mava 216,56,16
TR 52,8,24576
Mava 216,60,20
Mava 220,56,24
TR 54,8,28672
Mava 220,60,28
WL 8
Mava 224,32,0
TR 56,9,16384
Mava 224,36,4
DM 25,12,25,1024
Mava 228,32,8
TR 58,9,20480
Mava 228,36,12
Mava 232,32,16
TR 60,9,24576
Mava 232,36,20
DM 26,12,25,2048
Mava 236,32,24
TR 62,9,28672
Mava 236,36,28
WL 8
Mava 240,40,0
TR 32,10,16384
Mava 240,44,4
Mava 244,40,8
TR 34,10,20480
Mava 244,44,12
DM 27,12,25,3072
Mava 248,40,16
TR 36,10,24576
Mava 248,44,20
Mava 252,40,24
TR 38,10,28672
Mava 252,44,28
WL 8
Mvva 128,48,32
TR 40,11,16384
Mvva 128,52,36
s_add_u32 s25, s25, 458752
Mvva 132,48,40
TR 42,11,20480
Mvva 132,52,44
Mvva 136,48,48
TR 44,11,24576
Mvva 136,52,52
s_add_u32 m0, s27, 114688
Mvva 140,48,56
TR 46,11,28672
Mvva 140,52,60
WL 8
Mvva 144,56,32
TR 48,12,16384
Mvva 144,60,36
Mvva 148,56,40
TR 50,12,20480
Mvva 148,60,44
DM 116,12,26,0
Mvva 152,56,48
TR 52,12,24576
Mvva 152,60,52
Mvva 156,56,56
TR 54,12,28672
Mvva 156,60,60
WL 8
Mvva 160,32,32
TR 56,13,16384
Mvva 160,36,36
DM 117,12,26,1024
Mvva 164,32,40
TR 58,13,20480
Mvva 164,36,44
Mvva 168,32,48
TR 60,13,24576
Mvva 168,36,52
DM 118,12,26,2048
Mvva 172,32,56
TR 62,13,28672
Mvva 172,36,60
WL 8
Mvva 176,40,32
TR 32,14,16384
Mvva 176,44,36
Mvva 180,40,40
TR 34,14,20480
Mvva 180,44,44
DM 119,12,26,3072
Mvva 184,40,48
TR 36,14,24576
Mvva 184,44,52
Mvva 188,40,56
TR 38,14,28672
Mvva 188,44,60
WL 8
Mvva 192,48,32
TR 40,15,16384
Mvva 192,52,36
s_add_u32 s26, s26, 458752
Mvva 196,48,40
TR 42,15,20480
Mvva 196,52,44
buffer_load_dwordx4 a[96:99], v28, s[8:11], s24 offen offset:0 sc1
Mvva 200,48,48
TR 44,15,24576
Mvva 200,52,52
Mvva 204,48,56
TR 46,15,28672
Mvva 204,52,60
WL 8
Mvva 208,56,32
TR 48,16,16384
Mvva 208,60,36
buffer_load_dwordx4 a[100:103], v28, s[8:11], s24 offen offset:1024 sc1
Mvva 212,56,40
TR 50,16,20480
Mvva 212,60,44
Mvva 216,56,48
TR 52,16,24576
Mvva 216,60,52
buffer_load_dwordx4 a[104:107], v29, s[8:11], s24 offen offset:0 sc1
Mvva 220,56,56
TR 54,16,28672
Mvva 220,60,60
WL 8
Mava 128,32,32
TR 56,17,16384
Mava 128,36,36
Mava 132,32,40
TR 58,17,20480
Mava 132,36,44
buffer_load_dwordx4 a[108:111], v29, s[8:11], s24 offen offset:1024 sc1
Mava 136,32,48
TR 60,17,24576
Mava 136,36,52
Mava 140,32,56
TR 62,17,28672
Mava 140,36,60
WL 8
Mava 144,40,32
TR 32,18,16384
Mava 144,44,36
buffer_load_dwordx4 a[112:115], v30, s[8:11], s24 offen offset:0 sc1
Mava 148,40,40
TR 34,18,20480
Mava 148,44,44
Mava 152,40,48
TR 36,18,24576
Mava 152,44,52
buffer_load_dwordx4 a[116:119], v30, s[8:11], s24 offen offset:1024 sc1
Mava 156,40,56
TR 38,18,28672
Mava 156,44,60
WL 8
Mava 160,48,32
TR 40,19,16384
Mava 160,52,36
Mava 164,48,40
TR 42,19,20480
Mava 164,52,44
buffer_load_dwordx4 a[120:123], v31, s[8:11], s24 offen offset:0 sc1
Mava 168,48,48
TR 44,19,24576
Mava 168,52,52
Mava 172,48,56
TR 46,19,28672
Mava 172,52,60
WL 8
Mava 176,56,32
TR 48,20,16384
Mava 176,60,36
buffer_load_dwordx4 a[124:127], v31, s[8:11], s24 offen offset:1024 sc1
Mava 180,56,40
TR 50,20,20480
Mava 180,60,44
Mava 184,56,48
TR 52,20,24576
Mava 184,60,52
s_add_u32 s24, s24, 2048
Mava 188,56,56
TR 54,20,28672
Mava 188,60,60
WL 8
Mava 192,32,32
TR 56,21,16384
Mava 192,36,36
Mava 196,32,40
TR 58,21,20480
Mava 196,36,44
buffer_load_dword v115, v113, s[44:47], 0 offen sc1
Mava 200,32,48
TR 60,21,24576
Mava 200,36,52
Mava 204,32,56
TR 62,21,28672
Mava 204,36,60
WL 8
s_waitcnt vmcnt(0)
s_barrier
v_cmp_ne_u32 vcc, 8, v115
s_nop 1
s_cbranch_vccnz B3_cs_w
B3_cs_k:
Mava 208,40,32
TR 32,8,32768
Mava 208,44,36
buffer_load_dwordx2 v[96:97], v112, s[20:23], s40 offen offset:0 sc1
Mava 212,40,40
TR 34,8,36864
Mava 212,44,44
buffer_load_dwordx2 v[98:99], v112, s[20:23], s40 offen offset:128 sc1
Mava 216,40,48
TR 36,8,40960
Mava 216,44,52
Mava 220,40,56
TR 38,8,45056
Mava 220,44,60
WL 8
Mava 224,48,32
TR 40,9,32768
Mava 224,52,36
buffer_load_dwordx2 v[100:101], v112, s[20:23], s40 offen offset:1024 sc1
Mava 228,48,40
TR 42,9,36864
Mava 228,52,44
Mava 232,48,48
TR 44,9,40960
Mava 232,52,52
buffer_load_dwordx2 v[102:103], v112, s[20:23], s40 offen offset:1152 sc1
Mava 236,48,56
TR 46,9,45056
Mava 236,52,60
WL 8
Mava 240,56,32
TR 48,10,32768
Mava 240,60,36
Mava 244,56,40
TR 50,10,36864
Mava 244,60,44
buffer_load_dwordx2 v[104:105], v112, s[20:23], s40 offen offset:2048 sc1
Mava 248,56,48
TR 52,10,40960
Mava 248,60,52
buffer_load_dwordx2 v[106:107], v112, s[20:23], s40 offen offset:2176 sc1
Mava 252,56,56
TR 54,10,45056
Mava 252,60,60
WL 8
Mvva 128,32,64
TR 56,11,32768
Mvva 128,36,68
Mvva 132,32,72
TR 58,11,36864
Mvva 132,36,76
buffer_load_dwordx2 v[108:109], v112, s[20:23], s40 offen offset:3072 sc1
Mvva 136,32,80
TR 60,11,40960
Mvva 136,36,84
Mvva 140,32,88
TR 62,11,45056
Mvva 140,36,92
WL 8
Mvva 144,40,64
TR 32,12,32768
Mvva 144,44,68
buffer_load_dwordx2 v[110:111], v112, s[20:23], s40 offen offset:3200 sc1
Mvva 148,40,72
TR 34,12,36864
Mvva 148,44,76
Mvva 152,40,80
TR 36,12,40960
Mvva 152,44,84
buffer_load_dword v224, v121, s[28:31], s41 offen sc1
Mvva 156,40,88
TR 38,12,45056
Mvva 156,44,92
WL 8
Mvva 160,48,64
TR 40,13,32768
Mvva 160,52,68
s_add_u32 s41, s41, 14336
Mvva 164,48,72
TR 42,13,36864
Mvva 164,52,76
Mvva 168,48,80
TR 44,13,40960
Mvva 168,52,84
buffer_load_dword v225, v121, s[28:31], s41 offen sc1
Mvva 172,48,88
TR 46,13,45056
Mvva 172,52,92
WL 8
Mvva 176,56,64
TR 48,14,32768
Mvva 176,60,68
Mvva 180,56,72
TR 50,14,36864
Mvva 180,60,76
s_add_u32 s41, s41, 14336
Mvva 184,56,80
TR 52,14,40960
Mvva 184,60,84
Mvva 188,56,88
TR 54,14,45056
Mvva 188,60,92
WL 8
Mvva 192,32,64
TR 56,15,32768
Mvva 192,36,68
buffer_load_dword v226, v121, s[28:31], s41 offen sc1
Mvva 196,32,72
TR 58,15,36864
Mvva 196,36,76
s_add_u32 s41, s41, 14336
Mvva 200,32,80
TR 60,15,40960
Mvva 200,36,84
Mvva 204,32,88
TR 62,15,45056
Mvva 204,36,92
WL 8
Mvva 208,40,64
TR 32,16,32768
Mvva 208,44,68
buffer_load_dword v227, v121, s[28:31], s41 offen sc1
Mvva 212,40,72
TR 34,16,36864
Mvva 212,44,76
Mvva 216,40,80
TR 36,16,40960
Mvva 216,44,84
s_add_u32 s41, s41, 14336
Mvva 220,40,88
TR 38,16,45056
Mvva 220,44,92
WL 8
Mava 128,48,64
TR 40,17,32768
Mava 128,52,68
Mava 132,48,72
TR 42,17,36864
Mava 132,52,76
buffer_load_dword v228, v121, s[28:31], s41 offen sc1
Mava 136,48,80
TR 44,17,40960
Mava 136,52,84
s_add_u32 s41, s41, 14336
Mava 140,48,88
TR 46,17,45056
Mava 140,52,92
WL 8
Mava 144,56,64
TR 48,18,32768
Mava 144,60,68
Mava 148,56,72
TR 50,18,36864
Mava 148,60,76
buffer_load_dword v229, v121, s[28:31], s41 offen sc1
Mava 152,56,80
TR 52,18,40960
Mava 152,60,84
Mava 156,56,88
TR 54,18,45056
Mava 156,60,92
WL 8
Mava 160,32,64
TR 56,19,32768
Mava 160,36,68
s_add_u32 s41, s41, 14336
Mava 164,32,72
TR 58,19,36864
Mava 164,36,76
Mava 168,32,80
TR 60,19,40960
Mava 168,36,84
buffer_load_dword v230, v121, s[28:31], s41 offen sc1
Mava 172,32,88
TR 62,19,45056
Mava 172,36,92
WL 8
Mava 176,40,64
TR 32,20,32768
Mava 176,44,68
s_add_u32 s41, s41, 14336
Mava 180,40,72
TR 34,20,36864
Mava 180,44,76
Mava 184,40,80
TR 36,20,40960
Mava 184,44,84
buffer_load_dword v231, v121, s[28:31], s41 offen sc1
Mava 188,40,88
TR 38,20,45056
Mava 188,44,92
WL 8
Mava 192,48,64
TR 40,21,32768
Mava 192,52,68
Mava 196,48,72
TR 42,21,36864
Mava 196,52,76
s_add_u32 s41, s41, 14336
Mava 200,48,80
TR 44,21,40960
Mava 200,52,84
Mava 204,48,88
TR 46,21,45056
Mava 204,52,92
WL 8
s_waitcnt vmcnt(8)
s_barrier
Mava 208,56,64
TR 48,8,49152
v_add_f32 v2, v96, v98
v_mov_b32 v3, v2
Mava 208,60,68
s_nop 0
v_permlane16_swap_b32 v3, v2
Mava 212,56,72
TR 50,8,53248
v_add_f32 v2, v2, v3
Mava 212,60,76
v_mov_b32 v3, v2
Mava 216,56,80
TR 52,8,57344
v_permlane32_swap_b32 v3, v2
Mava 216,60,84
v_add_f32 v2, v2, v3
v_mul_f32 v2, 0x3e000000, v2
Mava 220,56,88
TR 54,8,61440
v_sub_f32 v3, v96, v2
Mava 220,60,92
WL 8
v_sub_f32 v4, v98, v2
Mava 224,32,64
TR 56,9,49152
v_mul_f32 v3, v3, v3
Mava 224,36,68
v_fmac_f32 v3, v4, v4
Mava 228,32,72
TR 58,9,53248
v_add_f32 v4, v97, v99
Mava 228,36,76
v_fmac_f32 v4, 0x43000000, v3
v_mov_b32 v3, v4
Mava 232,32,80
TR 60,9,57344
v_permlane16_swap_b32 v3, v4
Mava 232,36,84
v_add_f32 v4, v4, v3
Mava 236,32,88
TR 62,9,61440
v_mov_b32 v3, v4
Mava 236,36,92
WL 8
v_permlane32_swap_b32 v3, v4
Mava 240,40,64
TR 32,10,49152
v_add_f32 v4, v4, v3
v_mov_b32 v5, 0x3727c5ac
Mava 240,44,68
v_fmac_f32 v5, 0x3a800000, v4
Mava 244,40,72
TR 34,10,53248
v_rsq_f32 v6, v5
Mava 244,44,76
v_sqrt_f32 v70, v5
Mava 248,40,80
TR 36,10,57344
v_sub_f32 v64, 0, v2
Mava 248,44,84
v_mov_b32 v65, v64
Mava 252,40,88
TR 38,10,61440
v_mul_f32 v66, 0xc0135761, v6
v_mov_b32 v67, v66
Mava 252,44,92
WL 8
v_mul_f32 v7, v6, v6
Mvva 128,48,96
TR 40,11,49152
v_mul_f32 v7, v7, v6
Mvva 128,52,100
v_mul_f32 v68, 0xbdd2d3e8, v7
Mvva 132,48,104
TR 42,11,53248
v_mov_b32 v69, v68
Mvva 132,52,108
v_mov_b32 v71, v70
Mvva 136,48,112
TR 44,11,57344
v_add_f32 v2, v100, v102
v_mov_b32 v3, v2
Mvva 136,52,116
s_nop 0
v_permlane16_swap_b32 v3, v2
Mvva 140,48,120
TR 46,11,61440
v_add_f32 v2, v2, v3
Mvva 140,52,124
WL 8
v_mov_b32 v3, v2
Mvva 144,56,96
TR 48,12,49152
v_permlane32_swap_b32 v3, v2
Mvva 144,60,100
v_add_f32 v2, v2, v3
v_mul_f32 v2, 0x3e000000, v2
Mvva 148,56,104
TR 50,12,53248
v_sub_f32 v3, v100, v2
Mvva 148,60,108
v_sub_f32 v4, v102, v2
Mvva 152,56,112
TR 52,12,57344
v_mul_f32 v3, v3, v3
Mvva 152,60,116
v_fmac_f32 v3, v4, v4
Mvva 156,56,120
TR 54,12,61440
v_add_f32 v4, v101, v103
Mvva 156,60,124
WL 8
v_fmac_f32 v4, 0x43000000, v3
v_mov_b32 v3, v4
Mvva 160,32,96
TR 56,13,49152
v_permlane16_swap_b32 v3, v4
Mvva 160,36,100
v_add_f32 v4, v4, v3
Mvva 164,32,104
TR 58,13,53248
v_mov_b32 v3, v4
Mvva 164,36,108
s_nop 0
v_permlane32_swap_b32 v3, v4
Mvva 168,32,112
TR 60,13,57344
v_add_f32 v4, v4, v3
v_mov_b32 v5, 0x3727c5ac
Mvva 168,36,116
v_fmac_f32 v5, 0x3a800000, v4
Mvva 172,32,120
TR 62,13,61440
v_rsq_f32 v6, v5
Mvva 172,36,124
WL 8
v_sqrt_f32 v78, v5
Mvva 176,40,96
TR 32,14,49152
v_sub_f32 v72, 0, v2
Mvva 176,44,100
v_mov_b32 v73, v72
Mvva 180,40,104
TR 34,14,53248
v_mul_f32 v74, 0xc0135761, v6
v_mov_b32 v75, v74
Mvva 180,44,108
v_mul_f32 v7, v6, v6
Mvva 184,40,112
TR 36,14,57344
v_mul_f32 v7, v7, v6
Mvva 184,44,116
v_mul_f32 v76, 0xbdd2d3e8, v7
Mvva 188,40,120
TR 38,14,61440
v_mov_b32 v77, v76
Mvva 188,44,124
WL 8
v_mov_b32 v79, v78
Mvva 192,48,96
TR 40,15,49152
v_add_f32 v2, v104, v106
v_mov_b32 v3, v2
Mvva 192,52,100
s_nop 0
v_permlane16_swap_b32 v3, v2
Mvva 196,48,104
TR 42,15,53248
v_add_f32 v2, v2, v3
Mvva 196,52,108
v_mov_b32 v3, v2
Mvva 200,48,112
TR 44,15,57344
v_permlane32_swap_b32 v3, v2
Mvva 200,52,116
v_add_f32 v2, v2, v3
v_mul_f32 v2, 0x3e000000, v2
Mvva 204,48,120
TR 46,15,61440
v_sub_f32 v3, v104, v2
Mvva 204,52,124
WL 8
v_sub_f32 v4, v106, v2
Mvva 208,56,96
TR 48,16,49152
v_mul_f32 v3, v3, v3
Mvva 208,60,100
v_fmac_f32 v3, v4, v4
Mvva 212,56,104
TR 50,16,53248
v_add_f32 v4, v105, v107
Mvva 212,60,108
v_fmac_f32 v4, 0x43000000, v3
v_mov_b32 v3, v4
Mvva 216,56,112
TR 52,16,57344
v_permlane16_swap_b32 v3, v4
Mvva 216,60,116
v_add_f32 v4, v4, v3
Mvva 220,56,120
TR 54,16,61440
v_mov_b32 v3, v4
Mvva 220,60,124
WL 8
v_permlane32_swap_b32 v3, v4
Mava 128,32,96
TR 56,17,49152
v_add_f32 v4, v4, v3
v_mov_b32 v5, 0x3727c5ac
Mava 128,36,100
v_fmac_f32 v5, 0x3a800000, v4
Mava 132,32,104
TR 58,17,53248
v_rsq_f32 v6, v5
Mava 132,36,108
v_sqrt_f32 v86, v5
Mava 136,32,112
TR 60,17,57344
v_sub_f32 v80, 0, v2
Mava 136,36,116
v_mov_b32 v81, v80
Mava 140,32,120
TR 62,17,61440
v_mul_f32 v82, 0xc0135761, v6
v_mov_b32 v83, v82
Mava 140,36,124
WL 8
v_mul_f32 v7, v6, v6
Mava 144,40,96
TR 32,18,49152
v_mul_f32 v7, v7, v6
Mava 144,44,100
v_mul_f32 v84, 0xbdd2d3e8, v7
Mava 148,40,104
TR 34,18,53248
v_mov_b32 v85, v84
Mava 148,44,108
v_mov_b32 v87, v86
Mava 152,40,112
TR 36,18,57344
v_add_f32 v2, v108, v110
v_mov_b32 v3, v2
Mava 152,44,116
s_nop 0
v_permlane16_swap_b32 v3, v2
Mava 156,40,120
TR 38,18,61440
v_add_f32 v2, v2, v3
Mava 156,44,124
WL 8
v_mov_b32 v3, v2
Mava 160,48,96
TR 40,19,49152
v_permlane32_swap_b32 v3, v2
Mava 160,52,100
v_add_f32 v2, v2, v3
v_mul_f32 v2, 0x3e000000, v2
Mava 164,48,104
TR 42,19,53248
v_sub_f32 v3, v108, v2
Mava 164,52,108
v_sub_f32 v4, v110, v2
Mava 168,48,112
TR 44,19,57344
v_mul_f32 v3, v3, v3
Mava 168,52,116
v_fmac_f32 v3, v4, v4
Mava 172,48,120
TR 46,19,61440
v_add_f32 v4, v109, v111
Mava 172,52,124
WL 8
v_fmac_f32 v4, 0x43000000, v3
v_mov_b32 v3, v4
Mava 176,56,96
TR 48,20,49152
v_permlane16_swap_b32 v3, v4
Mava 176,60,100
v_add_f32 v4, v4, v3
Mava 180,56,104
TR 50,20,53248
v_mov_b32 v3, v4
Mava 180,60,108
s_nop 0
v_permlane32_swap_b32 v3, v4
Mava 184,56,112
TR 52,20,57344
v_add_f32 v4, v4, v3
v_mov_b32 v5, 0x3727c5ac
Mava 184,60,116
v_fmac_f32 v5, 0x3a800000, v4
Mava 188,56,120
TR 54,20,61440
v_rsq_f32 v6, v5
Mava 188,60,124
WL 8
v_sqrt_f32 v94, v5
Mava 192,32,96
TR 56,21,49152
v_sub_f32 v88, 0, v2
Mava 192,36,100
v_mov_b32 v89, v88
Mava 196,32,104
TR 58,21,53248
v_mul_f32 v90, 0xc0135761, v6
v_mov_b32 v91, v90
Mava 196,36,108
v_mul_f32 v7, v6, v6
Mava 200,32,112
TR 60,21,57344
v_mul_f32 v7, v7, v6
Mava 200,36,116
v_mul_f32 v92, 0xbdd2d3e8, v7
Mava 204,32,120
TR 62,21,61440
v_mov_b32 v93, v92
Mava 204,36,124
WL 8
v_mov_b32 v95, v94
Mava 208,40,96
Mava 208,44,100
Mava 212,40,104
Mava 212,44,108
Mava 216,40,112
Mava 216,44,116
Mava 220,40,120
Mava 220,44,124
WL 4
Mava 224,48,96
Mava 224,52,100
Mava 228,48,104
Mava 228,52,108
Mava 232,48,112
Mava 232,52,116
Mava 236,48,120
Mava 236,52,124
WL 0
Mava 240,56,96
Mava 240,60,100
Mava 244,56,104
Mava 244,60,108
Mava 248,56,112
Mava 248,60,116
Mava 252,56,120
Mava 252,60,124
B3_ep:
s_waitcnt vmcnt(0)
v_add_f32 v224, v224, v225
v_add_f32 v224, v224, v226
v_add_f32 v224, v224, v227
v_add_f32 v224, v224, v228
v_add_f32 v224, v224, v229
v_add_f32 v224, v224, v230
v_add_f32 v224, v224, v231
v_lshlrev_b32 v5, 2, v120
v_add_u32 v5, 0x20000, v5
ds_write_b32 v5, v224
v_lshrrev_b32 v2, 4, v1
v_lshlrev_b32 v2, 4, v2
v_add_u32 v2, 0x20000, v2
WL 0
s_barrier
RQ 96,2,0
RQ 100,2,64
RQ 104,2,128
RQ 108,2,192
RQ 112,2,256
RQ 116,2,320
s_mul_i32 s54, s39, 114688
s_mul_i32 s36, s34, 7168
s_add_u32 s54, s54, s36
s_add_u32 s55, s54, 4096
v_lshlrev_b32 v28, 4, v1
v_add_u32 v29, 114688, v28
v_add_u32 v30, 229376, v28
v_add_u32 v31, 344064, v28
s_mov_b32 s12, s92
s_mov_b32 s13, s93
s_mov_b32 s14, 8388608
s_mov_b32 s15, 0x20000
s_add_u32 s84, s4, 21495808
s_addc_u32 s85, s5, 0
s_mov_b32 s86, 32768
s_mov_b32 s87, 0x20000
v_lshrrev_b32 v36, 4, v1
s_lshl_b32 s36, s3, 4
v_add_u32 v37, s36, v36
v_mul_u32_u24 v37, 2048, v37
v_and_b32 v38, 15, v1
v_add_u32 v39, 0, v36
v_lshlrev_b32 v39, 1, v39
v_xor_b32 v39, v39, v38
v_lshl_add_u32 v39, v39, 4, v37
v_add_u32 v24, 0, v39
v_add_u32 v39, 4, v36
v_lshlrev_b32 v39, 1, v39
v_xor_b32 v39, v39, v38
v_lshl_add_u32 v39, v39, 4, v37
v_add_u32 v25, 7168, v39
v_add_u32 v39, 0, v36
v_lshlrev_b32 v39, 1, v39
v_xor_b32 v39, v39, v38
v_lshl_add_u32 v39, v39, 4, v37
v_add_u32 v26, 14336, v39
v_add_u32 v39, 4, v36
v_lshlrev_b32 v39, 1, v39
v_xor_b32 v39, v39, v38
v_lshl_add_u32 v39, v39, 4, v37
v_add_u32 v27, 21504, v39
s_and_b32 s50, s35, 6
s_lshr_b32 s36, s35, 6
s_add_u32 s50, s50, s36
s_lshl_b32 s50, s50, 7
s_add_u32 s51, s50, 25600
s_add_u32 s50, s50, 24576
s_lshr_b32 s37, s35, 3
s_and_b32 s37, s37, 7
s_lshl_b32 s37, s37, 8
s_and_b32 s38, s35, 1
s_mul_i32 s36, s38, 4194304
s_add_u32 s25, s37, s36
s_lshl_b32 s49, s33, 1
s_add_u32 s49, s49, s38
s_lshl_b32 s49, s49, 7
s_add_u32 s62, s49, 30720
s_add_u32 s49, s49, 26624
s_and_b32 s33, s35, 6
s_lshr_b32 s36, s35, 6
s_add_u32 s33, s33, s36
s_lshr_b32 s34, s35, 3
s_and_b32 s34, s34, 7
s_and_b32 s41, s35, 1
s_add_u32 s40, s41, 0
s_lshl_b32 s39, s33, 4
s_lshl_b32 s36, s3, 2
s_add_u32 s39, s39, s36
s_lshl_b32 s27, s3, 12
s_add_u32 s8, s4, 41943040
s_addc_u32 s9, s5, 0
s_mov_b32 s10, 16777216
s_mov_b32 s11, 0x20000
s_mul_i32 s24, s39, 131072
s_mul_i32 s36, s41, 65536
s_add_u32 s24, s24, s36
v_lshlrev_b32 v36, 4, v1
s_add_u32 s36, s40, 0
s_and_b32 s36, s36, 3
s_mul_i32 s36, s36, 131072
v_add_u32 v44, s36, v36
s_add_u32 s36, s40, 1
s_and_b32 s36, s36, 3
s_mul_i32 s36, s36, 131072
v_add_u32 v45, s36, v36
s_add_u32 s36, s40, 2
s_and_b32 s36, s36, 3
s_mul_i32 s36, s36, 131072
v_add_u32 v46, s36, v36
s_add_u32 s36, s40, 3
s_and_b32 s36, s36, 3
s_mul_i32 s36, s36, 131072
v_add_u32 v47, s36, v36
buffer_load_dword v40, off, s[84:87], s50 sc1
WL 0
PF 128,96,64,128
PF 130,98,64,130
PF 144,100,64,144
PF 146,102,64,146
PM 224,128,128
PM 226,130,130
PM 228,144,144
PM 230,146,146
PF 224,224,68,66
PF 226,226,68,66
PF 228,228,68,66
PF 230,230,68,66
PM 224,224,128
PM 226,226,130
PM 228,228,144
PM 230,230,146
EX 224
EX 225
PF 132,96,72,132
EX 226
PF 134,98,72,134
EX 227
PF 148,100,72,148
EX 228
PF 150,102,72,150
PF 224,224,70,70
EX 229
PM 232,132,132
PF 226,226,70,70
PM 234,134,134
EX 230
PM 236,148,148
EX 231
PM 238,150,150
RC 224
PF 228,228,70,70
PF 232,232,76,74
RC 225
PF 234,234,76,74
PF 230,230,70,70
PF 236,236,76,74
RC 226
PF 238,238,76,74
RC 227
RC 228
PM 232,232,132
RC 229
PM 234,234,134
RC 230
PM 236,236,148
RC 231
PM 238,238,150
EX 232
PM 128,128,224
EX 233
PM 130,130,226
EX 234
PM 144,144,228
EX 235
PM 146,146,230
CV 248,128,129
EX 236
CV 249,130,131
PF 232,232,78,78
CV 250,144,145
EX 237
CV 251,146,147
PF 234,234,78,78
buffer_store_dwordx4 v[248:251], v28, s[16:19], s54 offen offset:0 sc1
PF 136,96,80,136
EX 238
PF 138,98,80,138
EX 239
PF 152,100,80,152
RC 232
PF 154,102,80,154
PF 236,236,78,78
PM 240,136,136
PM 242,138,138
RC 233
PM 244,152,152
PF 238,238,78,78
PM 246,154,154
RC 234
PF 240,240,84,82
RC 235
PF 242,242,84,82
PF 244,244,84,82
RC 236
PF 246,246,84,82
RC 237
PM 240,240,136
RC 238
PM 242,242,138
RC 239
PM 244,244,152
PM 246,246,154
EX 240
PM 132,132,232
EX 241
PM 134,134,234
EX 242
PM 148,148,236
EX 243
PM 150,150,238
CV 252,132,133
EX 244
CV 253,134,135
PF 240,240,86,86
CV 254,148,149
EX 245
CV 255,150,151
PF 242,242,86,86
buffer_store_dwordx4 v[252:255], v29, s[16:19], s54 offen offset:0 sc1
PF 140,96,88,140
EX 246
PF 142,98,88,142
EX 247
PF 156,100,88,156
RC 240
PF 158,102,88,158
PF 244,244,86,86
PM 224,140,140
PM 226,142,142
RC 241
PM 228,156,156
PF 246,246,86,86
PM 230,158,158
RC 242
PF 224,224,92,90
RC 243
PF 226,226,92,90
PF 228,228,92,90
RC 244
PF 230,230,92,90
RC 245
PM 224,224,140
RC 246
PM 226,226,142
RC 247
PM 228,228,156
PM 230,230,158
EX 224
PM 136,136,240
EX 225
PM 138,138,242
EX 226
PM 152,152,244
EX 227
PM 154,154,246
CV 248,136,137
EX 228
CV 249,138,139
PF 224,224,94,94
CV 250,152,153
EX 229
CV 251,154,155
PF 226,226,94,94
buffer_store_dwordx4 v[248:251], v30, s[16:19], s54 offen offset:0 sc1
PF 160,104,64,160
EX 230
PF 162,106,64,162
EX 231
PF 176,108,64,176
RC 224
PF 178,110,64,178
PF 228,228,94,94
PM 232,160,160
PM 234,162,162
RC 225
PM 236,176,176
PF 230,230,94,94
PM 238,178,178
RC 226
PF 232,232,68,66
RC 227
PF 234,234,68,66
PF 236,236,68,66
RC 228
PF 238,238,68,66
RC 229
PM 232,232,160
RC 230
PM 234,234,162
RC 231
PM 236,236,176
PM 238,238,178
EX 232
PM 140,140,224
EX 233
PM 142,142,226
EX 234
PM 156,156,228
EX 235
PM 158,158,230
CV 252,140,141
EX 236
CV 253,142,143
PF 232,232,70,70
CV 254,156,157
EX 237
CV 255,158,159
PF 234,234,70,70
buffer_store_dwordx4 v[252:255], v31, s[16:19], s54 offen offset:0 sc1
PF 164,104,72,164
EX 238
PF 166,106,72,166
EX 239
PF 180,108,72,180
RC 232
PF 182,110,72,182
PF 236,236,70,70
PM 240,164,164
PM 242,166,166
RC 233
PM 244,180,180
PF 238,238,70,70
PM 246,182,182
RC 234
PF 240,240,76,74
RC 235
PF 242,242,76,74
PF 244,244,76,74
RC 236
PF 246,246,76,74
RC 237
PM 240,240,164
RC 238
PM 242,242,166
RC 239
PM 244,244,180
PM 246,246,182
EX 240
PM 160,160,232
EX 241
PM 162,162,234
PM 176,176,236
EX 242
PM 178,178,238
EX 243
CV 248,160,161
CV 249,162,163
EX 244
CV 250,176,177
CV 251,178,179
PF 240,240,78,78
buffer_store_dwordx4 v[248:251], v28, s[16:19], s54 offen offset:1024 sc1
EX 245
RQ 128,2,384
RQ 132,2,448
PF 242,242,78,78
RQ 136,2,512
RQ 140,2,576
EX 246
RQ 144,2,640
EX 247
RQ 148,2,704
RQ 152,2,768
RC 240
RQ 156,2,832
PF 168,104,80,168
PF 244,244,78,78
PF 170,106,80,170
RC 241
PF 184,108,80,184
PF 186,110,80,186
PF 246,246,78,78
PM 224,168,168
PM 226,170,170
RC 242
PM 228,184,184
RC 243
PM 230,186,186
PF 224,224,84,82
RC 244
PF 226,226,84,82
PF 228,228,84,82
RC 245
PF 230,230,84,82
RC 246
PM 224,224,168
PM 226,226,170
RC 247
PM 228,228,184
PM 230,230,186
EX 224
PM 164,164,240
EX 225
PM 166,166,242
EX 226
PM 180,180,244
EX 227
PM 182,182,246
CV 252,164,165
EX 228
CV 253,166,167
PF 224,224,86,86
CV 254,180,181
EX 229
CV 255,182,183
PF 226,226,86,86
buffer_store_dwordx4 v[252:255], v29, s[16:19], s54 offen offset:1024 sc1
PF 172,104,88,172
EX 230
PF 174,106,88,174
EX 231
PF 188,108,88,188
RC 224
PF 190,110,88,190
PF 228,228,86,86
PM 232,172,172
PM 234,174,174
RC 225
PM 236,188,188
PF 230,230,86,86
PM 238,190,190
RC 226
PF 232,232,92,90
RC 227
PF 234,234,92,90
PF 236,236,92,90
RC 228
PF 238,238,92,90
RC 229
PM 232,232,172
RC 230
PM 234,234,174
RC 231
PM 236,236,188
PM 238,238,190
EX 232
PM 168,168,224
EX 233
PM 170,170,226
EX 234
PM 184,184,228
EX 235
PM 186,186,230
CV 248,168,169
EX 236
CV 249,170,171
PF 232,232,94,94
CV 250,184,185
EX 237
CV 251,186,187
PF 234,234,94,94
buffer_store_dwordx4 v[248:251], v30, s[16:19], s54 offen offset:1024 sc1
PF 192,112,64,192
EX 238
PF 194,114,64,194
EX 239
PF 208,116,64,208
RC 232
PF 210,118,64,210
PF 236,236,94,94
PM 240,192,192
PM 242,194,194
RC 233
PM 244,208,208
PF 238,238,94,94
PM 246,210,210
RC 234
PF 240,240,68,66
RC 235
PF 242,242,68,66
PF 244,244,68,66
RC 236
PF 246,246,68,66
RC 237
PM 240,240,192
RC 238
PM 242,242,194
RC 239
PM 244,244,208
PM 246,246,210
EX 240
PM 172,172,232
EX 241
PM 174,174,234
EX 242
PM 188,188,236
EX 243
PM 190,190,238
CV 252,172,173
EX 244
CV 253,174,175
PF 240,240,70,70
CV 254,188,189
EX 245
CV 255,190,191
PF 242,242,70,70
buffer_store_dwordx4 v[252:255], v31, s[16:19], s54 offen offset:1024 sc1
PF 196,112,72,196
EX 246
PF 198,114,72,198
EX 247
PF 212,116,72,212
RC 240
PF 214,118,72,214
PF 244,244,70,70
PM 224,196,196
PM 226,198,198
RC 241
PM 228,212,212
PF 246,246,70,70
PM 230,214,214
RC 242
PF 224,224,76,74
RC 243
PF 226,226,76,74
PF 228,228,76,74
RC 244
PF 230,230,76,74
RC 245
PM 224,224,196
RC 246
PM 226,226,198
RC 247
PM 228,228,212
PM 230,230,214
EX 224
PM 192,192,240
EX 225
PM 194,194,242
EX 226
PM 208,208,244
EX 227
PM 210,210,246
CV 248,192,193
EX 228
CV 249,194,195
PF 224,224,78,78
CV 250,208,209
EX 229
CV 251,210,211
PF 226,226,78,78
buffer_store_dwordx4 v[248:251], v28, s[16:19], s54 offen offset:2048 sc1
PF 200,112,80,200
EX 230
PF 202,114,80,202
EX 231
PF 216,116,80,216
RC 224
PF 218,118,80,218
PF 228,228,78,78
PM 232,200,200
PM 234,202,202
RC 225
PM 236,216,216
PF 230,230,78,78
PM 238,218,218
RC 226
PF 232,232,84,82
RC 227
PF 234,234,84,82
PF 236,236,84,82
RC 228
PF 238,238,84,82
RC 229
PM 232,232,200
RC 230
PM 234,234,202
RC 231
PM 236,236,216
PM 238,238,218
EX 232
PM 196,196,224
EX 233
PM 198,198,226
EX 234
PM 212,212,228
EX 235
PM 214,214,230
CV 252,196,197
EX 236
CV 253,198,199
PF 232,232,86,86
CV 254,212,213
EX 237
CV 255,214,215
PF 234,234,86,86
buffer_store_dwordx4 v[252:255], v29, s[16:19], s54 offen offset:2048 sc1
PF 204,112,88,204
EX 238
PF 206,114,88,206
EX 239
PF 220,116,88,220
RC 232
PF 222,118,88,222
PF 236,236,86,86
PM 240,204,204
PM 242,206,206
RC 233
PM 244,220,220
PF 238,238,86,86
PM 246,222,222
RC 234
PF 240,240,92,90
RC 235
PF 242,242,92,90
PF 244,244,92,90
RC 236
PF 246,246,92,90
RC 237
PM 240,240,204
RC 238
PM 242,242,206
RC 239
PM 244,244,220
PM 246,246,222
EX 240
PM 200,200,232
EX 241
PM 202,202,234
PM 216,216,236
EX 242
PM 218,218,238
CV 248,200,201
EX 243
CV 249,202,203
EX 244
CV 250,216,217
CV 251,218,219
PF 240,240,94,94
buffer_store_dwordx4 v[248:251], v30, s[16:19], s54 offen offset:2048 sc1
WL 0
EX 245
AR 160,128
PF 242,242,94,94
AR 161,129
AR 162,130
EX 246
AR 163,131
AR 164,144
EX 247
AR 165,145
AR 166,146
RC 240
AR 167,147
PF 244,244,94,94
PF 160,128,64,160
PF 162,130,64,162
RC 241
PF 164,132,64,164
PF 166,134,64,166
PF 246,246,94,94
PM 224,160,160
RC 242
PM 226,162,162
PM 228,164,164
RC 243
PM 230,166,166
PF 224,224,68,66
RC 244
PF 226,226,68,66
RC 245
PF 228,228,68,66
PF 230,230,68,66
RC 246
PM 224,224,160
PM 226,226,162
RC 247
PM 228,228,164
PM 230,230,166
EX 224
PM 204,204,240
EX 225
PM 206,206,242
PM 220,220,244
EX 226
PM 222,222,246
EX 227
CV 252,204,205
CV 253,206,207
EX 228
CV 254,220,221
CV 255,222,223
PF 224,224,70,70
buffer_store_dwordx4 v[252:255], v31, s[16:19], s54 offen offset:2048 sc1
EX 229
AR 168,132
AR 169,133
PF 226,226,70,70
AR 170,134
AR 171,135
EX 230
AR 172,148
EX 231
AR 173,149
AR 174,150
RC 224
AR 175,151
PF 168,128,72,168
PF 228,228,70,70
PF 170,130,72,170
RC 225
PF 172,132,72,172
PF 174,134,72,174
PF 230,230,70,70
PM 232,168,168
PM 234,170,170
RC 226
PM 236,172,172
RC 227
PM 238,174,174
PF 232,232,76,74
RC 228
PF 234,234,76,74
PF 236,236,76,74
RC 229
PF 238,238,76,74
RC 230
PM 232,232,168
PM 234,234,170
RC 231
PM 236,236,172
PM 238,238,174
EX 232
PM 160,160,224
EX 233
PM 162,162,226
PM 164,164,228
EX 234
PM 166,166,230
EX 235
CV 248,160,161
CV 249,162,163
EX 236
CV 250,164,165
CV 251,166,167
PF 232,232,78,78
buffer_store_dwordx4 v[248:251], v28, s[16:19], s54 offen offset:3072 sc1
EX 237
AR 176,136
AR 177,137
PF 234,234,78,78
AR 178,138
AR 179,139
EX 238
AR 180,152
EX 239
AR 181,153
AR 182,154
RC 232
AR 183,155
PF 176,128,80,176
PF 236,236,78,78
PF 178,130,80,178
RC 233
PF 180,132,80,180
PF 182,134,80,182
PF 238,238,78,78
PM 240,176,176
PM 242,178,178
RC 234
PM 244,180,180
RC 235
PM 246,182,182
PF 240,240,84,82
RC 236
PF 242,242,84,82
PF 244,244,84,82
RC 237
PF 246,246,84,82
RC 238
PM 240,240,176
PM 242,242,178
RC 239
PM 244,244,180
PM 246,246,182
EX 240
PM 168,168,232
EX 241
PM 170,170,234
PM 172,172,236
EX 242
PM 174,174,238
EX 243
CV 252,168,169
CV 253,170,171
EX 244
CV 254,172,173
CV 255,174,175
PF 240,240,86,86
buffer_store_dwordx4 v[252:255], v29, s[16:19], s54 offen offset:3072 sc1
EX 245
AR 160,140
AR 161,141
PF 242,242,86,86
AR 162,142
AR 163,143
EX 246
AR 164,156
EX 247
AR 165,157
AR 166,158
RC 240
AR 167,159
PF 160,128,88,160
PF 244,244,86,86
PF 162,130,88,162
RC 241
PF 164,132,88,164
PF 166,134,88,166
PF 246,246,86,86
PM 224,160,160
PM 226,162,162
RC 242
PM 228,164,164
RC 243
PM 230,166,166
PF 224,224,92,90
RC 244
PF 226,226,92,90
PF 228,228,92,90
RC 245
PF 230,230,92,90
RC 246
PM 224,224,160
PM 226,226,162
RC 247
PM 228,228,164
PM 230,230,166
EX 224
PM 176,176,240
EX 225
PM 178,178,242
PM 180,180,244
EX 226
PM 182,182,246
EX 227
CV 248,176,177
CV 249,178,179
EX 228
CV 250,180,181
CV 251,182,183
PF 224,224,94,94
buffer_store_dwordx4 v[248:251], v30, s[16:19], s54 offen offset:3072 sc1
EX 229
AR 168,160
AR 169,161
PF 226,226,94,94
AR 170,162
AR 171,163
EX 230
AR 172,176
EX 231
AR 173,177
AR 174,178
RC 224
AR 175,179
PF 168,136,64,168
PF 228,228,94,94
PF 170,138,64,170
RC 225
PF 172,140,64,172
PF 174,142,64,174
PF 230,230,94,94
PM 232,168,168
PM 234,170,170
RC 226
PM 236,172,172
RC 227
PM 238,174,174
PF 232,232,68,66
RC 228
PF 234,234,68,66
PF 236,236,68,66
RC 229
PF 238,238,68,66
RC 230
PM 232,232,168
PM 234,234,170
RC 231
PM 236,236,172
PM 238,238,174
EX 232
PM 160,160,224
EX 233
PM 162,162,226
PM 164,164,228
EX 234
PM 166,166,230
EX 235
CV 252,160,161
CV 253,162,163
EX 236
CV 254,164,165
CV 255,166,167
PF 232,232,70,70
buffer_store_dwordx4 v[252:255], v31, s[16:19], s54 offen offset:3072 sc1
s_waitcnt vmcnt(4)
s_barrier
s_cmp_lg_u32 s3, 0
s_cbranch_scc1 B3_sg0
s_mov_b64 exec, 1
v_mov_b32 v3, 1
buffer_atomic_add v3, off, s[84:87], s49 sc1
s_mov_b64 exec, -1
B3_sg0:
v_cmp_ne_u32 vcc, 16, v40
s_nop 1
s_cbranch_vccnz A2_f0_w
A2_f0_k:
EX 237
AR 176,164
AR 177,165
PF 234,234,70,70
AR 178,166
AR 179,167
EX 238
AR 180,180
EX 239
AR 181,181
AR 182,182
RC 232
AR 183,183
PF 176,136,72,176
PF 236,236,70,70
PF 178,138,72,178
s_add_u32 m0, s27, 0
RC 233
PF 180,140,72,180
PF 182,142,72,182
PF 238,238,70,70
PM 240,176,176
PM 242,178,178
RC 234
PM 244,180,180
RC 235
PM 246,182,182
PF 240,240,76,74
RC 236
PF 242,242,76,74
PF 244,244,76,74
RC 237
PF 246,246,76,74
DM 24,12,25,0
RC 238
PM 240,240,176
PM 242,242,178
RC 239
PM 244,244,180
PM 246,246,182
EX 240
PM 168,168,232
EX 241
PM 170,170,234
PM 172,172,236
EX 242
PM 174,174,238
EX 243
CV 248,168,169
CV 249,170,171
DM 25,12,25,1024
EX 244
CV 250,172,173
CV 251,174,175
PF 240,240,78,78
buffer_store_dwordx4 v[248:251], v28, s[16:19], s55 offen offset:0 sc1
EX 245
AR 160,168
AR 161,169
PF 242,242,78,78
AR 162,170
AR 163,171
EX 246
AR 164,184
EX 247
AR 165,185
AR 166,186
DM 26,12,25,2048
RC 240
AR 167,187
PF 160,136,80,160
PF 244,244,78,78
PF 162,138,80,162
RC 241
PF 164,140,80,164
PF 166,142,80,166
PF 246,246,78,78
PM 224,160,160
PM 226,162,162
RC 242
PM 228,164,164
RC 243
PM 230,166,166
PF 224,224,84,82
DM 27,12,25,3072
RC 244
PF 226,226,84,82
PF 228,228,84,82
RC 245
PF 230,230,84,82
RC 246
PM 224,224,160
PM 226,226,162
RC 247
PM 228,228,164
PM 230,230,166
EX 224
PM 176,176,240
EX 225
PM 178,178,242
PM 180,180,244
s_add_u32 s25, s25, 131072
EX 226
PM 182,182,246
EX 227
CV 252,176,177
CV 253,178,179
EX 228
CV 254,180,181
CV 255,182,183
PF 224,224,86,86
buffer_store_dwordx4 v[252:255], v29, s[16:19], s55 offen offset:0 sc1
EX 229
AR 168,172
AR 169,173
PF 226,226,86,86
AR 170,174
AR 171,175
buffer_load_dwordx4 a[0:3], v44, s[8:11], s24 offen offset:0 sc1
EX 230
AR 172,188
EX 231
AR 173,189
AR 174,190
RC 224
AR 175,191
PF 168,136,88,168
PF 228,228,86,86
PF 170,138,88,170
RC 225
PF 172,140,88,172
PF 174,142,88,174
PF 230,230,86,86
PM 232,168,168
buffer_load_dwordx4 a[4:7], v44, s[8:11], s24 offen offset:1024 sc1
PM 234,170,170
RC 226
PM 236,172,172
RC 227
PM 238,174,174
PF 232,232,92,90
RC 228
PF 234,234,92,90
PF 236,236,92,90
RC 229
PF 238,238,92,90
RC 230
PM 232,232,168
PM 234,234,170
RC 231
PM 236,236,172
buffer_load_dwordx4 a[8:11], v45, s[8:11], s24 offen offset:0 sc1
PM 238,238,174
EX 232
PM 160,160,224
EX 233
PM 162,162,226
PM 164,164,228
EX 234
PM 166,166,230
EX 235
CV 248,160,161
CV 249,162,163
EX 236
CV 250,164,165
CV 251,166,167
PF 232,232,94,94
buffer_store_dwordx4 v[248:251], v30, s[16:19], s55 offen offset:0 sc1
buffer_load_dwordx4 a[12:15], v45, s[8:11], s24 offen offset:1024 sc1
EX 237
AR 176,192
AR 177,193
PF 234,234,94,94
AR 178,194
AR 179,195
EX 238
AR 180,208
EX 239
AR 181,209
AR 182,210
RC 232
AR 183,211
PF 176,144,64,176
PF 236,236,94,94
PF 178,146,64,178
buffer_load_dwordx4 a[16:19], v46, s[8:11], s24 offen offset:0 sc1
RC 233
PF 180,148,64,180
PF 182,150,64,182
PF 238,238,94,94
PM 240,176,176
PM 242,178,178
RC 234
PM 244,180,180
RC 235
PM 246,182,182
PF 240,240,68,66
RC 236
PF 242,242,68,66
PF 244,244,68,66
RC 237
PF 246,246,68,66
buffer_load_dwordx4 a[20:23], v46, s[8:11], s24 offen offset:1024 sc1
RC 238
PM 240,240,176
PM 242,242,178
RC 239
PM 244,244,180
PM 246,246,182
EX 240
PM 168,168,232
EX 241
PM 170,170,234
PM 172,172,236
EX 242
PM 174,174,238
EX 243
CV 252,168,169
CV 253,170,171
buffer_load_dwordx4 a[24:27], v47, s[8:11], s24 offen offset:0 sc1
EX 244
CV 254,172,173
CV 255,174,175
PF 240,240,70,70
buffer_store_dwordx4 v[252:255], v31, s[16:19], s55 offen offset:0 sc1
EX 245
AR 160,196
AR 161,197
PF 242,242,70,70
AR 162,198
AR 163,199
EX 246
AR 164,212
EX 247
AR 165,213
AR 166,214
buffer_load_dwordx4 a[28:31], v47, s[8:11], s24 offen offset:1024 sc1
RC 240
AR 167,215
PF 160,144,72,160
PF 244,244,70,70
PF 162,146,72,162
RC 241
PF 164,148,72,164
PF 166,150,72,166
PF 246,246,70,70
PM 224,160,160
PM 226,162,162
RC 242
PM 228,164,164
RC 243
PM 230,166,166
s_add_u32 s24, s24, 2048
PF 224,224,76,74
RC 244
PF 226,226,76,74
PF 228,228,76,74
RC 245
PF 230,230,76,74
RC 246
PM 224,224,160
PM 226,226,162
RC 247
PM 228,228,164
PM 230,230,166
EX 224
PM 176,176,240
EX 225
PM 178,178,242
s_add_u32 m0, s27, 16384
PM 180,180,244
EX 226
PM 182,182,246
EX 227
CV 248,176,177
CV 249,178,179
EX 228
CV 250,180,181
CV 251,182,183
PF 224,224,78,78
buffer_store_dwordx4 v[248:251], v28, s[16:19], s55 offen offset:1024 sc1
EX 229
AR 168,200
AR 169,201
PF 226,226,78,78
AR 170,202
DM 24,12,25,0
AR 171,203
EX 230
AR 172,216
EX 231
AR 173,217
AR 174,218
RC 224
AR 175,219
PF 168,144,80,168
PF 228,228,78,78
PF 170,146,80,170
RC 225
PF 172,148,80,172
PF 174,150,80,174
PF 230,230,78,78
PM 232,168,168
DM 25,12,25,1024
PM 234,170,170
RC 226
PM 236,172,172
RC 227
PM 238,174,174
PF 232,232,84,82
RC 228
PF 234,234,84,82
PF 236,236,84,82
RC 229
PF 238,238,84,82
RC 230
PM 232,232,168
PM 234,234,170
RC 231
PM 236,236,172
DM 26,12,25,2048
PM 238,238,174
EX 232
PM 160,160,224
EX 233
PM 162,162,226
PM 164,164,228
EX 234
PM 166,166,230
EX 235
CV 252,160,161
CV 253,162,163
EX 236
CV 254,164,165
CV 255,166,167
PF 232,232,86,86
buffer_store_dwordx4 v[252:255], v29, s[16:19], s55 offen offset:1024 sc1
DM 27,12,25,3072
EX 237
AR 176,204
AR 177,205
PF 234,234,86,86
AR 178,206
AR 179,207
EX 238
AR 180,220
EX 239
AR 181,221
AR 182,222
RC 232
AR 183,223
PF 176,144,88,176
PF 236,236,86,86
PF 178,146,88,178
s_add_u32 s25, s25, 393216
RC 233
PF 180,148,88,180
PF 182,150,88,182
PF 238,238,86,86
PM 240,176,176
PM 242,178,178
RC 234
PM 244,180,180
RC 235
PM 246,182,182
PF 240,240,92,90
RC 236
PF 242,242,92,90
PF 244,244,92,90
RC 237
PF 246,246,92,90
buffer_load_dwordx4 a[32:35], v44, s[8:11], s24 offen offset:0 sc1
RC 238
PM 240,240,176
PM 242,242,178
RC 239
PM 244,244,180
PM 246,246,182
EX 240
PM 168,168,232
EX 241
PM 170,170,234
PM 172,172,236
EX 242
PM 174,174,238
EX 243
CV 248,168,169
buffer_load_dwordx4 a[36:39], v44, s[8:11], s24 offen offset:1024 sc1
CV 249,170,171
EX 244
CV 250,172,173
CV 251,174,175
PF 240,240,94,94
buffer_store_dwordx4 v[248:251], v30, s[16:19], s55 offen offset:1024 sc1
EX 245
AR 160,224
AR 161,225
PF 242,242,94,94
AR 162,226
AR 163,227
EX 246
AR 164,240
EX 247
AR 165,241
buffer_load_dwordx4 a[40:43], v45, s[8:11], s24 offen offset:0 sc1
AR 166,242
RC 240
AR 167,243
PF 160,152,64,160
PF 244,244,94,94
PF 162,154,64,162
RC 241
PF 164,156,64,164
PF 166,158,64,166
PF 246,246,94,94
PM 224,160,160
PM 226,162,162
RC 242
PM 228,164,164
RC 243
PM 230,166,166
buffer_load_dwordx4 a[44:47], v45, s[8:11], s24 offen offset:1024 sc1
PF 224,224,68,66
RC 244
PF 226,226,68,66
PF 228,228,68,66
RC 245
PF 230,230,68,66
RC 246
PM 224,224,160
PM 226,226,162
RC 247
PM 228,228,164
PM 230,230,166
EX 224
PM 176,176,240
EX 225
PM 178,178,242
buffer_load_dwordx4 a[48:51], v46, s[8:11], s24 offen offset:0 sc1
PM 180,180,244
EX 226
PM 182,182,246
EX 227
CV 252,176,177
CV 253,178,179
EX 228
CV 254,180,181
CV 255,182,183
PF 224,224,70,70
buffer_store_dwordx4 v[252:255], v31, s[16:19], s55 offen offset:1024 sc1
EX 229
AR 168,228
AR 169,229
PF 226,226,70,70
AR 170,230
buffer_load_dwordx4 a[52:55], v46, s[8:11], s24 offen offset:1024 sc1
AR 171,231
EX 230
AR 172,244
EX 231
AR 173,245
AR 174,246
RC 224
AR 175,247
PF 168,152,72,168
PF 228,228,70,70
PF 170,154,72,170
RC 225
PF 172,156,72,172
PF 174,158,72,174
PF 230,230,70,70
PM 232,168,168
buffer_load_dwordx4 a[56:59], v47, s[8:11], s24 offen offset:0 sc1
PM 234,170,170
RC 226
PM 236,172,172
RC 227
PM 238,174,174
PF 232,232,76,74
RC 228
PF 234,234,76,74
PF 236,236,76,74
RC 229
PF 238,238,76,74
RC 230
PM 232,232,168
PM 234,234,170
RC 231
PM 236,236,172
buffer_load_dwordx4 a[60:63], v47, s[8:11], s24 offen offset:1024 sc1
PM 238,238,174
EX 232
PM 160,160,224
EX 233
PM 162,162,226
PM 164,164,228
EX 234
PM 166,166,230
EX 235
CV 248,160,161
CV 249,162,163
EX 236
CV 250,164,165
CV 251,166,167
PF 232,232,78,78
s_add_u32 s24, s24, 6144
buffer_store_dwordx4 v[248:251], v28, s[16:19], s55 offen offset:2048 sc1
EX 237
AR 176,232
AR 177,233
PF 234,234,78,78
AR 178,234
AR 179,235
EX 238
AR 180,248
EX 239
AR 181,249
AR 182,250
RC 232
AR 183,251
PF 176,152,80,176
PF 236,236,78,78
PF 178,154,80,178
RC 233
PF 180,156,80,180
PF 182,158,80,182
PF 238,238,78,78
PM 240,176,176
PM 242,178,178
RC 234
PM 244,180,180
RC 235
PM 246,182,182
PF 240,240,84,82
RC 236
PF 242,242,84,82
PF 244,244,84,82
RC 237
PF 246,246,84,82
RC 238
PM 240,240,176
PM 242,242,178
RC 239
PM 244,244,180
PM 246,246,182
EX 240
PM 168,168,232
EX 241
PM 170,170,234
PM 172,172,236
EX 242
PM 174,174,238
EX 243
CV 252,168,169
CV 253,170,171
EX 244
CV 254,172,173
CV 255,174,175
PF 240,240,86,86
buffer_store_dwordx4 v[252:255], v29, s[16:19], s55 offen offset:2048 sc1
EX 245
AR 160,236
AR 161,237
PF 242,242,86,86
AR 162,238
AR 163,239
EX 246
AR 164,252
EX 247
AR 165,253
AR 166,254
RC 240
AR 167,255
PF 160,152,88,160
PF 244,244,86,86
PF 162,154,88,162
RC 241
PF 164,156,88,164
PF 166,158,88,166
PF 246,246,86,86
PM 224,160,160
PM 226,162,162
RC 242
PM 228,164,164
RC 243
PM 230,166,166
PF 224,224,92,90
RC 244
PF 226,226,92,90
PF 228,228,92,90
RC 245
PF 230,230,92,90
RC 246
PM 224,224,160
PM 226,226,162
RC 247
PM 228,228,164
PM 230,230,166
EX 224
EX 225
EX 226
PM 176,176,240
EX 227
EX 228
PM 178,178,242
PF 224,224,94,94
EX 229
PM 180,180,244
PF 226,226,94,94
EX 230
PM 182,182,246
EX 231
RC 224
PF 228,228,94,94
CV 248,176,177
RC 225
PF 230,230,94,94
CV 249,178,179
RC 226
RC 227
CV 250,180,181
RC 228
RC 229
CV 251,182,183
RC 230
RC 231
buffer_store_dwordx4 v[248:251], v30, s[16:19], s55 offen offset:2048 sc1
PM 160,160,224
PM 162,162,226
PM 164,164,228
PM 166,166,230
CV 252,160,161
CV 253,162,163
CV 254,164,165
CV 255,166,167
buffer_store_dwordx4 v[252:255], v31, s[16:19], s55 offen offset:2048 sc1
v_mov_b32 v64, v44
v_mov_b32 v65, v45
v_mov_b32 v66, v46
v_mov_b32 v67, v47
s_mov_b32 s20, s80
s_mov_b32 s21, s81
s_mov_b32 s22, 4194304
s_mov_b32 s23, 0x20000
s_add_u32 s28, s4, 12582912
s_addc_u32 s29, s5, 0
s_mov_b32 s30, 4194304
s_mov_b32 s31, 0x20000
s_add_u32 s88, s4, 67108864
s_addc_u32 s89, s5, 0
s_mov_b32 s90, 33554432
s_mov_b32 s91, 0x20000
v_lshrrev_b32 v2, 4, v1
v_and_b32 v3, 15, v1
v_add_u32 v4, 0, v2
v_xor_b32 v4, v4, v3
v_lshlrev_b32 v4, 4, v4
v_lshl_add_u32 v4, v2, 11, v4
v_add_u32 v90, 0, v4
v_add_u32 v4, 4, v2
v_xor_b32 v4, v4, v3
v_lshlrev_b32 v4, 4, v4
v_lshl_add_u32 v4, v2, 11, v4
v_add_u32 v91, 7168, v4
v_add_u32 v4, 8, v2
v_xor_b32 v4, v4, v3
v_lshlrev_b32 v4, 4, v4
v_lshl_add_u32 v4, v2, 11, v4
v_add_u32 v92, 14336, v4
v_add_u32 v4, 12, v2
v_xor_b32 v4, v4, v3
v_lshlrev_b32 v4, 4, v4
v_lshl_add_u32 v4, v2, 11, v4
v_add_u32 v93, 21504, v4
s_add_u32 s36, s39, s40
s_lshl_b32 s42, s36, 15
s_lshl_b32 s37, s34, 12
s_add_u32 s43, s42, s37
s_lshl_b32 s37, s34, 8
s_add_u32 s42, s42, s37
s_add_u32 s46, s27, 0x20000
v_lshlrev_b32 v88, 4, v1
s_lshl_b32 s36, s33, 3
s_add_u32 s36, s36, s34
s_lshl_b32 s47, s36, 8
s_lshl_b32 s78, s36, 19
s_add_u32 s78, s78, s27
v_lshrrev_b32 v2, 2, v1
v_and_b32 v3, 7, v2
v_lshlrev_b32 v2, 8, v2
v_and_b32 v4, 3, v1
v_lshl_add_u32 v2, v4, 3, v2
v_xor_b32 v4, 0, v3
v_lshl_add_u32 v8, v4, 5, v2
v_xor_b32 v4, 1, v3
v_lshl_add_u32 v9, v4, 5, v2
v_xor_b32 v4, 2, v3
v_lshl_add_u32 v10, v4, 5, v2
v_xor_b32 v4, 3, v3
v_lshl_add_u32 v11, v4, 5, v2
v_xor_b32 v4, 4, v3
v_lshl_add_u32 v12, v4, 5, v2
v_xor_b32 v4, 5, v3
v_lshl_add_u32 v13, v4, 5, v2
v_xor_b32 v4, 6, v3
v_lshl_add_u32 v14, v4, 5, v2
v_xor_b32 v4, 7, v3
v_lshl_add_u32 v15, v4, 5, v2
s_waitcnt vmcnt(13)
s_barrier
TR 32,8,0
TR 34,8,4096
TR 36,8,8192
TR 38,8,12288
TR 40,9,0
TR 42,9,4096
TR 44,9,8192
TR 46,9,12288
TR 48,10,0
TR 50,10,4096
TR 52,10,8192
TR 54,10,12288
WL 8
Zvva 128,32,0
TR 56,11,0
Mvva 128,36,4
s_add_u32 m0, s27, 32768
Zvva 132,32,8
TR 58,11,4096
Mvva 132,36,12
DM 24,12,25,0
Zvva 136,32,16
TR 60,11,8192
Mvva 136,36,20
DM 25,12,25,1024
Zvva 140,32,24
TR 62,11,12288
Mvva 140,36,28
WL 8
Zvva 144,40,0
TR 32,12,0
Mvva 144,44,4
DM 26,12,25,2048
Zvva 148,40,8
TR 34,12,4096
Mvva 148,44,12
DM 27,12,25,3072
Zvva 152,40,16
TR 36,12,8192
Mvva 152,44,20
s_add_u32 s25, s25, 131072
Zvva 156,40,24
TR 38,12,12288
Mvva 156,44,28
WL 8
Zvva 160,48,0
TR 40,13,0
Mvva 160,52,4
buffer_load_dwordx4 a[64:67], v64, s[8:11], s24 offen offset:0 sc1
Zvva 164,48,8
TR 42,13,4096
Mvva 164,52,12
buffer_load_dwordx4 a[68:71], v64, s[8:11], s24 offen offset:1024 sc1
Zvva 168,48,16
TR 44,13,8192
Mvva 168,52,20
buffer_load_dwordx4 a[72:75], v65, s[8:11], s24 offen offset:0 sc1
Zvva 172,48,24
TR 46,13,12288
Mvva 172,52,28
WL 8
Zvva 176,56,0
TR 48,14,0
Mvva 176,60,4
buffer_load_dwordx4 a[76:79], v65, s[8:11], s24 offen offset:1024 sc1
Zvva 180,56,8
TR 50,14,4096
Mvva 180,60,12
buffer_load_dwordx4 a[80:83], v66, s[8:11], s24 offen offset:0 sc1
Zvva 184,56,16
TR 52,14,8192
Mvva 184,60,20
buffer_load_dwordx4 a[84:87], v66, s[8:11], s24 offen offset:1024 sc1
Zvva 188,56,24
TR 54,14,12288
Mvva 188,60,28
WL 8
Zvva 192,32,0
TR 56,15,0
Mvva 192,36,4
buffer_load_dwordx4 a[88:91], v67, s[8:11], s24 offen offset:0 sc1
Zvva 196,32,8
TR 58,15,4096
Mvva 196,36,12
buffer_load_dwordx4 a[92:95], v67, s[8:11], s24 offen offset:1024 sc1
Zvva 200,32,16
TR 60,15,8192
Mvva 200,36,20
s_add_u32 s24, s24, 2048
Zvva 204,32,24
TR 62,15,12288
Mvva 204,36,28
WL 8
s_waitcnt vmcnt(12)
s_barrier
s_cmp_lg_u32 s3, 0
s_cbranch_scc1 B3_sg1
s_mov_b64 exec, 1
v_mov_b32 v3, 1
buffer_atomic_add v3, off, s[84:87], s62 sc1
s_mov_b64 exec, -1
B3_sg1:
Zvva 208,40,0
TR 32,8,16384
Mvva 208,44,4
s_add_u32 m0, s27, 49152
Zvva 212,40,8
TR 34,8,20480
Mvva 212,44,12
DM 24,12,25,0
Zvva 216,40,16
TR 36,8,24576
Mvva 216,44,20
DM 25,12,25,1024
Zvva 220,40,24
TR 38,8,28672
Mvva 220,44,28
WL 8
Zvva 224,48,0
TR 40,9,16384
Mvva 224,52,4
DM 26,12,25,2048
Zvva 228,48,8
TR 42,9,20480
Mvva 228,52,12
DM 27,12,25,3072
Zvva 232,48,16
TR 44,9,24576
Mvva 232,52,20
s_add_u32 s25, s25, 393216
Zvva 236,48,24
TR 46,9,28672
Mvva 236,52,28
WL 8
Zvva 240,56,0
TR 48,10,16384
Mvva 240,60,4
buffer_load_dwordx4 a[96:99], v64, s[8:11], s24 offen offset:0 sc1
Zvva 244,56,8
TR 50,10,20480
Mvva 244,60,12
buffer_load_dwordx4 a[100:103], v64, s[8:11], s24 offen offset:1024 sc1
Zvva 248,56,16
TR 52,10,24576
Mvva 248,60,20
buffer_load_dwordx4 a[104:107], v65, s[8:11], s24 offen offset:0 sc1
Zvva 252,56,24
TR 54,10,28672
Mvva 252,60,28
WL 8
Mvva 128,32,32
TR 56,11,16384
Mvva 128,36,36
buffer_load_dwordx4 a[108:111], v65, s[8:11], s24 offen offset:1024 sc1
Mvva 132,32,40
TR 58,11,20480
Mvva 132,36,44
buffer_load_dwordx4 a[112:115], v66, s[8:11], s24 offen offset:0 sc1
Mvva 136,32,48
TR 60,11,24576
Mvva 136,36,52
buffer_load_dwordx4 a[116:119], v66, s[8:11], s24 offen offset:1024 sc1
Mvva 140,32,56
TR 62,11,28672
Mvva 140,36,60
WL 8
Mvva 144,40,32
TR 32,12,16384
Mvva 144,44,36
buffer_load_dwordx4 a[120:123], v67, s[8:11], s24 offen offset:0 sc1
Mvva 148,40,40
TR 34,12,20480
Mvva 148,44,44
buffer_load_dwordx4 a[124:127], v67, s[8:11], s24 offen offset:1024 sc1
Mvva 152,40,48
TR 36,12,24576
Mvva 152,44,52
s_add_u32 s24, s24, 6144
Mvva 156,40,56
TR 38,12,28672
Mvva 156,44,60
WL 8
Mvva 160,48,32
TR 40,13,16384
Mvva 160,52,36
s_mov_b32 m0, s46
Mvva 164,48,40
TR 42,13,20480
Mvva 164,52,44
DM 90,20,42,0
Mvva 168,48,48
TR 44,13,24576
Mvva 168,52,52
DM 91,20,42,1024
Mvva 172,48,56
TR 46,13,28672
Mvva 172,52,60
WL 8
Mvva 176,56,32
TR 48,14,16384
Mvva 176,60,36
DM 92,20,42,2048
Mvva 180,56,40
TR 50,14,20480
Mvva 180,60,44
DM 93,20,42,3072
Mvva 184,56,48
TR 52,14,24576
Mvva 184,60,52
buffer_load_dwordx4 v[72:75], v88, s[28:31], s43 offen offset:0 sc1
Mvva 188,56,56
TR 54,14,28672
Mvva 188,60,60
WL 8
Mvva 192,32,32
TR 56,15,16384
Mvva 192,36,36
buffer_load_dwordx4 v[76:79], v88, s[28:31], s43 offen offset:1024 sc1
Mvva 196,32,40
TR 58,15,20480
Mvva 196,36,44
buffer_load_dwordx4 v[80:83], v88, s[28:31], s43 offen offset:2048 sc1
Mvva 200,32,48
TR 60,15,24576
Mvva 200,36,52
buffer_load_dwordx4 v[84:87], v88, s[28:31], s43 offen offset:3072 sc1
Mvva 204,32,56
TR 62,15,28672
Mvva 204,36,60
WL 8
s_waitcnt vmcnt(20)
s_barrier
Mvva 208,40,32
TR 32,8,32768
Mvva 208,44,36
s_add_u32 m0, s27, 0
Mvva 212,40,40
TR 34,8,36864
Mvva 212,44,44
DM 24,12,25,0
Mvva 216,40,48
TR 36,8,40960
Mvva 216,44,52
Mvva 220,40,56
TR 38,8,45056
Mvva 220,44,60
WL 8
Mvva 224,48,32
TR 40,9,32768
Mvva 224,52,36
DM 25,12,25,1024
Mvva 228,48,40
TR 42,9,36864
Mvva 228,52,44
DM 26,12,25,2048
Mvva 232,48,48
TR 44,9,40960
Mvva 232,52,52
Mvva 236,48,56
TR 46,9,45056
Mvva 236,52,60
WL 8
Mvva 240,56,32
TR 48,10,32768
Mvva 240,60,36
DM 27,12,25,3072
Mvva 244,56,40
TR 50,10,36864
Mvva 244,60,44
Mvva 248,56,48
TR 52,10,40960
Mvva 248,60,52
s_add_u32 s25, s25, 131072
Mvva 252,56,56
TR 54,10,45056
Mvva 252,60,60
WL 8
Mvva 128,32,64
TR 56,11,32768
Mvva 128,36,68
buffer_load_dwordx4 a[0:3], v64, s[8:11], s24 offen offset:0 sc1
Mvva 132,32,72
TR 58,11,36864
Mvva 132,36,76
Mvva 136,32,80
TR 60,11,40960
Mvva 136,36,84
buffer_load_dwordx4 a[4:7], v64, s[8:11], s24 offen offset:1024 sc1
Mvva 140,32,88
TR 62,11,45056
Mvva 140,36,92
WL 8
Mvva 144,40,64
TR 32,12,32768
Mvva 144,44,68
buffer_load_dwordx4 a[8:11], v65, s[8:11], s24 offen offset:0 sc1
Mvva 148,40,72
TR 34,12,36864
Mvva 148,44,76
Mvva 152,40,80
TR 36,12,40960
Mvva 152,44,84
buffer_load_dwordx4 a[12:15], v65, s[8:11], s24 offen offset:1024 sc1
Mvva 156,40,88
TR 38,12,45056
Mvva 156,44,92
WL 8
Mvva 160,48,64
TR 40,13,32768
Mvva 160,52,68
Mvva 164,48,72
TR 42,13,36864
Mvva 164,52,76
buffer_load_dwordx4 a[16:19], v66, s[8:11], s24 offen offset:0 sc1
Mvva 168,48,80
TR 44,13,40960
Mvva 168,52,84
buffer_load_dwordx4 a[20:23], v66, s[8:11], s24 offen offset:1024 sc1
Mvva 172,48,88
TR 46,13,45056
Mvva 172,52,92
WL 8
Mvva 176,56,64
TR 48,14,32768
Mvva 176,60,68
Mvva 180,56,72
TR 50,14,36864
Mvva 180,60,76
buffer_load_dwordx4 a[24:27], v67, s[8:11], s24 offen offset:0 sc1
Mvva 184,56,80
TR 52,14,40960
Mvva 184,60,84
buffer_load_dwordx4 a[28:31], v67, s[8:11], s24 offen offset:1024 sc1
Mvva 188,56,88
TR 54,14,45056
Mvva 188,60,92
WL 8
Mvva 192,32,64
TR 56,15,32768
Mvva 192,36,68
Mvva 196,32,72
TR 58,15,36864
Mvva 196,36,76
s_add_u32 s24, s24, 2048
Mvva 200,32,80
TR 60,15,40960
Mvva 200,36,84
Mvva 204,32,88
TR 62,15,45056
Mvva 204,36,92
WL 8
s_waitcnt vmcnt(20)
s_barrier
Mvva 208,40,64
TR 32,8,49152
Mvva 208,44,68
s_add_u32 m0, s27, 16384
Mvva 212,40,72
TR 34,8,53248
Mvva 212,44,76
DM 24,12,25,0
Mvva 216,40,80
TR 36,8,57344
Mvva 216,44,84
Mvva 220,40,88
TR 38,8,61440
Mvva 220,44,92
WL 8
Mvva 224,48,64
TR 40,9,49152
Mvva 224,52,68
DM 25,12,25,1024
Mvva 228,48,72
TR 42,9,53248
Mvva 228,52,76
DM 26,12,25,2048
Mvva 232,48,80
TR 44,9,57344
Mvva 232,52,84
Mvva 236,48,88
TR 46,9,61440
Mvva 236,52,92
WL 8
Mvva 240,56,64
TR 48,10,49152
Mvva 240,60,68
DM 27,12,25,3072
Mvva 244,56,72
TR 50,10,53248
Mvva 244,60,76
Mvva 248,56,80
TR 52,10,57344
Mvva 248,60,84
s_add_u32 s25, s25, 393216
Mvva 252,56,88
TR 54,10,61440
Mvva 252,60,92
WL 8
Mvva 128,32,96
TR 56,11,49152
Mvva 128,36,100
buffer_load_dwordx4 a[32:35], v64, s[8:11], s24 offen offset:0 sc1
Mvva 132,32,104
TR 58,11,53248
Mvva 132,36,108
Mvva 136,32,112
TR 60,11,57344
Mvva 136,36,116
buffer_load_dwordx4 a[36:39], v64, s[8:11], s24 offen offset:1024 sc1
Mvva 140,32,120
TR 62,11,61440
Mvva 140,36,124
WL 8
Mvva 144,40,96
TR 32,12,49152
Mvva 144,44,100
buffer_load_dwordx4 a[40:43], v65, s[8:11], s24 offen offset:0 sc1
Mvva 148,40,104
TR 34,12,53248
Mvva 148,44,108
Mvva 152,40,112
TR 36,12,57344
Mvva 152,44,116
buffer_load_dwordx4 a[44:47], v65, s[8:11], s24 offen offset:1024 sc1
Mvva 156,40,120
TR 38,12,61440
Mvva 156,44,124
WL 8
Mvva 160,48,96
TR 40,13,49152
Mvva 160,52,100
Mvva 164,48,104
TR 42,13,53248
Mvva 164,52,108
buffer_load_dwordx4 a[48:51], v66, s[8:11], s24 offen offset:0 sc1
Mvva 168,48,112
TR 44,13,57344
Mvva 168,52,116
buffer_load_dwordx4 a[52:55], v66, s[8:11], s24 offen offset:1024 sc1
Mvva 172,48,120
TR 46,13,61440
Mvva 172,52,124
WL 8
Mvva 176,56,96
TR 48,14,49152
Mvva 176,60,100
Mvva 180,56,104
TR 50,14,53248
Mvva 180,60,108
buffer_load_dwordx4 a[56:59], v67, s[8:11], s24 offen offset:0 sc1
Mvva 184,56,112
TR 52,14,57344
Mvva 184,60,116
buffer_load_dwordx4 a[60:63], v67, s[8:11], s24 offen offset:1024 sc1
Mvva 188,56,120
TR 54,14,61440
Mvva 188,60,124
WL 8
Mvva 192,32,96
TR 56,15,49152
Mvva 192,36,100
Mvva 196,32,104
TR 58,15,53248
Mvva 196,36,108
s_add_u32 s24, s24, 6144
Mvva 200,32,112
TR 60,15,57344
Mvva 200,36,116
Mvva 204,32,120
TR 62,15,61440
Mvva 204,36,124
WL 8
s_mov_b32 s32, 2
A2_loopa:
s_waitcnt vmcnt(12)
s_barrier
Mvva 208,40,96
TR 32,8,0
Mvva 208,44,100
s_add_u32 m0, s27, 32768
Mvva 212,40,104
TR 34,8,4096
Mvva 212,44,108
DM 24,12,25,0
Mvva 216,40,112
TR 36,8,8192
Mvva 216,44,116
Mvva 220,40,120
TR 38,8,12288
Mvva 220,44,124
WL 8
Mvva 224,48,96
TR 40,9,0
Mvva 224,52,100
DM 25,12,25,1024
Mvva 228,48,104
TR 42,9,4096
Mvva 228,52,108
DM 26,12,25,2048
Mvva 232,48,112
TR 44,9,8192
Mvva 232,52,116
Mvva 236,48,120
TR 46,9,12288
Mvva 236,52,124
WL 8
Mvva 240,56,96
TR 48,10,0
Mvva 240,60,100
DM 27,12,25,3072
Mvva 244,56,104
TR 50,10,4096
Mvva 244,60,108
Mvva 248,56,112
TR 52,10,8192
Mvva 248,60,116
s_add_u32 s25, s25, 131072
Mvva 252,56,120
TR 54,10,12288
Mvva 252,60,124
WL 8
Mvva 128,32,0
TR 56,11,0
Mvva 128,36,4
buffer_load_dwordx4 a[64:67], v64, s[8:11], s24 offen offset:0 sc1
Mvva 132,32,8
TR 58,11,4096
Mvva 132,36,12
Mvva 136,32,16
TR 60,11,8192
Mvva 136,36,20
buffer_load_dwordx4 a[68:71], v64, s[8:11], s24 offen offset:1024 sc1
Mvva 140,32,24
TR 62,11,12288
Mvva 140,36,28
WL 8
Mvva 144,40,0
TR 32,12,0
Mvva 144,44,4
buffer_load_dwordx4 a[72:75], v65, s[8:11], s24 offen offset:0 sc1
Mvva 148,40,8
TR 34,12,4096
Mvva 148,44,12
Mvva 152,40,16
TR 36,12,8192
Mvva 152,44,20
buffer_load_dwordx4 a[76:79], v65, s[8:11], s24 offen offset:1024 sc1
Mvva 156,40,24
TR 38,12,12288
Mvva 156,44,28
WL 8
Mvva 160,48,0
TR 40,13,0
Mvva 160,52,4
Mvva 164,48,8
TR 42,13,4096
Mvva 164,52,12
buffer_load_dwordx4 a[80:83], v66, s[8:11], s24 offen offset:0 sc1
Mvva 168,48,16
TR 44,13,8192
Mvva 168,52,20
buffer_load_dwordx4 a[84:87], v66, s[8:11], s24 offen offset:1024 sc1
Mvva 172,48,24
TR 46,13,12288
Mvva 172,52,28
WL 8
Mvva 176,56,0
TR 48,14,0
Mvva 176,60,4
Mvva 180,56,8
TR 50,14,4096
Mvva 180,60,12
buffer_load_dwordx4 a[88:91], v67, s[8:11], s24 offen offset:0 sc1
Mvva 184,56,16
TR 52,14,8192
Mvva 184,60,20
buffer_load_dwordx4 a[92:95], v67, s[8:11], s24 offen offset:1024 sc1
Mvva 188,56,24
TR 54,14,12288
Mvva 188,60,28
WL 8
Mvva 192,32,0
TR 56,15,0
Mvva 192,36,4
Mvva 196,32,8
TR 58,15,4096
Mvva 196,36,12
s_add_u32 s24, s24, 2048
Mvva 200,32,16
TR 60,15,8192
Mvva 200,36,20
Mvva 204,32,24
TR 62,15,12288
Mvva 204,36,28
WL 8
s_waitcnt vmcnt(12)
s_barrier
Mvva 208,40,0
TR 32,8,16384
Mvva 208,44,4
s_add_u32 m0, s27, 49152
Mvva 212,40,8
TR 34,8,20480
Mvva 212,44,12
DM 24,12,25,0
Mvva 216,40,16
TR 36,8,24576
Mvva 216,44,20
Mvva 220,40,24
TR 38,8,28672
Mvva 220,44,28
WL 8
Mvva 224,48,0
TR 40,9,16384
Mvva 224,52,4
DM 25,12,25,1024
Mvva 228,48,8
TR 42,9,20480
Mvva 228,52,12
DM 26,12,25,2048
Mvva 232,48,16
TR 44,9,24576
Mvva 232,52,20
Mvva 236,48,24
TR 46,9,28672
Mvva 236,52,28
WL 8
Mvva 240,56,0
TR 48,10,16384
Mvva 240,60,4
DM 27,12,25,3072
Mvva 244,56,8
TR 50,10,20480
Mvva 244,60,12
Mvva 248,56,16
TR 52,10,24576
Mvva 248,60,20
s_add_u32 s25, s25, 393216
Mvva 252,56,24
TR 54,10,28672
Mvva 252,60,28
WL 8
Mvva 128,32,32
TR 56,11,16384
Mvva 128,36,36
buffer_load_dwordx4 a[96:99], v64, s[8:11], s24 offen offset:0 sc1
Mvva 132,32,40
TR 58,11,20480
Mvva 132,36,44
Mvva 136,32,48
TR 60,11,24576
Mvva 136,36,52
buffer_load_dwordx4 a[100:103], v64, s[8:11], s24 offen offset:1024 sc1
Mvva 140,32,56
TR 62,11,28672
Mvva 140,36,60
WL 8
Mvva 144,40,32
TR 32,12,16384
Mvva 144,44,36
buffer_load_dwordx4 a[104:107], v65, s[8:11], s24 offen offset:0 sc1
Mvva 148,40,40
TR 34,12,20480
Mvva 148,44,44
Mvva 152,40,48
TR 36,12,24576
Mvva 152,44,52
buffer_load_dwordx4 a[108:111], v65, s[8:11], s24 offen offset:1024 sc1
Mvva 156,40,56
TR 38,12,28672
Mvva 156,44,60
WL 8
Mvva 160,48,32
TR 40,13,16384
Mvva 160,52,36
Mvva 164,48,40
TR 42,13,20480
Mvva 164,52,44
buffer_load_dwordx4 a[112:115], v66, s[8:11], s24 offen offset:0 sc1
Mvva 168,48,48
TR 44,13,24576
Mvva 168,52,52
buffer_load_dwordx4 a[116:119], v66, s[8:11], s24 offen offset:1024 sc1
Mvva 172,48,56
TR 46,13,28672
Mvva 172,52,60
WL 8
Mvva 176,56,32
TR 48,14,16384
Mvva 176,60,36
Mvva 180,56,40
TR 50,14,20480
Mvva 180,60,44
buffer_load_dwordx4 a[120:123], v67, s[8:11], s24 offen offset:0 sc1
Mvva 184,56,48
TR 52,14,24576
Mvva 184,60,52
buffer_load_dwordx4 a[124:127], v67, s[8:11], s24 offen offset:1024 sc1
Mvva 188,56,56
TR 54,14,28672
Mvva 188,60,60
WL 8
Mvva 192,32,32
TR 56,15,16384
Mvva 192,36,36
Mvva 196,32,40
TR 58,15,20480
Mvva 196,36,44
s_add_u32 s24, s24, 6144
Mvva 200,32,48
TR 60,15,24576
Mvva 200,36,52
Mvva 204,32,56
TR 62,15,28672
Mvva 204,36,60
WL 8
s_waitcnt vmcnt(12)
s_barrier
Mvva 208,40,32
TR 32,8,32768
Mvva 208,44,36
s_add_u32 m0, s27, 0
Mvva 212,40,40
TR 34,8,36864
Mvva 212,44,44
DM 24,12,25,0
Mvva 216,40,48
TR 36,8,40960
Mvva 216,44,52
Mvva 220,40,56
TR 38,8,45056
Mvva 220,44,60
WL 8
Mvva 224,48,32
TR 40,9,32768
Mvva 224,52,36
DM 25,12,25,1024
Mvva 228,48,40
TR 42,9,36864
Mvva 228,52,44
DM 26,12,25,2048
Mvva 232,48,48
TR 44,9,40960
Mvva 232,52,52
Mvva 236,48,56
TR 46,9,45056
Mvva 236,52,60
WL 8
Mvva 240,56,32
TR 48,10,32768
Mvva 240,60,36
DM 27,12,25,3072
Mvva 244,56,40
TR 50,10,36864
Mvva 244,60,44
Mvva 248,56,48
TR 52,10,40960
Mvva 248,60,52
s_add_u32 s25, s25, 131072
Mvva 252,56,56
TR 54,10,45056
Mvva 252,60,60
WL 8
Mvva 128,32,64
TR 56,11,32768
Mvva 128,36,68
buffer_load_dwordx4 a[0:3], v64, s[8:11], s24 offen offset:0 sc1
Mvva 132,32,72
TR 58,11,36864
Mvva 132,36,76
Mvva 136,32,80
TR 60,11,40960
Mvva 136,36,84
buffer_load_dwordx4 a[4:7], v64, s[8:11], s24 offen offset:1024 sc1
Mvva 140,32,88
TR 62,11,45056
Mvva 140,36,92
WL 8
Mvva 144,40,64
TR 32,12,32768
Mvva 144,44,68
buffer_load_dwordx4 a[8:11], v65, s[8:11], s24 offen offset:0 sc1
Mvva 148,40,72
TR 34,12,36864
Mvva 148,44,76
Mvva 152,40,80
TR 36,12,40960
Mvva 152,44,84
buffer_load_dwordx4 a[12:15], v65, s[8:11], s24 offen offset:1024 sc1
Mvva 156,40,88
TR 38,12,45056
Mvva 156,44,92
WL 8
Mvva 160,48,64
TR 40,13,32768
Mvva 160,52,68
Mvva 164,48,72
TR 42,13,36864
Mvva 164,52,76
buffer_load_dwordx4 a[16:19], v66, s[8:11], s24 offen offset:0 sc1
Mvva 168,48,80
TR 44,13,40960
Mvva 168,52,84
buffer_load_dwordx4 a[20:23], v66, s[8:11], s24 offen offset:1024 sc1
Mvva 172,48,88
TR 46,13,45056
Mvva 172,52,92
WL 8
Mvva 176,56,64
TR 48,14,32768
Mvva 176,60,68
Mvva 180,56,72
TR 50,14,36864
Mvva 180,60,76
buffer_load_dwordx4 a[24:27], v67, s[8:11], s24 offen offset:0 sc1
Mvva 184,56,80
TR 52,14,40960
Mvva 184,60,84
buffer_load_dwordx4 a[28:31], v67, s[8:11], s24 offen offset:1024 sc1
Mvva 188,56,88
TR 54,14,45056
Mvva 188,60,92
WL 8
Mvva 192,32,64
TR 56,15,32768
Mvva 192,36,68
Mvva 196,32,72
TR 58,15,36864
Mvva 196,36,76
s_add_u32 s24, s24, 2048
Mvva 200,32,80
TR 60,15,40960
Mvva 200,36,84
Mvva 204,32,88
TR 62,15,45056
Mvva 204,36,92
WL 8
s_waitcnt vmcnt(12)
s_barrier
Mvva 208,40,64
TR 32,8,49152
Mvva 208,44,68
s_add_u32 m0, s27, 16384
Mvva 212,40,72
TR 34,8,53248
Mvva 212,44,76
DM 24,12,25,0
Mvva 216,40,80
TR 36,8,57344
Mvva 216,44,84
Mvva 220,40,88
TR 38,8,61440
Mvva 220,44,92
WL 8
Mvva 224,48,64
TR 40,9,49152
Mvva 224,52,68
DM 25,12,25,1024
Mvva 228,48,72
TR 42,9,53248
Mvva 228,52,76
DM 26,12,25,2048
Mvva 232,48,80
TR 44,9,57344
Mvva 232,52,84
Mvva 236,48,88
TR 46,9,61440
Mvva 236,52,92
WL 8
Mvva 240,56,64
TR 48,10,49152
Mvva 240,60,68
DM 27,12,25,3072
Mvva 244,56,72
TR 50,10,53248
Mvva 244,60,76
Mvva 248,56,80
TR 52,10,57344
Mvva 248,60,84
s_add_u32 s25, s25, 393216
Mvva 252,56,88
TR 54,10,61440
Mvva 252,60,92
WL 8
Mvva 128,32,96
TR 56,11,49152
Mvva 128,36,100
buffer_load_dwordx4 a[32:35], v64, s[8:11], s24 offen offset:0 sc1
Mvva 132,32,104
TR 58,11,53248
Mvva 132,36,108
Mvva 136,32,112
TR 60,11,57344
Mvva 136,36,116
buffer_load_dwordx4 a[36:39], v64, s[8:11], s24 offen offset:1024 sc1
Mvva 140,32,120
TR 62,11,61440
Mvva 140,36,124
WL 8
Mvva 144,40,96
TR 32,12,49152
Mvva 144,44,100
buffer_load_dwordx4 a[40:43], v65, s[8:11], s24 offen offset:0 sc1
Mvva 148,40,104
TR 34,12,53248
Mvva 148,44,108
Mvva 152,40,112
TR 36,12,57344
Mvva 152,44,116
buffer_load_dwordx4 a[44:47], v65, s[8:11], s24 offen offset:1024 sc1
Mvva 156,40,120
TR 38,12,61440
Mvva 156,44,124
WL 8
Mvva 160,48,96
TR 40,13,49152
Mvva 160,52,100
Mvva 164,48,104
TR 42,13,53248
Mvva 164,52,108
buffer_load_dwordx4 a[48:51], v66, s[8:11], s24 offen offset:0 sc1
Mvva 168,48,112
TR 44,13,57344
Mvva 168,52,116
buffer_load_dwordx4 a[52:55], v66, s[8:11], s24 offen offset:1024 sc1
Mvva 172,48,120
TR 46,13,61440
Mvva 172,52,124
WL 8
Mvva 176,56,96
TR 48,14,49152
Mvva 176,60,100
Mvva 180,56,104
TR 50,14,53248
Mvva 180,60,108
buffer_load_dwordx4 a[56:59], v67, s[8:11], s24 offen offset:0 sc1
Mvva 184,56,112
TR 52,14,57344
Mvva 184,60,116
buffer_load_dwordx4 a[60:63], v67, s[8:11], s24 offen offset:1024 sc1
Mvva 188,56,120
TR 54,14,61440
Mvva 188,60,124
WL 8
Mvva 192,32,96
TR 56,15,49152
Mvva 192,36,100
Mvva 196,32,104
TR 58,15,53248
Mvva 196,36,108
s_add_u32 s24, s24, 6144
Mvva 200,32,112
TR 60,15,57344
Mvva 200,36,116
Mvva 204,32,120
TR 62,15,61440
s_sub_u32 s32, s32, 1
Mvva 204,36,124
WL 8
s_cmp_lg_u32 s32, 0
s_cbranch_scc1 A2_loopa
s_waitcnt vmcnt(12)
s_barrier
Mvva 208,40,96
TR 32,8,0
Mvva 208,44,100
s_add_u32 m0, s27, 32768
Mvva 212,40,104
TR 34,8,4096
Mvva 212,44,108
DM 24,12,25,0
Mvva 216,40,112
TR 36,8,8192
Mvva 216,44,116
Mvva 220,40,120
TR 38,8,12288
Mvva 220,44,124
WL 8
Mvva 224,48,96
TR 40,9,0
Mvva 224,52,100
DM 25,12,25,1024
Mvva 228,48,104
TR 42,9,4096
Mvva 228,52,108
DM 26,12,25,2048
Mvva 232,48,112
TR 44,9,8192
Mvva 232,52,116
Mvva 236,48,120
TR 46,9,12288
Mvva 236,52,124
WL 8
Mvva 240,56,96
TR 48,10,0
Mvva 240,60,100
DM 27,12,25,3072
Mvva 244,56,104
TR 50,10,4096
Mvva 244,60,108
s_add_u32 s25, s25, 131072
Mvva 248,56,112
TR 52,10,8192
Mvva 248,60,116
Mvva 252,56,120
TR 54,10,12288
Mvva 252,60,124
WL 8
Mvva 128,32,0
TR 56,11,0
Mvva 128,36,4
buffer_load_dwordx4 a[64:67], v64, s[8:11], s24 offen offset:0 sc1
Mvva 132,32,8
TR 58,11,4096
Mvva 132,36,12
buffer_load_dwordx4 a[68:71], v64, s[8:11], s24 offen offset:1024 sc1
Mvva 136,32,16
TR 60,11,8192
Mvva 136,36,20
Mvva 140,32,24
TR 62,11,12288
Mvva 140,36,28
WL 8
Mvva 144,40,0
TR 32,12,0
Mvva 144,44,4
buffer_load_dwordx4 a[72:75], v65, s[8:11], s24 offen offset:0 sc1
Mvva 148,40,8
TR 34,12,4096
Mvva 148,44,12
buffer_load_dwordx4 a[76:79], v65, s[8:11], s24 offen offset:1024 sc1
Mvva 152,40,16
TR 36,12,8192
Mvva 152,44,20
Mvva 156,40,24
TR 38,12,12288
Mvva 156,44,28
WL 8
Mvva 160,48,0
TR 40,13,0
Mvva 160,52,4
buffer_load_dwordx4 a[80:83], v66, s[8:11], s24 offen offset:0 sc1
Mvva 164,48,8
TR 42,13,4096
Mvva 164,52,12
buffer_load_dwordx4 a[84:87], v66, s[8:11], s24 offen offset:1024 sc1
Mvva 168,48,16
TR 44,13,8192
Mvva 168,52,20
Mvva 172,48,24
TR 46,13,12288
Mvva 172,52,28
WL 8
Mvva 176,56,0
TR 48,14,0
Mvva 176,60,4
buffer_load_dwordx4 a[88:91], v67, s[8:11], s24 offen offset:0 sc1
Mvva 180,56,8
TR 50,14,4096
Mvva 180,60,12
buffer_load_dwordx4 a[92:95], v67, s[8:11], s24 offen offset:1024 sc1
Mvva 184,56,16
TR 52,14,8192
Mvva 184,60,20
Mvva 188,56,24
TR 54,14,12288
Mvva 188,60,28
WL 8
Mvva 192,32,0
TR 56,15,0
Mvva 192,36,4
s_add_u32 s24, s24, 2048
Mvva 196,32,8
TR 58,15,4096
Mvva 196,36,12
buffer_load_dword v89, off, s[84:87], s51 sc1
Mvva 200,32,16
TR 60,15,8192
Mvva 200,36,20
Mvva 204,32,24
TR 62,15,12288
Mvva 204,36,28
WL 8
s_waitcnt vmcnt(13)
s_barrier
Mvva 208,40,0
TR 32,8,16384
Mvva 208,44,4
s_add_u32 m0, s27, 49152
Mvva 212,40,8
TR 34,8,20480
Mvva 212,44,12
DM 24,12,25,0
Mvva 216,40,16
TR 36,8,24576
Mvva 216,44,20
Mvva 220,40,24
TR 38,8,28672
Mvva 220,44,28
WL 8
Mvva 224,48,0
TR 40,9,16384
Mvva 224,52,4
DM 25,12,25,1024
Mvva 228,48,8
TR 42,9,20480
Mvva 228,52,12
DM 26,12,25,2048
Mvva 232,48,16
TR 44,9,24576
Mvva 232,52,20
Mvva 236,48,24
TR 46,9,28672
Mvva 236,52,28
WL 8
Mvva 240,56,0
TR 48,10,16384
Mvva 240,60,4
DM 27,12,25,3072
Mvva 244,56,8
TR 50,10,20480
Mvva 244,60,12
Mvva 248,56,16
TR 52,10,24576
Mvva 248,60,20
s_sub_u32 s25, s25, 3538944
Mvva 252,56,24
TR 54,10,28672
Mvva 252,60,28
WL 8
Mvva 128,32,32
TR 56,11,16384
Mvva 128,36,36
buffer_load_dwordx4 a[96:99], v64, s[8:11], s24 offen offset:0 sc1
Mvva 132,32,40
TR 58,11,20480
Mvva 132,36,44
Mvva 136,32,48
TR 60,11,24576
Mvva 136,36,52
buffer_load_dwordx4 a[100:103], v64, s[8:11], s24 offen offset:1024 sc1
Mvva 140,32,56
TR 62,11,28672
Mvva 140,36,60
WL 8
Mvva 144,40,32
TR 32,12,16384
Mvva 144,44,36
buffer_load_dwordx4 a[104:107], v65, s[8:11], s24 offen offset:0 sc1
Mvva 148,40,40
TR 34,12,20480
Mvva 148,44,44
Mvva 152,40,48
TR 36,12,24576
Mvva 152,44,52
buffer_load_dwordx4 a[108:111], v65, s[8:11], s24 offen offset:1024 sc1
Mvva 156,40,56
TR 38,12,28672
Mvva 156,44,60
WL 8
Mvva 160,48,32
TR 40,13,16384
Mvva 160,52,36
Mvva 164,48,40
TR 42,13,20480
Mvva 164,52,44
buffer_load_dwordx4 a[112:115], v66, s[8:11], s24 offen offset:0 sc1
Mvva 168,48,48
TR 44,13,24576
Mvva 168,52,52
buffer_load_dwordx4 a[116:119], v66, s[8:11], s24 offen offset:1024 sc1
Mvva 172,48,56
TR 46,13,28672
Mvva 172,52,60
WL 8
Mvva 176,56,32
TR 48,14,16384
Mvva 176,60,36
Mvva 180,56,40
TR 50,14,20480
Mvva 180,60,44
buffer_load_dwordx4 a[120:123], v67, s[8:11], s24 offen offset:0 sc1
Mvva 184,56,48
TR 52,14,24576
Mvva 184,60,52
buffer_load_dwordx4 a[124:127], v67, s[8:11], s24 offen offset:1024 sc1
Mvva 188,56,56
TR 54,14,28672
Mvva 188,60,60
WL 8
Mvva 192,32,32
TR 56,15,16384
Mvva 192,36,36
Mvva 196,32,40
TR 58,15,20480
Mvva 196,36,44
s_sub_u32 s24, s24, 55296
Mvva 200,32,48
TR 60,15,24576
Mvva 200,36,52
Mvva 204,32,56
TR 62,15,28672
Mvva 204,36,60
WL 8
s_waitcnt vmcnt(12)
s_barrier
v_cmp_ne_u32 vcc, 16, v89
s_nop 1
s_cbranch_vccnz A2_f1_w
A2_f1_k:
Mvva 208,40,32
TR 32,8,32768
Mvva 208,44,36
s_add_u32 m0, s27, 0
Mvva 212,40,40
TR 34,8,36864
Mvva 212,44,44
DM 24,12,25,0
Mvva 216,40,48
TR 36,8,40960
Mvva 216,44,52
Mvva 220,40,56
TR 38,8,45056
Mvva 220,44,60
WL 8
Mvva 224,48,32
TR 40,9,32768
Mvva 224,52,36
DM 25,12,25,1024
Mvva 228,48,40
TR 42,9,36864
Mvva 228,52,44
DM 26,12,25,2048
Mvva 232,48,48
TR 44,9,40960
Mvva 232,52,52
Mvva 236,48,56
TR 46,9,45056
Mvva 236,52,60
WL 8
Mvva 240,56,32
TR 48,10,32768
Mvva 240,60,36
DM 27,12,25,3072
Mvva 244,56,40
TR 50,10,36864
Mvva 244,60,44
Mvva 248,56,48
TR 52,10,40960
Mvva 248,60,52
s_add_u32 s25, s25, 131072
Mvva 252,56,56
TR 54,10,45056
Mvva 252,60,60
WL 8
Mvva 128,32,64
TR 56,11,32768
Mvva 128,36,68
buffer_load_dwordx4 a[0:3], v64, s[8:11], s24 offen offset:0 sc1
Mvva 132,32,72
TR 58,11,36864
Mvva 132,36,76
Mvva 136,32,80
TR 60,11,40960
Mvva 136,36,84
buffer_load_dwordx4 a[4:7], v64, s[8:11], s24 offen offset:1024 sc1
Mvva 140,32,88
TR 62,11,45056
Mvva 140,36,92
WL 8
Mvva 144,40,64
TR 32,12,32768
Mvva 144,44,68
buffer_load_dwordx4 a[8:11], v65, s[8:11], s24 offen offset:0 sc1
Mvva 148,40,72
TR 34,12,36864
Mvva 148,44,76
Mvva 152,40,80
TR 36,12,40960
Mvva 152,44,84
buffer_load_dwordx4 a[12:15], v65, s[8:11], s24 offen offset:1024 sc1
Mvva 156,40,88
TR 38,12,45056
Mvva 156,44,92
WL 8
Mvva 160,48,64
TR 40,13,32768
Mvva 160,52,68
Mvva 164,48,72
TR 42,13,36864
Mvva 164,52,76
buffer_load_dwordx4 a[16:19], v66, s[8:11], s24 offen offset:0 sc1
Mvva 168,48,80
TR 44,13,40960
Mvva 168,52,84
buffer_load_dwordx4 a[20:23], v66, s[8:11], s24 offen offset:1024 sc1
Mvva 172,48,88
TR 46,13,45056
Mvva 172,52,92
WL 8
Mvva 176,56,64
TR 48,14,32768
Mvva 176,60,68
Mvva 180,56,72
TR 50,14,36864
Mvva 180,60,76
buffer_load_dwordx4 a[24:27], v67, s[8:11], s24 offen offset:0 sc1
Mvva 184,56,80
TR 52,14,40960
Mvva 184,60,84
buffer_load_dwordx4 a[28:31], v67, s[8:11], s24 offen offset:1024 sc1
Mvva 188,56,88
TR 54,14,45056
Mvva 188,60,92
WL 8
Mvva 192,32,64
TR 56,15,32768
Mvva 192,36,68
Mvva 196,32,72
TR 58,15,36864
Mvva 196,36,76
s_add_u32 s24, s24, 2048
Mvva 200,32,80
TR 60,15,40960
Mvva 200,36,84
Mvva 204,32,88
TR 62,15,45056
Mvva 204,36,92
WL 8
s_mov_b32 s32, 3
A2_loop:
s_waitcnt vmcnt(12)
s_barrier
Mvva 208,40,64
TR 32,8,49152
Mvva 208,44,68
s_add_u32 m0, s27, 16384
Mvva 212,40,72
TR 34,8,53248
Mvva 212,44,76
DM 24,12,25,0
Mvva 216,40,80
TR 36,8,57344
Mvva 216,44,84
Mvva 220,40,88
TR 38,8,61440
Mvva 220,44,92
WL 8
Mvva 224,48,64
TR 40,9,49152
Mvva 224,52,68
DM 25,12,25,1024
Mvva 228,48,72
TR 42,9,53248
Mvva 228,52,76
DM 26,12,25,2048
Mvva 232,48,80
TR 44,9,57344
Mvva 232,52,84
Mvva 236,48,88
TR 46,9,61440
Mvva 236,52,92
WL 8
Mvva 240,56,64
TR 48,10,49152
Mvva 240,60,68
DM 27,12,25,3072
Mvva 244,56,72
TR 50,10,53248
Mvva 244,60,76
Mvva 248,56,80
TR 52,10,57344
Mvva 248,60,84
s_add_u32 s25, s25, 393216
Mvva 252,56,88
TR 54,10,61440
Mvva 252,60,92
WL 8
Mvva 128,32,96
TR 56,11,49152
Mvva 128,36,100
buffer_load_dwordx4 a[32:35], v64, s[8:11], s24 offen offset:0 sc1
Mvva 132,32,104
TR 58,11,53248
Mvva 132,36,108
Mvva 136,32,112
TR 60,11,57344
Mvva 136,36,116
buffer_load_dwordx4 a[36:39], v64, s[8:11], s24 offen offset:1024 sc1
Mvva 140,32,120
TR 62,11,61440
Mvva 140,36,124
WL 8
Mvva 144,40,96
TR 32,12,49152
Mvva 144,44,100
buffer_load_dwordx4 a[40:43], v65, s[8:11], s24 offen offset:0 sc1
Mvva 148,40,104
TR 34,12,53248
Mvva 148,44,108
Mvva 152,40,112
TR 36,12,57344
Mvva 152,44,116
buffer_load_dwordx4 a[44:47], v65, s[8:11], s24 offen offset:1024 sc1
Mvva 156,40,120
TR 38,12,61440
Mvva 156,44,124
WL 8
Mvva 160,48,96
TR 40,13,49152
Mvva 160,52,100
Mvva 164,48,104
TR 42,13,53248
Mvva 164,52,108
buffer_load_dwordx4 a[48:51], v66, s[8:11], s24 offen offset:0 sc1
Mvva 168,48,112
TR 44,13,57344
Mvva 168,52,116
buffer_load_dwordx4 a[52:55], v66, s[8:11], s24 offen offset:1024 sc1
Mvva 172,48,120
TR 46,13,61440
Mvva 172,52,124
WL 8
Mvva 176,56,96
TR 48,14,49152
Mvva 176,60,100
Mvva 180,56,104
TR 50,14,53248
Mvva 180,60,108
buffer_load_dwordx4 a[56:59], v67, s[8:11], s24 offen offset:0 sc1
Mvva 184,56,112
TR 52,14,57344
Mvva 184,60,116
buffer_load_dwordx4 a[60:63], v67, s[8:11], s24 offen offset:1024 sc1
Mvva 188,56,120
TR 54,14,61440
Mvva 188,60,124
WL 8
Mvva 192,32,96
TR 56,15,49152
Mvva 192,36,100
Mvva 196,32,104
TR 58,15,53248
Mvva 196,36,108
s_add_u32 s24, s24, 6144
Mvva 200,32,112
TR 60,15,57344
Mvva 200,36,116
Mvva 204,32,120
TR 62,15,61440
Mvva 204,36,124
WL 8
s_waitcnt vmcnt(12)
s_barrier
Mvva 208,40,96
TR 32,8,0
Mvva 208,44,100
s_add_u32 m0, s27, 32768
Mvva 212,40,104
TR 34,8,4096
Mvva 212,44,108
DM 24,12,25,0
Mvva 216,40,112
TR 36,8,8192
Mvva 216,44,116
Mvva 220,40,120
TR 38,8,12288
Mvva 220,44,124
WL 8
Mvva 224,48,96
TR 40,9,0
Mvva 224,52,100
DM 25,12,25,1024
Mvva 228,48,104
TR 42,9,4096
Mvva 228,52,108
DM 26,12,25,2048
Mvva 232,48,112
TR 44,9,8192
Mvva 232,52,116
Mvva 236,48,120
TR 46,9,12288
Mvva 236,52,124
WL 8
Mvva 240,56,96
TR 48,10,0
Mvva 240,60,100
DM 27,12,25,3072
Mvva 244,56,104
TR 50,10,4096
Mvva 244,60,108
Mvva 248,56,112
TR 52,10,8192
Mvva 248,60,116
s_add_u32 s25, s25, 131072
Mvva 252,56,120
TR 54,10,12288
Mvva 252,60,124
WL 8
Mvva 128,32,0
TR 56,11,0
Mvva 128,36,4
buffer_load_dwordx4 a[64:67], v64, s[8:11], s24 offen offset:0 sc1
Mvva 132,32,8
TR 58,11,4096
Mvva 132,36,12
Mvva 136,32,16
TR 60,11,8192
Mvva 136,36,20
buffer_load_dwordx4 a[68:71], v64, s[8:11], s24 offen offset:1024 sc1
Mvva 140,32,24
TR 62,11,12288
Mvva 140,36,28
WL 8
Mvva 144,40,0
TR 32,12,0
Mvva 144,44,4
buffer_load_dwordx4 a[72:75], v65, s[8:11], s24 offen offset:0 sc1
Mvva 148,40,8
TR 34,12,4096
Mvva 148,44,12
Mvva 152,40,16
TR 36,12,8192
Mvva 152,44,20
buffer_load_dwordx4 a[76:79], v65, s[8:11], s24 offen offset:1024 sc1
Mvva 156,40,24
TR 38,12,12288
Mvva 156,44,28
WL 8
Mvva 160,48,0
TR 40,13,0
Mvva 160,52,4
Mvva 164,48,8
TR 42,13,4096
Mvva 164,52,12
buffer_load_dwordx4 a[80:83], v66, s[8:11], s24 offen offset:0 sc1
Mvva 168,48,16
TR 44,13,8192
Mvva 168,52,20
buffer_load_dwordx4 a[84:87], v66, s[8:11], s24 offen offset:1024 sc1
Mvva 172,48,24
TR 46,13,12288
Mvva 172,52,28
WL 8
Mvva 176,56,0
TR 48,14,0
Mvva 176,60,4
Mvva 180,56,8
TR 50,14,4096
Mvva 180,60,12
buffer_load_dwordx4 a[88:91], v67, s[8:11], s24 offen offset:0 sc1
Mvva 184,56,16
TR 52,14,8192
Mvva 184,60,20
buffer_load_dwordx4 a[92:95], v67, s[8:11], s24 offen offset:1024 sc1
Mvva 188,56,24
TR 54,14,12288
Mvva 188,60,28
WL 8
Mvva 192,32,0
TR 56,15,0
Mvva 192,36,4
Mvva 196,32,8
TR 58,15,4096
Mvva 196,36,12
s_add_u32 s24, s24, 2048
Mvva 200,32,16
TR 60,15,8192
Mvva 200,36,20
Mvva 204,32,24
TR 62,15,12288
Mvva 204,36,28
WL 8
s_waitcnt vmcnt(12)
s_barrier
Mvva 208,40,0
TR 32,8,16384
Mvva 208,44,4
s_add_u32 m0, s27, 49152
Mvva 212,40,8
TR 34,8,20480
Mvva 212,44,12
DM 24,12,25,0
Mvva 216,40,16
TR 36,8,24576
Mvva 216,44,20
Mvva 220,40,24
TR 38,8,28672
Mvva 220,44,28
WL 8
Mvva 224,48,0
TR 40,9,16384
Mvva 224,52,4
DM 25,12,25,1024
Mvva 228,48,8
TR 42,9,20480
Mvva 228,52,12
DM 26,12,25,2048
Mvva 232,48,16
TR 44,9,24576
Mvva 232,52,20
Mvva 236,48,24
TR 46,9,28672
Mvva 236,52,28
WL 8
Mvva 240,56,0
TR 48,10,16384
Mvva 240,60,4
DM 27,12,25,3072
Mvva 244,56,8
TR 50,10,20480
Mvva 244,60,12
Mvva 248,56,16
TR 52,10,24576
Mvva 248,60,20
s_add_u32 s25, s25, 393216
Mvva 252,56,24
TR 54,10,28672
Mvva 252,60,28
WL 8
Mvva 128,32,32
TR 56,11,16384
Mvva 128,36,36
buffer_load_dwordx4 a[96:99], v64, s[8:11], s24 offen offset:0 sc1
Mvva 132,32,40
TR 58,11,20480
Mvva 132,36,44
Mvva 136,32,48
TR 60,11,24576
Mvva 136,36,52
buffer_load_dwordx4 a[100:103], v64, s[8:11], s24 offen offset:1024 sc1
Mvva 140,32,56
TR 62,11,28672
Mvva 140,36,60
WL 8
Mvva 144,40,32
TR 32,12,16384
Mvva 144,44,36
buffer_load_dwordx4 a[104:107], v65, s[8:11], s24 offen offset:0 sc1
Mvva 148,40,40
TR 34,12,20480
Mvva 148,44,44
Mvva 152,40,48
TR 36,12,24576
Mvva 152,44,52
buffer_load_dwordx4 a[108:111], v65, s[8:11], s24 offen offset:1024 sc1
Mvva 156,40,56
TR 38,12,28672
Mvva 156,44,60
WL 8
Mvva 160,48,32
TR 40,13,16384
Mvva 160,52,36
Mvva 164,48,40
TR 42,13,20480
Mvva 164,52,44
buffer_load_dwordx4 a[112:115], v66, s[8:11], s24 offen offset:0 sc1
Mvva 168,48,48
TR 44,13,24576
Mvva 168,52,52
buffer_load_dwordx4 a[116:119], v66, s[8:11], s24 offen offset:1024 sc1
Mvva 172,48,56
TR 46,13,28672
Mvva 172,52,60
WL 8
Mvva 176,56,32
TR 48,14,16384
Mvva 176,60,36
Mvva 180,56,40
TR 50,14,20480
Mvva 180,60,44
buffer_load_dwordx4 a[120:123], v67, s[8:11], s24 offen offset:0 sc1
Mvva 184,56,48
TR 52,14,24576
Mvva 184,60,52
buffer_load_dwordx4 a[124:127], v67, s[8:11], s24 offen offset:1024 sc1
Mvva 188,56,56
TR 54,14,28672
Mvva 188,60,60
WL 8
Mvva 192,32,32
TR 56,15,16384
Mvva 192,36,36
Mvva 196,32,40
TR 58,15,20480
Mvva 196,36,44
s_add_u32 s24, s24, 6144
Mvva 200,32,48
TR 60,15,24576
Mvva 200,36,52
Mvva 204,32,56
TR 62,15,28672
Mvva 204,36,60
WL 8
s_waitcnt vmcnt(12)
s_barrier
Mvva 208,40,32
TR 32,8,32768
Mvva 208,44,36
s_add_u32 m0, s27, 0
Mvva 212,40,40
TR 34,8,36864
Mvva 212,44,44
DM 24,12,25,0
Mvva 216,40,48
TR 36,8,40960
Mvva 216,44,52
Mvva 220,40,56
TR 38,8,45056
Mvva 220,44,60
WL 8
Mvva 224,48,32
TR 40,9,32768
Mvva 224,52,36
DM 25,12,25,1024
Mvva 228,48,40
TR 42,9,36864
Mvva 228,52,44
DM 26,12,25,2048
Mvva 232,48,48
TR 44,9,40960
Mvva 232,52,52
Mvva 236,48,56
TR 46,9,45056
Mvva 236,52,60
WL 8
Mvva 240,56,32
TR 48,10,32768
Mvva 240,60,36
DM 27,12,25,3072
Mvva 244,56,40
TR 50,10,36864
Mvva 244,60,44
Mvva 248,56,48
TR 52,10,40960
Mvva 248,60,52
s_add_u32 s25, s25, 131072
Mvva 252,56,56
TR 54,10,45056
Mvva 252,60,60
WL 8
Mvva 128,32,64
TR 56,11,32768
Mvva 128,36,68
buffer_load_dwordx4 a[0:3], v64, s[8:11], s24 offen offset:0 sc1
Mvva 132,32,72
TR 58,11,36864
Mvva 132,36,76
Mvva 136,32,80
TR 60,11,40960
Mvva 136,36,84
buffer_load_dwordx4 a[4:7], v64, s[8:11], s24 offen offset:1024 sc1
Mvva 140,32,88
TR 62,11,45056
Mvva 140,36,92
WL 8
Mvva 144,40,64
TR 32,12,32768
Mvva 144,44,68
buffer_load_dwordx4 a[8:11], v65, s[8:11], s24 offen offset:0 sc1
Mvva 148,40,72
TR 34,12,36864
Mvva 148,44,76
Mvva 152,40,80
TR 36,12,40960
Mvva 152,44,84
buffer_load_dwordx4 a[12:15], v65, s[8:11], s24 offen offset:1024 sc1
Mvva 156,40,88
TR 38,12,45056
Mvva 156,44,92
WL 8
Mvva 160,48,64
TR 40,13,32768
Mvva 160,52,68
Mvva 164,48,72
TR 42,13,36864
Mvva 164,52,76
buffer_load_dwordx4 a[16:19], v66, s[8:11], s24 offen offset:0 sc1
Mvva 168,48,80
TR 44,13,40960
Mvva 168,52,84
buffer_load_dwordx4 a[20:23], v66, s[8:11], s24 offen offset:1024 sc1
Mvva 172,48,88
TR 46,13,45056
Mvva 172,52,92
WL 8
Mvva 176,56,64
TR 48,14,32768
Mvva 176,60,68
Mvva 180,56,72
TR 50,14,36864
Mvva 180,60,76
buffer_load_dwordx4 a[24:27], v67, s[8:11], s24 offen offset:0 sc1
Mvva 184,56,80
TR 52,14,40960
Mvva 184,60,84
buffer_load_dwordx4 a[28:31], v67, s[8:11], s24 offen offset:1024 sc1
Mvva 188,56,88
TR 54,14,45056
Mvva 188,60,92
WL 8
Mvva 192,32,64
TR 56,15,32768
Mvva 192,36,68
Mvva 196,32,72
TR 58,15,36864
Mvva 196,36,76
s_add_u32 s24, s24, 2048
Mvva 200,32,80
TR 60,15,40960
Mvva 200,36,84
Mvva 204,32,88
TR 62,15,45056
s_sub_u32 s32, s32, 1
Mvva 204,36,92
WL 8
s_cmp_lg_u32 s32, 0
s_cbranch_scc1 A2_loop
s_waitcnt vmcnt(12)
s_barrier
Mvva 208,40,64
TR 32,8,49152
Mvva 208,44,68
s_add_u32 m0, s27, 16384
Mvva 212,40,72
TR 34,8,53248
Mvva 212,44,76
DM 24,12,25,0
Mvva 216,40,80
TR 36,8,57344
Mvva 216,44,84
Mvva 220,40,88
TR 38,8,61440
Mvva 220,44,92
WL 8
Mvva 224,48,64
TR 40,9,49152
Mvva 224,52,68
DM 25,12,25,1024
Mvva 228,48,72
TR 42,9,53248
Mvva 228,52,76
DM 26,12,25,2048
Mvva 232,48,80
TR 44,9,57344
Mvva 232,52,84
Mvva 236,48,88
TR 46,9,61440
Mvva 236,52,92
WL 8
Mvva 240,56,64
TR 48,10,49152
Mvva 240,60,68
DM 27,12,25,3072
Mvva 244,56,72
TR 50,10,53248
Mvva 244,60,76
Mvva 248,56,80
TR 52,10,57344
Mvva 248,60,84
s_add_u32 s25, s25, 393216
Mvva 252,56,88
TR 54,10,61440
Mvva 252,60,92
WL 8
Mvva 128,32,96
TR 56,11,49152
Mvva 128,36,100
buffer_load_dwordx4 a[32:35], v64, s[8:11], s24 offen offset:0 sc1
Mvva 132,32,104
TR 58,11,53248
Mvva 132,36,108
Mvva 136,32,112
TR 60,11,57344
Mvva 136,36,116
buffer_load_dwordx4 a[36:39], v64, s[8:11], s24 offen offset:1024 sc1
Mvva 140,32,120
TR 62,11,61440
Mvva 140,36,124
WL 8
Mvva 144,40,96
TR 32,12,49152
Mvva 144,44,100
buffer_load_dwordx4 a[40:43], v65, s[8:11], s24 offen offset:0 sc1
Mvva 148,40,104
TR 34,12,53248
Mvva 148,44,108
Mvva 152,40,112
TR 36,12,57344
Mvva 152,44,116
buffer_load_dwordx4 a[44:47], v65, s[8:11], s24 offen offset:1024 sc1
Mvva 156,40,120
TR 38,12,61440
Mvva 156,44,124
WL 8
Mvva 160,48,96
TR 40,13,49152
Mvva 160,52,100
Mvva 164,48,104
TR 42,13,53248
Mvva 164,52,108
buffer_load_dwordx4 a[48:51], v66, s[8:11], s24 offen offset:0 sc1
Mvva 168,48,112
TR 44,13,57344
Mvva 168,52,116
buffer_load_dwordx4 a[52:55], v66, s[8:11], s24 offen offset:1024 sc1
Mvva 172,48,120
TR 46,13,61440
Mvva 172,52,124
WL 8
Mvva 176,56,96
TR 48,14,49152
Mvva 176,60,100
Mvva 180,56,104
TR 50,14,53248
Mvva 180,60,108
buffer_load_dwordx4 a[56:59], v67, s[8:11], s24 offen offset:0 sc1
Mvva 184,56,112
TR 52,14,57344
Mvva 184,60,116
buffer_load_dwordx4 a[60:63], v67, s[8:11], s24 offen offset:1024 sc1
Mvva 188,56,120
TR 54,14,61440
Mvva 188,60,124
WL 8
Mvva 192,32,96
TR 56,15,49152
Mvva 192,36,100
Mvva 196,32,104
TR 58,15,53248
Mvva 196,36,108
s_add_u32 s24, s24, 6144
Mvva 200,32,112
TR 60,15,57344
Mvva 200,36,116
Mvva 204,32,120
TR 62,15,61440
Mvva 204,36,124
WL 8
s_waitcnt vmcnt(12)
s_barrier
Mvva 208,40,96
TR 32,8,0
Mvva 208,44,100
s_add_u32 m0, s27, 32768
Mvva 212,40,104
TR 34,8,4096
Mvva 212,44,108
DM 24,12,25,0
Mvva 216,40,112
TR 36,8,8192
Mvva 216,44,116
Mvva 220,40,120
TR 38,8,12288
Mvva 220,44,124
WL 8
Mvva 224,48,96
TR 40,9,0
Mvva 224,52,100
DM 25,12,25,1024
Mvva 228,48,104
TR 42,9,4096
Mvva 228,52,108
DM 26,12,25,2048
Mvva 232,48,112
TR 44,9,8192
Mvva 232,52,116
Mvva 236,48,120
TR 46,9,12288
Mvva 236,52,124
WL 8
Mvva 240,56,96
TR 48,10,0
Mvva 240,60,100
DM 27,12,25,3072
Mvva 244,56,104
TR 50,10,4096
Mvva 244,60,108
Mvva 248,56,112
TR 52,10,8192
Mvva 248,60,116
s_add_u32 s25, s25, 131072
Mvva 252,56,120
TR 54,10,12288
Mvva 252,60,124
WL 8
Mvva 128,32,0
TR 56,11,0
Mvva 128,36,4
buffer_load_dwordx4 a[64:67], v64, s[8:11], s24 offen offset:0 sc1
Mvva 132,32,8
TR 58,11,4096
Mvva 132,36,12
Mvva 136,32,16
TR 60,11,8192
Mvva 136,36,20
buffer_load_dwordx4 a[68:71], v64, s[8:11], s24 offen offset:1024 sc1
Mvva 140,32,24
TR 62,11,12288
Mvva 140,36,28
WL 8
Mvva 144,40,0
TR 32,12,0
Mvva 144,44,4
buffer_load_dwordx4 a[72:75], v65, s[8:11], s24 offen offset:0 sc1
Mvva 148,40,8
TR 34,12,4096
Mvva 148,44,12
Mvva 152,40,16
TR 36,12,8192
Mvva 152,44,20
buffer_load_dwordx4 a[76:79], v65, s[8:11], s24 offen offset:1024 sc1
Mvva 156,40,24
TR 38,12,12288
Mvva 156,44,28
WL 8
Mvva 160,48,0
TR 40,13,0
Mvva 160,52,4
Mvva 164,48,8
TR 42,13,4096
Mvva 164,52,12
buffer_load_dwordx4 a[80:83], v66, s[8:11], s24 offen offset:0 sc1
Mvva 168,48,16
TR 44,13,8192
Mvva 168,52,20
buffer_load_dwordx4 a[84:87], v66, s[8:11], s24 offen offset:1024 sc1
Mvva 172,48,24
TR 46,13,12288
Mvva 172,52,28
WL 8
Mvva 176,56,0
TR 48,14,0
Mvva 176,60,4
Mvva 180,56,8
TR 50,14,4096
Mvva 180,60,12
buffer_load_dwordx4 a[88:91], v67, s[8:11], s24 offen offset:0 sc1
Mvva 184,56,16
TR 52,14,8192
Mvva 184,60,20
buffer_load_dwordx4 a[92:95], v67, s[8:11], s24 offen offset:1024 sc1
Mvva 188,56,24
TR 54,14,12288
Mvva 188,60,28
WL 8
Mvva 192,32,0
TR 56,15,0
Mvva 192,36,4
Mvva 196,32,8
TR 58,15,4096
Mvva 196,36,12
s_add_u32 s24, s24, 2048
Mvva 200,32,16
TR 60,15,8192
Mvva 200,36,20
Mvva 204,32,24
TR 62,15,12288
Mvva 204,36,28
WL 8
s_waitcnt vmcnt(12)
s_barrier
Mvva 208,40,0
TR 32,8,16384
Mvva 208,44,4
s_add_u32 m0, s27, 49152
Mvva 212,40,8
TR 34,8,20480
Mvva 212,44,12
DM 24,12,25,0
Mvva 216,40,16
TR 36,8,24576
Mvva 216,44,20
Mvva 220,40,24
TR 38,8,28672
Mvva 220,44,28
WL 8
Mvva 224,48,0
TR 40,9,16384
Mvva 224,52,4
DM 25,12,25,1024
Mvva 228,48,8
TR 42,9,20480
Mvva 228,52,12
DM 26,12,25,2048
Mvva 232,48,16
TR 44,9,24576
Mvva 232,52,20
Mvva 236,48,24
TR 46,9,28672
Mvva 236,52,28
WL 8
Mvva 240,56,0
TR 48,10,16384
Mvva 240,60,4
DM 27,12,25,3072
Mvva 244,56,8
TR 50,10,20480
Mvva 244,60,12
Mvva 248,56,16
TR 52,10,24576
Mvva 248,60,20
s_sub_u32 s25, s25, 4063232
Mvva 252,56,24
TR 54,10,28672
Mvva 252,60,28
WL 8
Mvva 128,32,32
TR 56,11,16384
Mvva 128,36,36
buffer_load_dwordx4 a[96:99], v64, s[8:11], s24 offen offset:0 sc1
Mvva 132,32,40
TR 58,11,20480
Mvva 132,36,44
Mvva 136,32,48
TR 60,11,24576
Mvva 136,36,52
buffer_load_dwordx4 a[100:103], v64, s[8:11], s24 offen offset:1024 sc1
Mvva 140,32,56
TR 62,11,28672
Mvva 140,36,60
WL 8
Mvva 144,40,32
TR 32,12,16384
Mvva 144,44,36
buffer_load_dwordx4 a[104:107], v65, s[8:11], s24 offen offset:0 sc1
Mvva 148,40,40
TR 34,12,20480
Mvva 148,44,44
Mvva 152,40,48
TR 36,12,24576
Mvva 152,44,52
buffer_load_dwordx4 a[108:111], v65, s[8:11], s24 offen offset:1024 sc1
Mvva 156,40,56
TR 38,12,28672
Mvva 156,44,60
WL 8
Mvva 160,48,32
TR 40,13,16384
Mvva 160,52,36
Mvva 164,48,40
TR 42,13,20480
Mvva 164,52,44
buffer_load_dwordx4 a[112:115], v66, s[8:11], s24 offen offset:0 sc1
Mvva 168,48,48
TR 44,13,24576
Mvva 168,52,52
buffer_load_dwordx4 a[116:119], v66, s[8:11], s24 offen offset:1024 sc1
Mvva 172,48,56
TR 46,13,28672
Mvva 172,52,60
WL 8
Mvva 176,56,32
TR 48,14,16384
Mvva 176,60,36
Mvva 180,56,40
TR 50,14,20480
Mvva 180,60,44
buffer_load_dwordx4 a[120:123], v67, s[8:11], s24 offen offset:0 sc1
Mvva 184,56,48
TR 52,14,24576
Mvva 184,60,52
buffer_load_dwordx4 a[124:127], v67, s[8:11], s24 offen offset:1024 sc1
Mvva 188,56,56
TR 54,14,28672
Mvva 188,60,60
WL 8
Mvva 192,32,32
TR 56,15,16384
Mvva 192,36,36
Mvva 196,32,40
TR 58,15,20480
Mvva 196,36,44
s_sub_u32 s24, s24, 63488
Mvva 200,32,48
TR 60,15,24576
Mvva 200,36,52
Mvva 204,32,56
TR 62,15,28672
Mvva 204,36,60
WL 8
s_waitcnt vmcnt(12)
s_barrier
Mvva 208,40,32
TR 32,8,32768
Mvva 208,44,36
v_lshlrev_b32 v94, 7, v1
Mvva 212,40,40
TR 34,8,36864
Mvva 212,44,44
Mvva 216,40,48
TR 36,8,40960
Mvva 216,44,52
s_lshl_b32 s36, s3, 13
Mvva 220,40,56
TR 38,8,45056
Mvva 220,44,60
WL 8
Mvva 224,48,32
TR 40,9,32768
Mvva 224,52,36
Mvva 228,48,40
TR 42,9,36864
Mvva 228,52,44
Mvva 232,48,48
TR 44,9,40960
Mvva 232,52,52
v_add_u32 v94, s36, v94
Mvva 236,48,56
TR 46,9,45056
Mvva 236,52,60
WL 8
Mvva 240,56,32
TR 48,10,32768
Mvva 240,60,36
Mvva 244,56,40
TR 50,10,36864
Mvva 244,60,44
Mvva 248,56,48
TR 52,10,40960
Mvva 248,60,52
v_add_u32 v94, A2_fin-M1_pc, v94
Mvva 252,56,56
TR 54,10,45056
Mvva 252,60,60
WL 8
Mvva 128,32,64
TR 56,11,32768
Mvva 128,36,68
Mvva 132,32,72
TR 58,11,36864
Mvva 132,36,76
v_min_u32 v94, M1_last-M1_pc, v94
Mvva 136,32,80
TR 60,11,40960
Mvva 136,36,84
Mvva 140,32,88
TR 62,11,45056
Mvva 140,36,92
WL 8
Mvva 144,40,64
TR 32,12,32768
Mvva 144,44,68
Mvva 148,40,72
TR 34,12,36864
Mvva 148,44,76
v_add_co_u32 v94, vcc, s100, v94
Mvva 152,40,80
TR 36,12,40960
Mvva 152,44,84
Mvva 156,40,88
TR 38,12,45056
Mvva 156,44,92
WL 8
Mvva 160,48,64
TR 40,13,32768
Mvva 160,52,68
Mvva 164,48,72
TR 42,13,36864
Mvva 164,52,76
v_mov_b32 v95, s101
Mvva 168,48,80
TR 44,13,40960
Mvva 168,52,84
Mvva 172,48,88
TR 46,13,45056
Mvva 172,52,92
WL 8
Mvva 176,56,64
TR 48,14,32768
Mvva 176,60,68
v_addc_co_u32 v95, vcc, 0, v95, vcc
Mvva 180,56,72
TR 50,14,36864
Mvva 180,60,76
Mvva 184,56,80
TR 52,14,40960
Mvva 184,60,84
Mvva 188,56,88
TR 54,14,45056
Mvva 188,60,92
WL 8
Mvva 192,32,64
TR 56,15,32768
Mvva 192,36,68
global_load_dword v89, v[94:95], off
Mvva 196,32,72
TR 58,15,36864
Mvva 196,36,76
Mvva 200,32,80
TR 60,15,40960
Mvva 200,36,84
Mvva 204,32,88
TR 62,15,45056
Mvva 204,36,92
WL 8
s_waitcnt vmcnt(1)
s_barrier
Mvva 208,40,64
TR 32,8,49152
Mvva 208,44,68
Mvva 212,40,72
TR 34,8,53248
Mvva 212,44,76
Mvva 216,40,80
TR 36,8,57344
Mvva 216,44,84
Mvva 220,40,88
TR 38,8,61440
Mvva 220,44,92
WL 8
Mvva 224,48,64
TR 40,9,49152
Mvva 224,52,68
Mvva 228,48,72
TR 42,9,53248
Mvva 228,52,76
Mvva 232,48,80
TR 44,9,57344
Mvva 232,52,84
Mvva 236,48,88
TR 46,9,61440
Mvva 236,52,92
WL 8
Mvva 240,56,64
TR 48,10,49152
Mvva 240,60,68
Mvva 244,56,72
TR 50,10,53248
Mvva 244,60,76
Mvva 248,56,80
TR 52,10,57344
Mvva 248,60,84
Mvva 252,56,88
TR 54,10,61440
Mvva 252,60,92
WL 8
Mvva 128,32,96
TR 56,11,49152
Mvva 128,36,100
Mvva 132,32,104
TR 58,11,53248
Mvva 132,36,108
Mvva 136,32,112
TR 60,11,57344
Mvva 136,36,116
Mvva 140,32,120
TR 62,11,61440
Mvva 140,36,124
WL 8
Mvva 144,40,96
TR 32,12,49152
Mvva 144,44,100
Mvva 148,40,104
TR 34,12,53248
Mvva 148,44,108
Mvva 152,40,112
TR 36,12,57344
Mvva 152,44,116
Mvva 156,40,120
TR 38,12,61440
Mvva 156,44,124
WL 8
Mvva 160,48,96
TR 40,13,49152
Mvva 160,52,100
Mvva 164,48,104
TR 42,13,53248
Mvva 164,52,108
Mvva 168,48,112
TR 44,13,57344
Mvva 168,52,116
Mvva 172,48,120
TR 46,13,61440
Mvva 172,52,124
WL 8
Mvva 176,56,96
TR 48,14,49152
Mvva 176,60,100
Mvva 180,56,104
TR 50,14,53248
Mvva 180,60,108
Mvva 184,56,112
TR 52,14,57344
Mvva 184,60,116
Mvva 188,56,120
TR 54,14,61440
Mvva 188,60,124
WL 8
Mvva 192,32,96
TR 56,15,49152
Mvva 192,36,100
Mvva 196,32,104
TR 58,15,53248
Mvva 196,36,108
Mvva 200,32,112
TR 60,15,57344
Mvva 200,36,116
Mvva 204,32,120
TR 62,15,61440
Mvva 204,36,124
WL 8
Mvva 208,40,96
Mvva 208,44,100
Mvva 212,40,104
Mvva 212,44,108
Mvva 216,40,112
Mvva 216,44,116
Mvva 220,40,120
Mvva 220,44,124
WL 4
Mvva 224,48,96
Mvva 224,52,100
Mvva 228,48,104
Mvva 228,52,108
Mvva 232,48,112
Mvva 232,52,116
Mvva 236,48,120
Mvva 236,52,124
WL 0
Mvva 240,56,96
Mvva 240,60,100
Mvva 244,56,104
Mvva 244,60,108
Mvva 248,56,112
Mvva 248,60,116
Mvva 252,56,120
Mvva 252,60,124
s_mov_b32 s16, s94
s_mov_b32 s17, s95
s_mov_b32 s18, 4194304
s_mov_b32 s19, 0x20000
A2_fin:
s_lshl_b32 s37, s40, 16
s_add_u32 s37, s37, s78
s_add_u32 s36, s40, 1
s_and_b32 s36, s36, 3
s_lshl_b32 s36, s36, 14
s_add_u32 s49, s37, s36
s_add_u32 s36, s40, 2
s_and_b32 s36, s36, 3
s_lshl_b32 s36, s36, 14
s_add_u32 s50, s37, s36
s_add_u32 s36, s40, 3
s_and_b32 s36, s36, 3
s_lshl_b32 s36, s36, 14
s_add_u32 s51, s37, s36
s_add_u32 s48, s47, 128
v_mov_b32 v2, 0
CV 24,132,133
CV 25,134,135
CV 26,148,149
CV 27,150,151
buffer_store_dwordx4 v[24:27], v88, s[88:91], s49 offen offset:0 sc1
CV 28,164,165
CV 29,166,167
CV 30,180,181
CV 31,182,183
buffer_store_dwordx4 v[28:31], v88, s[88:91], s49 offen offset:1024 sc1
CV 32,196,197
CV 33,198,199
CV 34,212,213
CV 35,214,215
buffer_store_dwordx4 v[32:35], v88, s[88:91], s49 offen offset:2048 sc1
CV 36,228,229
CV 37,230,231
CV 38,244,245
CV 39,246,247
buffer_store_dwordx4 v[36:39], v88, s[88:91], s49 offen offset:3072 sc1
CV 24,136,137
CV 25,138,139
CV 26,152,153
CV 27,154,155
buffer_store_dwordx4 v[24:27], v88, s[88:91], s50 offen offset:0 sc1
CV 28,168,169
CV 29,170,171
CV 30,184,185
CV 31,186,187
buffer_store_dwordx4 v[28:31], v88, s[88:91], s50 offen offset:1024 sc1
CV 32,200,201
CV 33,202,203
CV 34,216,217
CV 35,218,219
buffer_store_dwordx4 v[32:35], v88, s[88:91], s50 offen offset:2048 sc1
CV 36,232,233
CV 37,234,235
CV 38,248,249
CV 39,250,251
buffer_store_dwordx4 v[36:39], v88, s[88:91], s50 offen offset:3072 sc1
CV 24,140,141
CV 25,142,143
CV 26,156,157
CV 27,158,159
buffer_store_dwordx4 v[24:27], v88, s[88:91], s51 offen offset:0 sc1
CV 28,172,173
CV 29,174,175
CV 30,188,189
CV 31,190,191
buffer_store_dwordx4 v[28:31], v88, s[88:91], s51 offen offset:1024 sc1
CV 32,204,205
CV 33,206,207
CV 34,220,221
CV 35,222,223
buffer_store_dwordx4 v[32:35], v88, s[88:91], s51 offen offset:2048 sc1
CV 36,236,237
CV 37,238,239
CV 38,252,253
CV 39,254,255
buffer_store_dwordx4 v[36:39], v88, s[88:91], s51 offen offset:3072 sc1
s_lshl_b32 s37, s40, 14
s_add_u32 s37, s37, s78
s_xor_b32 s36, s40, 1
s_lshl_b32 s36, s36, 16
s_add_u32 s36, s36, s37
s_add_u32 s52, s37, 131072
s_add_u32 s53, s37, 196608
s_mov_b32 s56, s36
v_and_b32 v2, 15, v1
v_lshrrev_b32 v3, 5, v1
v_bfe_u32 v4, v1, 4, 1
v_lshlrev_b32 v4, 3, v4
v_lshl_add_u32 v4, v2, 8, v4
v_add_u32 v4, s46, v4
v_add_u32 v5, 0, v3
v_xor_b32 v5, v5, v2
v_lshl_add_u32 v8, v5, 4, v4
ds_read_b64 v[104:105], v8
v_add_u32 v5, 2, v3
v_xor_b32 v5, v5, v2
v_lshl_add_u32 v9, v5, 4, v4
ds_read_b64 v[106:107], v9
v_add_u32 v5, 4, v3
v_xor_b32 v5, v5, v2
v_lshl_add_u32 v10, v5, 4, v4
ds_read_b64 v[108:109], v10
v_add_u32 v5, 6, v3
v_xor_b32 v5, v5, v2
v_lshl_add_u32 v11, v5, 4, v4
ds_read_b64 v[110:111], v11
v_add_u32 v5, 8, v3
v_xor_b32 v5, v5, v2
v_lshl_add_u32 v12, v5, 4, v4
ds_read_b64 v[112:113], v12
v_add_u32 v5, 10, v3
v_xor_b32 v5, v5, v2
v_lshl_add_u32 v13, v5, 4, v4
ds_read_b64 v[114:115], v13
v_add_u32 v5, 12, v3
v_xor_b32 v5, v5, v2
v_lshl_add_u32 v14, v5, 4, v4
ds_read_b64 v[116:117], v14
v_add_u32 v5, 14, v3
v_xor_b32 v5, v5, v2
v_lshl_add_u32 v15, v5, 4, v4
ds_read_b64 v[118:119], v15
v_lshlrev_b32 v136, 16, v72
v_and_b32 v137, 0xffff0000, v72
v_lshlrev_b32 v138, 16, v73
v_and_b32 v139, 0xffff0000, v73
v_lshlrev_b32 v152, 16, v74
v_and_b32 v153, 0xffff0000, v74
v_lshlrev_b32 v154, 16, v75
v_and_b32 v155, 0xffff0000, v75
v_lshlrev_b32 v168, 16, v76
v_and_b32 v169, 0xffff0000, v76
v_lshlrev_b32 v170, 16, v77
v_and_b32 v171, 0xffff0000, v77
v_lshlrev_b32 v184, 16, v78
v_and_b32 v185, 0xffff0000, v78
v_lshlrev_b32 v186, 16, v79
v_and_b32 v187, 0xffff0000, v79
v_lshlrev_b32 v200, 16, v80
v_and_b32 v201, 0xffff0000, v80
v_lshlrev_b32 v202, 16, v81
v_and_b32 v203, 0xffff0000, v81
v_lshlrev_b32 v216, 16, v82
v_and_b32 v217, 0xffff0000, v82
v_lshlrev_b32 v218, 16, v83
v_and_b32 v219, 0xffff0000, v83
v_lshlrev_b32 v232, 16, v84
v_and_b32 v233, 0xffff0000, v84
v_lshlrev_b32 v234, 16, v85
v_and_b32 v235, 0xffff0000, v85
v_lshlrev_b32 v248, 16, v86
v_and_b32 v249, 0xffff0000, v86
v_lshlrev_b32 v250, 16, v87
v_and_b32 v251, 0xffff0000, v87
WL 0
v_lshlrev_b32 v132, 16, v104
v_and_b32 v133, 0xffff0000, v104
v_lshlrev_b32 v134, 16, v105
v_and_b32 v135, 0xffff0000, v105
v_lshlrev_b32 v148, 16, v106
v_and_b32 v149, 0xffff0000, v106
v_lshlrev_b32 v150, 16, v107
v_and_b32 v151, 0xffff0000, v107
v_lshlrev_b32 v164, 16, v108
v_and_b32 v165, 0xffff0000, v108
v_lshlrev_b32 v166, 16, v109
v_and_b32 v167, 0xffff0000, v109
v_lshlrev_b32 v180, 16, v110
v_and_b32 v181, 0xffff0000, v110
v_lshlrev_b32 v182, 16, v111
v_and_b32 v183, 0xffff0000, v111
v_lshlrev_b32 v196, 16, v112
v_and_b32 v197, 0xffff0000, v112
v_lshlrev_b32 v198, 16, v113
v_and_b32 v199, 0xffff0000, v113
v_lshlrev_b32 v212, 16, v114
v_and_b32 v213, 0xffff0000, v114
v_lshlrev_b32 v214, 16, v115
v_and_b32 v215, 0xffff0000, v115
v_lshlrev_b32 v228, 16, v116
v_and_b32 v229, 0xffff0000, v116
v_lshlrev_b32 v230, 16, v117
v_and_b32 v231, 0xffff0000, v117
v_lshlrev_b32 v244, 16, v118
v_and_b32 v245, 0xffff0000, v118
v_lshlrev_b32 v246, 16, v119
v_and_b32 v247, 0xffff0000, v119
v_mov_b32 v2, 0
v_add_u32 v16, s46, v88
v_mov_b32 v4, 0xbfb8aa3b
v_mov_b32 v5, 0xbfb8aa3b
v_mov_b32 v6, 0x3f800000
v_mov_b32 v7, 0x3f800000
v_and_b32 v2, 1, v1
v_lshlrev_b32 v2, 7, v2
s_waitcnt vmcnt(0)
s_barrier
s_cmp_lg_u32 s3, 0
s_cbranch_scc1 A2_fsig
s_mov_b64 exec, 1
v_mov_b32 v3, 1
buffer_atomic_add v3, off, s[84:87], s48 sc1
s_mov_b64 exec, -1
A2_fsig:
A2_p1:
s_sleep 4
buffer_load_dword v89, v2, s[84:87], s47 offen sc1
s_waitcnt vmcnt(0)
v_cmp_eq_u32 vcc, 2, v89
s_nop 1
s_bitcmp1_b32 vcc_lo, 0
s_cbranch_scc0 A2_p1
A2_g1:
s_and_b32 s59, vcc_lo, 2
s_cmp_eq_u32 s59, 0
s_cbranch_scc1 A2_n2
buffer_load_dwordx4 v[24:27], v88, s[88:91], s56 offen offset:0 sc1
buffer_load_dwordx4 v[28:31], v88, s[88:91], s56 offen offset:1024 sc1
buffer_load_dwordx4 v[32:35], v88, s[88:91], s56 offen offset:2048 sc1
buffer_load_dwordx4 v[36:39], v88, s[88:91], s56 offen offset:3072 sc1
A2_n2:
buffer_load_dwordx4 v[40:43], v88, s[88:91], s52 offen offset:0 sc1
buffer_load_dwordx4 v[44:47], v88, s[88:91], s53 offen offset:0 sc1
buffer_load_dwordx4 v[48:51], v88, s[88:91], s52 offen offset:1024 sc1
buffer_load_dwordx4 v[52:55], v88, s[88:91], s53 offen offset:1024 sc1
buffer_load_dwordx4 v[56:59], v88, s[88:91], s52 offen offset:2048 sc1
buffer_load_dwordx4 v[60:63], v88, s[88:91], s53 offen offset:2048 sc1
buffer_load_dwordx4 v[64:67], v88, s[88:91], s52 offen offset:3072 sc1
buffer_load_dwordx4 v[68:71], v88, s[88:91], s53 offen offset:3072 sc1
s_waitcnt vmcnt(6)
v_lshlrev_b32 v96, 16, v40
v_and_b32 v97, 0xffff0000, v40
v_lshlrev_b32 v98, 16, v41
v_and_b32 v99, 0xffff0000, v41
v_lshlrev_b32 v100, 16, v42
v_and_b32 v101, 0xffff0000, v42
v_lshlrev_b32 v102, 16, v43
v_and_b32 v103, 0xffff0000, v43
PA 136,136,96
PA 138,138,98
PA 152,152,100
PA 154,154,102
v_lshlrev_b32 v96, 16, v44
v_and_b32 v97, 0xffff0000, v44
v_lshlrev_b32 v98, 16, v45
v_and_b32 v99, 0xffff0000, v45
v_lshlrev_b32 v100, 16, v46
v_and_b32 v101, 0xffff0000, v46
v_lshlrev_b32 v102, 16, v47
v_and_b32 v103, 0xffff0000, v47
PA 136,136,96
PA 138,138,98
PA 152,152,100
PA 154,154,102
PM 96,136,4
PM 98,138,4
PM 100,152,4
PM 102,154,4
EX 96
EX 97
EX 98
EX 99
EX 100
EX 101
EX 102
EX 103
PA 96,96,6
PA 98,98,6
PA 100,100,6
PA 102,102,6
RC 96
RC 97
RC 98
RC 99
RC 100
RC 101
RC 102
RC 103
PM 136,136,96
PM 138,138,98
PM 152,152,100
PM 154,154,102
s_waitcnt vmcnt(4)
v_lshlrev_b32 v96, 16, v48
v_and_b32 v97, 0xffff0000, v48
v_lshlrev_b32 v98, 16, v49
v_and_b32 v99, 0xffff0000, v49
v_lshlrev_b32 v100, 16, v50
v_and_b32 v101, 0xffff0000, v50
v_lshlrev_b32 v102, 16, v51
v_and_b32 v103, 0xffff0000, v51
PA 168,168,96
PA 170,170,98
PA 184,184,100
PA 186,186,102
v_lshlrev_b32 v96, 16, v52
v_and_b32 v97, 0xffff0000, v52
v_lshlrev_b32 v98, 16, v53
v_and_b32 v99, 0xffff0000, v53
v_lshlrev_b32 v100, 16, v54
v_and_b32 v101, 0xffff0000, v54
v_lshlrev_b32 v102, 16, v55
v_and_b32 v103, 0xffff0000, v55
PA 168,168,96
PA 170,170,98
PA 184,184,100
PA 186,186,102
PM 96,168,4
PM 98,170,4
PM 100,184,4
PM 102,186,4
EX 96
EX 97
EX 98
EX 99
EX 100
EX 101
EX 102
EX 103
PA 96,96,6
PA 98,98,6
PA 100,100,6
PA 102,102,6
RC 96
RC 97
RC 98
RC 99
RC 100
RC 101
RC 102
RC 103
PM 168,168,96
PM 170,170,98
PM 184,184,100
PM 186,186,102
s_waitcnt vmcnt(2)
v_lshlrev_b32 v96, 16, v56
v_and_b32 v97, 0xffff0000, v56
v_lshlrev_b32 v98, 16, v57
v_and_b32 v99, 0xffff0000, v57
v_lshlrev_b32 v100, 16, v58
v_and_b32 v101, 0xffff0000, v58
v_lshlrev_b32 v102, 16, v59
v_and_b32 v103, 0xffff0000, v59
PA 200,200,96
PA 202,202,98
PA 216,216,100
PA 218,218,102
v_lshlrev_b32 v96, 16, v60
v_and_b32 v97, 0xffff0000, v60
v_lshlrev_b32 v98, 16, v61
v_and_b32 v99, 0xffff0000, v61
v_lshlrev_b32 v100, 16, v62
v_and_b32 v101, 0xffff0000, v62
v_lshlrev_b32 v102, 16, v63
v_and_b32 v103, 0xffff0000, v63
PA 200,200,96
PA 202,202,98
PA 216,216,100
PA 218,218,102
PM 96,200,4
PM 98,202,4
PM 100,216,4
PM 102,218,4
EX 96
EX 97
EX 98
EX 99
EX 100
EX 101
EX 102
EX 103
PA 96,96,6
PA 98,98,6
PA 100,100,6
PA 102,102,6
RC 96
RC 97
RC 98
RC 99
RC 100
RC 101
RC 102
RC 103
PM 200,200,96
PM 202,202,98
PM 216,216,100
PM 218,218,102
s_waitcnt vmcnt(0)
v_lshlrev_b32 v96, 16, v64
v_and_b32 v97, 0xffff0000, v64
v_lshlrev_b32 v98, 16, v65
v_and_b32 v99, 0xffff0000, v65
v_lshlrev_b32 v100, 16, v66
v_and_b32 v101, 0xffff0000, v66
v_lshlrev_b32 v102, 16, v67
v_and_b32 v103, 0xffff0000, v67
PA 232,232,96
PA 234,234,98
PA 248,248,100
PA 250,250,102
v_lshlrev_b32 v96, 16, v68
v_and_b32 v97, 0xffff0000, v68
v_lshlrev_b32 v98, 16, v69
v_and_b32 v99, 0xffff0000, v69
v_lshlrev_b32 v100, 16, v70
v_and_b32 v101, 0xffff0000, v70
v_lshlrev_b32 v102, 16, v71
v_and_b32 v103, 0xffff0000, v71
PA 232,232,96
PA 234,234,98
PA 248,248,100
PA 250,250,102
PM 96,232,4
PM 98,234,4
PM 100,248,4
PM 102,250,4
EX 96
EX 97
EX 98
EX 99
EX 100
EX 101
EX 102
EX 103
PA 96,96,6
PA 98,98,6
PA 100,100,6
PA 102,102,6
RC 96
RC 97
RC 98
RC 99
RC 100
RC 101
RC 102
RC 103
PM 232,232,96
PM 234,234,98
PM 248,248,100
PM 250,250,102
s_cmp_lg_u32 s59, 0
s_cbranch_scc1 A2_h2
A2_p2:
buffer_load_dword v89, off, s[84:87], s48 sc1
s_waitcnt vmcnt(0)
v_cmp_eq_u32 vcc, 2, v89
s_nop 1
s_cbranch_vccnz A2_g2
s_sleep 4
s_branch A2_p2
A2_g2:
buffer_load_dwordx4 v[24:27], v88, s[88:91], s56 offen offset:0 sc1
buffer_load_dwordx4 v[28:31], v88, s[88:91], s56 offen offset:1024 sc1
buffer_load_dwordx4 v[32:35], v88, s[88:91], s56 offen offset:2048 sc1
buffer_load_dwordx4 v[36:39], v88, s[88:91], s56 offen offset:3072 sc1
A2_h2:
s_waitcnt vmcnt(3)
v_lshlrev_b32 v96, 16, v24
v_and_b32 v97, 0xffff0000, v24
v_lshlrev_b32 v98, 16, v25
v_and_b32 v99, 0xffff0000, v25
v_lshlrev_b32 v100, 16, v26
v_and_b32 v101, 0xffff0000, v26
v_lshlrev_b32 v102, 16, v27
v_and_b32 v103, 0xffff0000, v27
PA 128,128,96
PA 130,130,98
PA 144,144,100
PA 146,146,102
PF 128,128,136,132
PF 130,130,138,134
PF 144,144,152,148
PF 146,146,154,150
CV 120,128,129
CV 121,130,131
CV 122,144,145
CV 123,146,147
ds_write_b64 v8, v[120:121]
ds_write_b64 v9, v[122:123]
s_waitcnt vmcnt(2)
v_lshlrev_b32 v96, 16, v28
v_and_b32 v97, 0xffff0000, v28
v_lshlrev_b32 v98, 16, v29
v_and_b32 v99, 0xffff0000, v29
v_lshlrev_b32 v100, 16, v30
v_and_b32 v101, 0xffff0000, v30
v_lshlrev_b32 v102, 16, v31
v_and_b32 v103, 0xffff0000, v31
PA 160,160,96
PA 162,162,98
PA 176,176,100
PA 178,178,102
PF 160,160,168,164
PF 162,162,170,166
PF 176,176,184,180
PF 178,178,186,182
CV 120,160,161
CV 121,162,163
CV 122,176,177
CV 123,178,179
ds_write_b64 v10, v[120:121]
ds_write_b64 v11, v[122:123]
s_waitcnt vmcnt(1)
v_lshlrev_b32 v96, 16, v32
v_and_b32 v97, 0xffff0000, v32
v_lshlrev_b32 v98, 16, v33
v_and_b32 v99, 0xffff0000, v33
v_lshlrev_b32 v100, 16, v34
v_and_b32 v101, 0xffff0000, v34
v_lshlrev_b32 v102, 16, v35
v_and_b32 v103, 0xffff0000, v35
PA 192,192,96
PA 194,194,98
PA 208,208,100
PA 210,210,102
PF 192,192,200,196
PF 194,194,202,198
PF 208,208,216,212
PF 210,210,218,214
CV 120,192,193
CV 121,194,195
CV 122,208,209
CV 123,210,211
ds_write_b64 v12, v[120:121]
ds_write_b64 v13, v[122:123]
s_waitcnt vmcnt(0)
v_lshlrev_b32 v96, 16, v36
v_and_b32 v97, 0xffff0000, v36
v_lshlrev_b32 v98, 16, v37
v_and_b32 v99, 0xffff0000, v37
v_lshlrev_b32 v100, 16, v38
v_and_b32 v101, 0xffff0000, v38
v_lshlrev_b32 v102, 16, v39
v_and_b32 v103, 0xffff0000, v39
PA 224,224,96
PA 226,226,98
PA 240,240,100
PA 242,242,102
PF 224,224,232,228
PF 226,226,234,230
PF 240,240,248,244
PF 242,242,250,246
CV 120,224,225
CV 121,226,227
CV 122,240,241
CV 123,242,243
ds_write_b64 v14, v[120:121]
ds_write_b64 v15, v[122:123]
WL 0
RQ 40,16,0
RQ 44,16,1024
RQ 48,16,2048
RQ 52,16,3072
WL 3
buffer_store_dwordx4 v[40:43], v90, s[16:19], s42 offen offset:0 sc1
WL 2
buffer_store_dwordx4 v[44:47], v91, s[16:19], s42 offen offset:1024 sc1
WL 1
buffer_store_dwordx4 v[48:51], v92, s[16:19], s42 offen offset:2048 sc1
WL 0
buffer_store_dwordx4 v[52:55], v93, s[16:19], s42 offen offset:3072 sc1
s_endpgm
B3_cs_w:
s_sleep 8
buffer_load_dword v115, v113, s[44:47], 0 offen sc1
s_waitcnt vmcnt(0)
v_cmp_ne_u32 vcc, 8, v115
s_nop 1
s_cbranch_vccnz B3_cs_w
s_branch B3_cs_k
A2_f0_w:
s_sleep 8
buffer_load_dword v40, off, s[84:87], s50 sc1
s_waitcnt vmcnt(0)
v_cmp_ne_u32 vcc, 16, v40
s_nop 1
s_cbranch_vccnz A2_f0_w
s_branch A2_f0_k
A2_f1_w:
s_sleep 8
buffer_load_dword v89, off, s[84:87], s51 sc1
s_waitcnt vmcnt(0)
v_cmp_ne_u32 vcc, 16, v89
s_nop 1
s_cbranch_vccnz A2_f1_w
s_branch A2_f1_k
B2_h0_w:
s_sleep 8
buffer_load_dword v61, v60, s[44:47], s41 offen sc1
s_waitcnt vmcnt(0)
v_cmp_ne_u32 vcc, 8, v61
s_nop 1
s_cbranch_vccnz B2_h0_w
s_branch B2_h0_k
B2_h1_w:
s_sleep 8
buffer_load_dword v61, v60, s[44:47], s42 offen sc1
s_waitcnt vmcnt(0)
v_cmp_ne_u32 vcc, 8, v61
s_nop 1
s_cbranch_vccnz B2_h1_w
s_branch B2_h1_k
B3_x_w:
s_sleep 8
buffer_load_dword v63, v62, s[44:47], s42 offen sc1
s_waitcnt vmcnt(0)
v_cmp_ne_u32 vcc, 8, v63
s_nop 1
s_cbranch_vccnz B3_x_w
s_branch B3_x_k
M1_last:
s_endpgm
.section .rodata,"a"
.p2align 6
.amdhsa_kernel m1_kernel
  .amdhsa_next_free_vgpr 512
  .amdhsa_next_free_sgpr 102
  .amdhsa_accum_offset 256
  .amdhsa_group_segment_fixed_size 0
  .amdhsa_kernarg_size 104
  .amdhsa_user_sgpr_count 2
  .amdhsa_user_sgpr_kernarg_segment_ptr 1
  .amdhsa_system_sgpr_workgroup_id_x 1
.end_amdhsa_kernel
```
